```python
import torch

def _softmax(x, axis=-1):
    return torch.softmax(x, dim=axis)
def _gelu(x):
    return torch.nn.functional.gelu(x, approximate="tanh")
def _silu(x):
    return torch.nn.functional.silu(x)
def _sigmoid(x):
    return torch.sigmoid(x)
def _layernorm(x, axis=-1, eps=1e-5):
    m = x.mean(dim=axis, keepdim=True)
    v = x.var(dim=axis, keepdim=True, unbiased=False)
    return (x - m) / torch.sqrt(v + eps)
def _scatter_add(tgt, idx, src, axis=0):
    return tgt.clone().index_add_(axis, idx, src)
def _segment_sum(src, seg, n):
    out = torch.zeros((n,) + src.shape[1:], dtype=src.dtype)
    return out.index_add_(0, seg, src)
def _pad(x, pw):
    flat = tuple(v for pair in reversed(pw) for v in pair)
    return torch.nn.functional.pad(x, flat)

kernel_name = 'standalone__mha_block_cached__near_ridge'

def setup_inputs():

    _w = (lambda a: (lambda t: t.to(torch.bfloat16) if t.is_floating_point() else t)(torch.as_tensor(a)))
    B, Sq, D = 8, 288, 576
    H, Sk, Dh = 32, 2048, 128
    return {
        "x": _w((lambda *s: torch.randn(*s, dtype=torch.bfloat16) * 0.8)(B, Sq, D)),
        "k_cache": _w((lambda *s: torch.randn(*s, dtype=torch.bfloat16) * 0.8)(B, H, Sk, Dh)),
        "v_cache": _w((lambda *s: torch.randn(*s, dtype=torch.bfloat16) * 0.05)(B, H, Sk, Dh)),
        "wq": _w((lambda *s: torch.randn(*s, dtype=torch.bfloat16) * 0.8)(D, H * Dh) * (D ** -0.5)),
        "wo": _w((lambda *s: torch.randn(*s, dtype=torch.bfloat16) * 0.05)(H * Dh, D) * ((H * Dh) ** -0.5)),
    }

def reference(x, k_cache, v_cache, wq, wo):
    B, Sq, D = x.shape
    H, Dh = 32, 128
    q = (lambda x, *d: x.permute(*d))((x @ wq).reshape(B, Sq, H, Dh), 0, 2, 1, 3)
    scores = torch.einsum("bhqd,bhkd->bhqk", q, k_cache) * (Dh ** -0.5)
    p = _softmax(scores, axis=-1)
    o = torch.einsum("bhqk,bhkd->bhqd", p, v_cache)
    return (lambda x, *d: x.permute(*d))(o, 0, 2, 1, 3).reshape(B, Sq, H * Dh) @ wo
```

```asm
; @launch grid=(256,1,1) block=(256,1,1) lds=163840
.amdgcn_target "amdgcn-amd-amdhsa--gfx950"
.text
.globl standalone__mha_block_cached__near_ridge_kernel
.p2align 8
.type standalone__mha_block_cached__near_ridge_kernel,@function
standalone__mha_block_cached__near_ridge_kernel:
    s_cmp_ge_u32 s2, 256
    s_cbranch_scc1 L1_done
    s_load_dwordx4 s[28:31], s[0:1], 0
    s_load_dwordx4 s[32:35], s[0:1], 16
    s_load_dwordx2 s[36:37], s[0:1], 56
    s_load_dwordx4 s[96:99], s[0:1], 32
    s_load_dwordx2 s[94:95], s[0:1], 48
    v_lshrrev_b32 v24, 6, v0
    v_and_b32 v25, 63, v0
    v_readfirstlane_b32 s38, v24
    s_getpc_b64 s[24:25]
Lpc_attn:
    s_bfe_u32 s7, s2, 0x10003
    s_lshl_b32 s7, s7, 15
    v_lshl_add_u32 v18, v0, 7, s7
    v_min_u32 v18, L1_end-Lpc_attn-4, v18
    v_mov_b32 v19, s25
    v_add_co_u32 v18, vcc, s24, v18
    s_nop 1
    v_addc_co_u32 v19, vcc, 0, v19, vcc
    global_load_dword v22, v[18:19], off
    s_and_b32 s3, s2, 1
    s_lshl_b32 s3, s3, 2
    s_bfe_u32 s5, s2, 0x20003
    s_add_u32 s3, s3, s5
    s_bfe_u32 s4, s2, 0x20001
    s_lshl_b32 s4, s4, 3
    s_lshr_b32 s6, s2, 5
    s_add_u32 s4, s4, s6
    s_mov_b32 s48, 8192
    s_mov_b32 s49, 16384
    s_mov_b32 s50, 24576
    s_mov_b32 s51, 36864
    s_mov_b32 s52, 45056
    s_mov_b32 s53, 53248
    s_mov_b32 s86, 61440
    s_mov_b32 s87, 73728
    s_mov_b32 s88, 31744
    s_mov_b32 s89, 63488
    s_mov_b32 s59, 95232
    s_mul_i32 s44, s38, 9216
    s_lshl_b32 s56, s38, 10
    s_lshl_b32 s39, s38, 12
    v_and_b32 v26, 3, v25
    v_bfe_u32 v27, v25, 2, 2
    v_lshrrev_b32 v28, 4, v25
    v_lshlrev_b32 v32, 6, v28
    v_lshl_add_u32 v32, v26, 4, v32
    v_lshl_add_u32 v33, v27, 13, v32
    v_lshl_add_u32 v3, v24, 17, v33
    v_xor_b32 v4, 48, v3
    v_bfe_u32 v31, v25, 2, 3
    v_mul_u32_u24 v33, 72, v24
    v_add_u32 v33, v33, v31
    v_mul_u32_u24 v33, 1152, v33
    v_and_b32 v30, 1, v24
    v_lshlrev_b32 v34, 1, v30
    v_xor_b32 v34, v34, v26
    v_lshl_add_u32 v33, v34, 4, v33
    v_lshrrev_b32 v29, 5, v25
    v_lshl_add_u32 v2, v29, 6, v33
    v_xor_b32 v21, 32, v2
    s_mul_i32 s6, s3, 331776
    s_lshl_b32 s7, s4, 8
    s_mov_b32 s10, 330752
    s_mov_b32 s11, 0x20000
    s_mov_b32 s14, 516352
    s_mov_b32 s15, 0x20000
    s_waitcnt lgkmcnt(0)
    s_add_u32 s8, s28, s6
    s_addc_u32 s9, s29, 0
    s_add_u32 s12, s34, s7
    s_addc_u32 s13, s35, 0
    s_add_u32 m0, s39, 36864
    s_nop 0
    buffer_load_dwordx4 v3, s[12:15], 0 offen lds
    v_lshlrev_b32 v1, 4, v25
    v_lshl_add_u32 v33, v27, 8, v32
    v_lshl_add_u32 v5, v24, 12, v33
    v_xor_b32 v6, 48, v5
    v_and_b32 v35, 1, v28
    buffer_load_dwordx4 v3, s[12:15], s88 offen offset:1024 lds
    v_lshl_or_b32 v36, v35, 1, v29
    v_and_b32 v37, 1, v27
    v_mul_u32_u24 v37, 3, v37
    v_xor_b32 v36, v36, v37
    v_lshlrev_b32 v36, 4, v36
    buffer_load_dwordx4 v4, s[12:15], s89 offen offset:2048 lds
    v_lshl_add_u32 v36, v26, 6, v36
    v_lshl_add_u32 v36, v27, 10, v36
    v_lshl_add_u32 v7, v30, 13, v36
    v_xor_b32 v8, 8192, v7
    v_mul_u32_u24 v37, 3, v35
    buffer_load_dwordx4 v4, s[12:15], s59 offen offset:3072 lds
    v_lshrrev_b32 v38, 1, v26
    v_xor_b32 v37, v37, v38
    v_lshlrev_b32 v37, 4, v37
    v_and_b32 v38, 1, v26
    v_lshl_add_u32 v37, v38, 3, v37
    s_add_u32 s12, s12, 524288
    s_addc_u32 s13, s13, 0
    s_add_u32 m0, s44, 0
    s_nop 0
    buffer_load_dwordx4 v2, s[8:11], 0 offen lds
    v_lshl_add_u32 v37, v27, 6, v37
    v_lshl_add_u32 v38, v28, 10, v37
    v_lshl_add_u32 v9, v30, 13, v38
    v_xor_b32 v10, 8192, v9
    v_lshl_add_u32 v38, v28, 11, v37
    buffer_load_dwordx4 v21, s[8:11], s48 offen offset:1024 lds
    v_lshl_add_u32 v38, v30, 9, v38
    v_add_u32 v13, 36864, v38
    v_xor_b32 v14, 32, v13
    v_xor_b32 v15, 512, v13
    v_xor_b32 v16, 512, v14
    buffer_load_dwordx4 v2, s[8:11], s49 offen offset:2048 lds
    v_bfe_u32 v38, v25, 3, 1
    v_lshlrev_b32 v39, 1, v38
    v_xor_b32 v39, v39, v28
    v_lshlrev_b32 v39, 4, v39
    v_lshl_add_u32 v39, v38, 10, v39
    buffer_load_dwordx4 v21, s[8:11], s50 offen offset:3072 lds
    v_and_b32 v38, 7, v25
    v_lshl_add_u32 v39, v38, 6, v39
    v_lshl_add_u32 v11, v24, 13, v39
    v_lshrrev_b32 v38, 1, v24
    v_lshl_add_u32 v39, v38, 11, v39
    s_add_u32 m0, s44, 4096
    s_nop 0
    buffer_load_dwordx4 v2, s[8:11], s51 offen lds
    v_add_u32 v12, 32768, v39
    v_cmp_eq_u32 vcc, 0, v26
    v_mov_b32 v38, 0x3f803f80
    s_nop 0
    v_cndmask_b32 v38, 0, v38, vcc
    buffer_load_dwordx4 v21, s[8:11], s52 offen offset:1024 lds
    v_accvgpr_write_b32 a180, v38
    v_accvgpr_write_b32 a181, v38
    v_accvgpr_write_b32 a182, v38
    v_accvgpr_write_b32 a183, v38
    buffer_load_dwordx4 v2, s[8:11], s53 offen offset:2048 lds
    buffer_load_dwordx4 v21, s[8:11], s86 offen offset:3072 lds
    s_add_u32 m0, s44, 8192
    s_nop 0
    buffer_load_dwordx4 v2, s[8:11], s87 offen lds
    s_add_u32 s8, s8, 128
    s_addc_u32 s9, s9, 0
    s_add_u32 m0, s39, 90112
    s_nop 0
    buffer_load_dwordx4 v3, s[12:15], 0 offen lds
    buffer_load_dwordx4 v3, s[12:15], s88 offen offset:1024 lds
    buffer_load_dwordx4 v4, s[12:15], s89 offen offset:2048 lds
    buffer_load_dwordx4 v4, s[12:15], s59 offen offset:3072 lds
    s_add_u32 s12, s12, 524288
    s_addc_u32 s13, s13, 0
    s_add_u32 m0, s44, 53248
    s_nop 0
    buffer_load_dwordx4 v2, s[8:11], 0 offen lds
    buffer_load_dwordx4 v21, s[8:11], s48 offen offset:1024 lds
    buffer_load_dwordx4 v2, s[8:11], s49 offen offset:2048 lds
    buffer_load_dwordx4 v21, s[8:11], s50 offen offset:3072 lds
    s_add_u32 m0, s44, 57344
    s_nop 0
    buffer_load_dwordx4 v2, s[8:11], s51 offen lds
    buffer_load_dwordx4 v21, s[8:11], s52 offen offset:1024 lds
    buffer_load_dwordx4 v2, s[8:11], s53 offen offset:2048 lds
    buffer_load_dwordx4 v21, s[8:11], s86 offen offset:3072 lds
    s_add_u32 m0, s44, 61440
    s_nop 0
    buffer_load_dwordx4 v2, s[8:11], s87 offen lds
    s_add_u32 s8, s8, 128
    s_addc_u32 s9, s9, 0
    s_waitcnt vmcnt(13)
    s_barrier
    ds_read_b128 a[184:187], v11 offset:0
    ds_read_b128 a[188:191], v11 offset:512
    ds_read_b64_tr_b16 a[216:217], v13 offset:0
    ds_read_b64_tr_b16 a[218:219], v13 offset:1024
    ds_read_b64_tr_b16 a[220:221], v13 offset:8192
    ds_read_b64_tr_b16 a[222:223], v13 offset:9216
    ds_read_b128 a[192:195], v11 offset:2048
    ds_read_b128 a[196:199], v11 offset:2560
    ds_read_b128 a[200:203], v11 offset:4096
    ds_read_b128 a[204:207], v11 offset:4608
    ds_read_b128 a[208:211], v11 offset:6144
    ds_read_b128 a[212:215], v11 offset:6656
    ds_read_b128 a[248:251], v12 offset:0
    ds_read_b128 a[252:255], v12 offset:512
    ds_read_b64_tr_b16 a[224:225], v14 offset:0
    ds_read_b64_tr_b16 a[226:227], v14 offset:1024
    ds_read_b64_tr_b16 a[228:229], v14 offset:8192
    ds_read_b64_tr_b16 a[230:231], v14 offset:9216
    ds_read_b64_tr_b16 a[232:233], v13 offset:256
    ds_read_b64_tr_b16 a[234:235], v13 offset:1280
    ds_read_b64_tr_b16 a[236:237], v13 offset:8448
    ds_read_b64_tr_b16 a[238:239], v13 offset:9472
    s_waitcnt lgkmcnt(0)
    v_mfma_f32_16x16x32_bf16 v[104:107], a[216:219], a[184:187], 0
    s_add_u32 m0, s39, 143360
    v_mfma_f32_16x16x32_bf16 v[104:107], a[220:223], a[188:191], v[104:107]
    ds_read_b64_tr_b16 a[240:241], v14 offset:256
    ds_read_b64_tr_b16 a[242:243], v14 offset:1280
    v_mfma_f32_16x16x32_bf16 v[136:139], a[216:219], a[192:195], 0
    ds_read_b64_tr_b16 a[244:245], v14 offset:8448
    ds_read_b64_tr_b16 a[246:247], v14 offset:9472
    v_mfma_f32_16x16x32_bf16 v[136:139], a[220:223], a[196:199], v[136:139]
    buffer_load_dwordx4 v3, s[12:15], 0 offen lds
    v_mfma_f32_16x16x32_bf16 v[168:171], a[216:219], a[200:203], 0
    v_mfma_f32_16x16x32_bf16 v[168:171], a[220:223], a[204:207], v[168:171]
    v_mfma_f32_16x16x32_bf16 v[200:203], a[216:219], a[208:211], 0
    buffer_load_dwordx4 v3, s[12:15], s88 offen offset:1024 lds
    v_mfma_f32_16x16x32_bf16 v[200:203], a[220:223], a[212:215], v[200:203]
    v_mfma_f32_16x16x32_bf16 v[232:235], a[216:219], a[248:251], 0
    v_mfma_f32_16x16x32_bf16 v[232:235], a[220:223], a[252:255], v[232:235]
    buffer_load_dwordx4 v4, s[12:15], s89 offen offset:2048 lds
    v_mfma_f32_16x16x32_bf16 v[108:111], a[224:227], a[184:187], 0
    v_mfma_f32_16x16x32_bf16 v[108:111], a[228:231], a[188:191], v[108:111]
    ds_read_b64_tr_b16 a[216:217], v15 offset:0
    ds_read_b64_tr_b16 a[218:219], v15 offset:1024
    v_mfma_f32_16x16x32_bf16 v[140:143], a[224:227], a[192:195], 0
    ds_read_b64_tr_b16 a[220:221], v15 offset:8192
    ds_read_b64_tr_b16 a[222:223], v15 offset:9216
    v_mfma_f32_16x16x32_bf16 v[140:143], a[228:231], a[196:199], v[140:143]
    buffer_load_dwordx4 v4, s[12:15], s59 offen offset:3072 lds
    v_mfma_f32_16x16x32_bf16 v[172:175], a[224:227], a[200:203], 0
    s_add_u32 s12, s12, 524288
    s_addc_u32 s13, s13, 0
    v_mfma_f32_16x16x32_bf16 v[172:175], a[228:231], a[204:207], v[172:175]
    s_add_u32 m0, s44, 106496
    v_mfma_f32_16x16x32_bf16 v[204:207], a[224:227], a[208:211], 0
    buffer_load_dwordx4 v2, s[8:11], 0 offen lds
    v_mfma_f32_16x16x32_bf16 v[204:207], a[228:231], a[212:215], v[204:207]
    v_mfma_f32_16x16x32_bf16 v[236:239], a[224:227], a[248:251], 0
    v_mfma_f32_16x16x32_bf16 v[236:239], a[228:231], a[252:255], v[236:239]
    buffer_load_dwordx4 v21, s[8:11], s48 offen offset:1024 lds
    v_mfma_f32_16x16x32_bf16 v[112:115], a[232:235], a[184:187], 0
    v_mfma_f32_16x16x32_bf16 v[112:115], a[236:239], a[188:191], v[112:115]
    ds_read_b64_tr_b16 a[224:225], v16 offset:0
    ds_read_b64_tr_b16 a[226:227], v16 offset:1024
    v_mfma_f32_16x16x32_bf16 v[144:147], a[232:235], a[192:195], 0
    ds_read_b64_tr_b16 a[228:229], v16 offset:8192
    ds_read_b64_tr_b16 a[230:231], v16 offset:9216
    v_mfma_f32_16x16x32_bf16 v[144:147], a[236:239], a[196:199], v[144:147]
    buffer_load_dwordx4 v2, s[8:11], s49 offen offset:2048 lds
    v_mfma_f32_16x16x32_bf16 v[176:179], a[232:235], a[200:203], 0
    v_mfma_f32_16x16x32_bf16 v[176:179], a[236:239], a[204:207], v[176:179]
    v_mfma_f32_16x16x32_bf16 v[208:211], a[232:235], a[208:211], 0
    buffer_load_dwordx4 v21, s[8:11], s50 offen offset:3072 lds
    v_mfma_f32_16x16x32_bf16 v[208:211], a[236:239], a[212:215], v[208:211]
    s_add_u32 m0, s44, 110592
    v_mfma_f32_16x16x32_bf16 v[240:243], a[232:235], a[248:251], 0
    buffer_load_dwordx4 v2, s[8:11], s51 offen lds
    v_mfma_f32_16x16x32_bf16 v[240:243], a[236:239], a[252:255], v[240:243]
    s_waitcnt lgkmcnt(0)
    v_mfma_f32_16x16x32_bf16 v[116:119], a[240:243], a[184:187], 0
    v_mfma_f32_16x16x32_bf16 v[116:119], a[244:247], a[188:191], v[116:119]
    ds_read_b64_tr_b16 a[232:233], v15 offset:256
    ds_read_b64_tr_b16 a[234:235], v15 offset:1280
    v_mfma_f32_16x16x32_bf16 v[148:151], a[240:243], a[192:195], 0
    ds_read_b64_tr_b16 a[236:237], v15 offset:8448
    ds_read_b64_tr_b16 a[238:239], v15 offset:9472
    v_mfma_f32_16x16x32_bf16 v[148:151], a[244:247], a[196:199], v[148:151]
    buffer_load_dwordx4 v21, s[8:11], s52 offen offset:1024 lds
    v_mfma_f32_16x16x32_bf16 v[180:183], a[240:243], a[200:203], 0
    v_mfma_f32_16x16x32_bf16 v[180:183], a[244:247], a[204:207], v[180:183]
    v_mfma_f32_16x16x32_bf16 v[212:215], a[240:243], a[208:211], 0
    buffer_load_dwordx4 v2, s[8:11], s53 offen offset:2048 lds
    v_mfma_f32_16x16x32_bf16 v[212:215], a[244:247], a[212:215], v[212:215]
    v_mfma_f32_16x16x32_bf16 v[244:247], a[240:243], a[248:251], 0
    v_mfma_f32_16x16x32_bf16 v[244:247], a[244:247], a[252:255], v[244:247]
    buffer_load_dwordx4 v21, s[8:11], s86 offen offset:3072 lds
    v_mfma_f32_16x16x32_bf16 v[120:123], a[216:219], a[184:187], 0
    s_add_u32 m0, s44, 114688
    v_mfma_f32_16x16x32_bf16 v[120:123], a[220:223], a[188:191], v[120:123]
    ds_read_b64_tr_b16 a[240:241], v16 offset:256
    ds_read_b64_tr_b16 a[242:243], v16 offset:1280
    v_mfma_f32_16x16x32_bf16 v[152:155], a[216:219], a[192:195], 0
    ds_read_b64_tr_b16 a[244:245], v16 offset:8448
    ds_read_b64_tr_b16 a[246:247], v16 offset:9472
    v_mfma_f32_16x16x32_bf16 v[152:155], a[220:223], a[196:199], v[152:155]
    buffer_load_dwordx4 v2, s[8:11], s87 offen lds
    v_mfma_f32_16x16x32_bf16 v[184:187], a[216:219], a[200:203], 0
    s_add_u32 s8, s8, 128
    s_addc_u32 s9, s9, 0
    v_mfma_f32_16x16x32_bf16 v[184:187], a[220:223], a[204:207], v[184:187]
    v_mfma_f32_16x16x32_bf16 v[216:219], a[216:219], a[208:211], 0
    v_mfma_f32_16x16x32_bf16 v[216:219], a[220:223], a[212:215], v[216:219]
    v_add_u32 v11, 0xd000, v11
    v_add_u32 v13, 0xd000, v13
    v_mfma_f32_16x16x32_bf16 v[124:127], a[224:227], a[184:187], 0
    v_add_u32 v14, 0xd000, v14
    v_add_u32 v12, 0xd000, v12
    v_mfma_f32_16x16x32_bf16 v[124:127], a[228:231], a[188:191], v[124:127]
    v_add_u32 v15, 0xd000, v15
    v_add_u32 v16, 0xd000, v16
    v_mfma_f32_16x16x32_bf16 v[156:159], a[224:227], a[192:195], 0
    v_mfma_f32_16x16x32_bf16 v[156:159], a[228:231], a[196:199], v[156:159]
    v_mfma_f32_16x16x32_bf16 v[188:191], a[224:227], a[200:203], 0
    s_waitcnt vmcnt(13) lgkmcnt(0)
    s_barrier
    v_mfma_f32_16x16x32_bf16 v[188:191], a[228:231], a[204:207], v[188:191]
    ds_read_b128 v[64:67], v11 offset:0
    ds_read_b128 v[68:71], v11 offset:512
    v_mfma_f32_16x16x32_bf16 v[220:223], a[224:227], a[208:211], 0
    ds_read_b64_tr_b16 a[216:217], v13 offset:0
    ds_read_b64_tr_b16 a[218:219], v13 offset:1024
    v_mfma_f32_16x16x32_bf16 v[220:223], a[228:231], a[212:215], v[220:223]
    ds_read_b64_tr_b16 a[220:221], v13 offset:8192
    ds_read_b64_tr_b16 a[222:223], v13 offset:9216
    v_mfma_f32_16x16x32_bf16 v[128:131], a[232:235], a[184:187], 0
    ds_read_b128 v[72:75], v11 offset:2048
    ds_read_b128 v[76:79], v11 offset:2560
    v_mfma_f32_16x16x32_bf16 v[128:131], a[236:239], a[188:191], v[128:131]
    ds_read_b128 v[80:83], v11 offset:4096
    ds_read_b128 v[84:87], v11 offset:4608
    v_mfma_f32_16x16x32_bf16 v[160:163], a[232:235], a[192:195], 0
    ds_read_b128 v[88:91], v11 offset:6144
    ds_read_b128 v[92:95], v11 offset:6656
    v_mfma_f32_16x16x32_bf16 v[160:163], a[236:239], a[196:199], v[160:163]
    ds_read_b128 v[96:99], v12 offset:0
    ds_read_b128 v[100:103], v12 offset:512
    v_mfma_f32_16x16x32_bf16 v[192:195], a[232:235], a[200:203], 0
    ds_read_b64_tr_b16 a[224:225], v14 offset:0
    ds_read_b64_tr_b16 a[226:227], v14 offset:1024
    v_mfma_f32_16x16x32_bf16 v[192:195], a[236:239], a[204:207], v[192:195]
    ds_read_b64_tr_b16 a[228:229], v14 offset:8192
    ds_read_b64_tr_b16 a[230:231], v14 offset:9216
    v_mfma_f32_16x16x32_bf16 v[224:227], a[232:235], a[208:211], 0
    s_add_u32 m0, s39, 36864
    v_mfma_f32_16x16x32_bf16 v[224:227], a[236:239], a[212:215], v[224:227]
    buffer_load_dwordx4 v3, s[12:15], 0 offen lds
    v_mfma_f32_16x16x32_bf16 v[132:135], a[240:243], a[184:187], 0
    v_mfma_f32_16x16x32_bf16 v[132:135], a[244:247], a[188:191], v[132:135]
    ds_read_b64_tr_b16 a[232:233], v13 offset:256
    ds_read_b64_tr_b16 a[234:235], v13 offset:1280
    v_mfma_f32_16x16x32_bf16 v[164:167], a[240:243], a[192:195], 0
    ds_read_b64_tr_b16 a[236:237], v13 offset:8448
    ds_read_b64_tr_b16 a[238:239], v13 offset:9472
    v_mfma_f32_16x16x32_bf16 v[164:167], a[244:247], a[196:199], v[164:167]
    buffer_load_dwordx4 v3, s[12:15], s88 offen offset:1024 lds
    v_mfma_f32_16x16x32_bf16 v[196:199], a[240:243], a[200:203], 0
    v_mfma_f32_16x16x32_bf16 v[196:199], a[244:247], a[204:207], v[196:199]
    v_mfma_f32_16x16x32_bf16 v[228:231], a[240:243], a[208:211], 0
    v_mfma_f32_16x16x32_bf16 v[228:231], a[244:247], a[212:215], v[228:231]
    s_waitcnt lgkmcnt(0)
    buffer_load_dwordx4 v4, s[12:15], s89 offen offset:2048 lds
    v_mfma_f32_16x16x32_bf16 v[104:107], a[216:219], v[64:67], v[104:107]
    s_lshl_b32 s5, s3, 5
    s_add_u32 s5, s5, s4
    v_mfma_f32_16x16x32_bf16 v[104:107], a[220:223], v[68:71], v[104:107]
    ds_read_b64_tr_b16 a[240:241], v14 offset:256
    ds_read_b64_tr_b16 a[242:243], v14 offset:1280
    v_mfma_f32_16x16x32_bf16 v[136:139], a[216:219], v[72:75], v[136:139]
    ds_read_b64_tr_b16 a[244:245], v14 offset:8448
    ds_read_b64_tr_b16 a[246:247], v14 offset:9472
    v_mfma_f32_16x16x32_bf16 v[136:139], a[220:223], v[76:79], v[136:139]
    buffer_load_dwordx4 v4, s[12:15], s59 offen offset:3072 lds
    v_mfma_f32_16x16x32_bf16 v[168:171], a[216:219], v[80:83], v[168:171]
    s_lshl_b32 s6, s5, 19
    v_mfma_f32_16x16x32_bf16 v[168:171], a[220:223], v[84:87], v[168:171]
    s_add_u32 s12, s12, 524288
    s_addc_u32 s13, s13, 0
    v_mfma_f32_16x16x32_bf16 v[200:203], a[216:219], v[88:91], v[200:203]
    s_add_u32 m0, s44, 0
    v_mfma_f32_16x16x32_bf16 v[200:203], a[220:223], v[92:95], v[200:203]
    buffer_load_dwordx4 v2, s[8:11], 0 offen lds
    v_mfma_f32_16x16x32_bf16 v[232:235], a[216:219], v[96:99], v[232:235]
    s_add_u32 s16, s30, s6
    s_addc_u32 s17, s31, 0
    v_mfma_f32_16x16x32_bf16 v[232:235], a[220:223], v[100:103], v[232:235]
    s_mov_b32 s18, 524288
    s_mov_b32 s19, 0x20000
    v_mfma_f32_16x16x32_bf16 v[108:111], a[224:227], v[64:67], v[108:111]
    s_add_u32 s20, s32, s6
    s_addc_u32 s21, s33, 0
    v_mfma_f32_16x16x32_bf16 v[108:111], a[228:231], v[68:71], v[108:111]
    ds_read_b64_tr_b16 a[216:217], v15 offset:0
    ds_read_b64_tr_b16 a[218:219], v15 offset:1024
    v_mfma_f32_16x16x32_bf16 v[140:143], a[224:227], v[72:75], v[140:143]
    ds_read_b64_tr_b16 a[220:221], v15 offset:8192
    ds_read_b64_tr_b16 a[222:223], v15 offset:9216
    v_mfma_f32_16x16x32_bf16 v[140:143], a[228:231], v[76:79], v[140:143]
    buffer_load_dwordx4 v21, s[8:11], s48 offen offset:1024 lds
    v_mfma_f32_16x16x32_bf16 v[172:175], a[224:227], v[80:83], v[172:175]
    s_mov_b32 s22, 524288
    s_mov_b32 s23, 0x20000
    v_mfma_f32_16x16x32_bf16 v[172:175], a[228:231], v[84:87], v[172:175]
    s_mul_i32 s5, s3, 2359296
    s_mul_i32 s6, s4, 4096
    v_mfma_f32_16x16x32_bf16 v[204:207], a[224:227], v[88:91], v[204:207]
    s_add_u32 s5, s5, s6
    v_mfma_f32_16x16x32_bf16 v[204:207], a[228:231], v[92:95], v[204:207]
    buffer_load_dwordx4 v2, s[8:11], s49 offen offset:2048 lds
    v_mfma_f32_16x16x32_bf16 v[236:239], a[224:227], v[96:99], v[236:239]
    s_add_u32 s24, s36, s5
    s_addc_u32 s25, s37, 0
    v_mfma_f32_16x16x32_bf16 v[236:239], a[228:231], v[100:103], v[236:239]
    s_mov_b32 s26, 2232320
    s_mov_b32 s27, 0x20000
    v_mfma_f32_16x16x32_bf16 v[112:115], a[232:235], v[64:67], v[112:115]
    s_mov_b32 s54, 0x3e0293ee
    s_lshl_b32 s57, s3, 2
    v_mfma_f32_16x16x32_bf16 v[112:115], a[236:239], v[68:71], v[112:115]
    ds_read_b64_tr_b16 a[224:225], v16 offset:0
    ds_read_b64_tr_b16 a[226:227], v16 offset:1024
    v_mfma_f32_16x16x32_bf16 v[144:147], a[232:235], v[72:75], v[144:147]
    ds_read_b64_tr_b16 a[228:229], v16 offset:8192
    ds_read_b64_tr_b16 a[230:231], v16 offset:9216
    v_mfma_f32_16x16x32_bf16 v[144:147], a[236:239], v[76:79], v[144:147]
    buffer_load_dwordx4 v21, s[8:11], s50 offen offset:3072 lds
    v_mfma_f32_16x16x32_bf16 v[176:179], a[232:235], v[80:83], v[176:179]
    s_mov_b32 s58, 0x53800000
    v_mfma_f32_16x16x32_bf16 v[176:179], a[236:239], v[84:87], v[176:179]
    s_add_u32 m0, s44, 4096
    v_mfma_f32_16x16x32_bf16 v[208:211], a[232:235], v[88:91], v[208:211]
    buffer_load_dwordx4 v2, s[8:11], s51 offen lds
    v_mfma_f32_16x16x32_bf16 v[208:211], a[236:239], v[92:95], v[208:211]
    v_mfma_f32_16x16x32_bf16 v[240:243], a[232:235], v[96:99], v[240:243]
    v_mfma_f32_16x16x32_bf16 v[240:243], a[236:239], v[100:103], v[240:243]
    s_waitcnt lgkmcnt(0)
    v_mfma_f32_16x16x32_bf16 v[116:119], a[240:243], v[64:67], v[116:119]
    buffer_load_dwordx4 v21, s[8:11], s52 offen offset:1024 lds
    v_mfma_f32_16x16x32_bf16 v[116:119], a[244:247], v[68:71], v[116:119]
    ds_read_b64_tr_b16 a[232:233], v15 offset:256
    ds_read_b64_tr_b16 a[234:235], v15 offset:1280
    v_mfma_f32_16x16x32_bf16 v[148:151], a[240:243], v[72:75], v[148:151]
    ds_read_b64_tr_b16 a[236:237], v15 offset:8448
    ds_read_b64_tr_b16 a[238:239], v15 offset:9472
    v_mfma_f32_16x16x32_bf16 v[148:151], a[244:247], v[76:79], v[148:151]
    v_mfma_f32_16x16x32_bf16 v[180:183], a[240:243], v[80:83], v[180:183]
    buffer_load_dwordx4 v2, s[8:11], s53 offen offset:2048 lds
    v_mfma_f32_16x16x32_bf16 v[180:183], a[244:247], v[84:87], v[180:183]
    v_mfma_f32_16x16x32_bf16 v[212:215], a[240:243], v[88:91], v[212:215]
    v_mfma_f32_16x16x32_bf16 v[212:215], a[244:247], v[92:95], v[212:215]
    v_mfma_f32_16x16x32_bf16 v[244:247], a[240:243], v[96:99], v[244:247]
    buffer_load_dwordx4 v21, s[8:11], s86 offen offset:3072 lds
    v_mfma_f32_16x16x32_bf16 v[244:247], a[244:247], v[100:103], v[244:247]
    v_mfma_f32_16x16x32_bf16 v[120:123], a[216:219], v[64:67], v[120:123]
    s_add_u32 m0, s44, 8192
    v_mfma_f32_16x16x32_bf16 v[120:123], a[220:223], v[68:71], v[120:123]
    ds_read_b64_tr_b16 a[240:241], v16 offset:256
    ds_read_b64_tr_b16 a[242:243], v16 offset:1280
    v_mfma_f32_16x16x32_bf16 v[152:155], a[216:219], v[72:75], v[152:155]
    ds_read_b64_tr_b16 a[244:245], v16 offset:8448
    ds_read_b64_tr_b16 a[246:247], v16 offset:9472
    v_mfma_f32_16x16x32_bf16 v[152:155], a[220:223], v[76:79], v[152:155]
    buffer_load_dwordx4 v2, s[8:11], s87 offen lds
    v_mfma_f32_16x16x32_bf16 v[184:187], a[216:219], v[80:83], v[184:187]
    v_mfma_f32_16x16x32_bf16 v[184:187], a[220:223], v[84:87], v[184:187]
    s_add_u32 s8, s8, 128
    s_addc_u32 s9, s9, 0
    v_mfma_f32_16x16x32_bf16 v[216:219], a[216:219], v[88:91], v[216:219]
    v_mfma_f32_16x16x32_bf16 v[216:219], a[220:223], v[92:95], v[216:219]
    v_add_u32 v11, 0xd000, v11
    v_add_u32 v13, 0xd000, v13
    v_mfma_f32_16x16x32_bf16 v[124:127], a[224:227], v[64:67], v[124:127]
    v_add_u32 v14, 0xd000, v14
    v_add_u32 v12, 0xd000, v12
    v_mfma_f32_16x16x32_bf16 v[124:127], a[228:231], v[68:71], v[124:127]
    v_add_u32 v15, 0xd000, v15
    v_add_u32 v16, 0xd000, v16
    v_mfma_f32_16x16x32_bf16 v[156:159], a[224:227], v[72:75], v[156:159]
    v_mfma_f32_16x16x32_bf16 v[156:159], a[228:231], v[76:79], v[156:159]
    v_mfma_f32_16x16x32_bf16 v[188:191], a[224:227], v[80:83], v[188:191]
    s_waitcnt vmcnt(13) lgkmcnt(0)
    s_barrier
    v_mfma_f32_16x16x32_bf16 v[188:191], a[228:231], v[84:87], v[188:191]
    ds_read_b128 a[184:187], v11 offset:0
    ds_read_b128 a[188:191], v11 offset:512
    v_mfma_f32_16x16x32_bf16 v[220:223], a[224:227], v[88:91], v[220:223]
    ds_read_b64_tr_b16 a[216:217], v13 offset:0
    ds_read_b64_tr_b16 a[218:219], v13 offset:1024
    v_mfma_f32_16x16x32_bf16 v[220:223], a[228:231], v[92:95], v[220:223]
    ds_read_b64_tr_b16 a[220:221], v13 offset:8192
    ds_read_b64_tr_b16 a[222:223], v13 offset:9216
    v_mfma_f32_16x16x32_bf16 v[128:131], a[232:235], v[64:67], v[128:131]
    ds_read_b128 a[192:195], v11 offset:2048
    ds_read_b128 a[196:199], v11 offset:2560
    v_mfma_f32_16x16x32_bf16 v[128:131], a[236:239], v[68:71], v[128:131]
    ds_read_b128 a[200:203], v11 offset:4096
    ds_read_b128 a[204:207], v11 offset:4608
    v_mfma_f32_16x16x32_bf16 v[160:163], a[232:235], v[72:75], v[160:163]
    ds_read_b128 a[208:211], v11 offset:6144
    ds_read_b128 a[212:215], v11 offset:6656
    v_mfma_f32_16x16x32_bf16 v[160:163], a[236:239], v[76:79], v[160:163]
    ds_read_b128 a[248:251], v12 offset:0
    ds_read_b128 a[252:255], v12 offset:512
    v_mfma_f32_16x16x32_bf16 v[192:195], a[232:235], v[80:83], v[192:195]
    ds_read_b64_tr_b16 a[224:225], v14 offset:0
    ds_read_b64_tr_b16 a[226:227], v14 offset:1024
    v_mfma_f32_16x16x32_bf16 v[192:195], a[236:239], v[84:87], v[192:195]
    ds_read_b64_tr_b16 a[228:229], v14 offset:8192
    ds_read_b64_tr_b16 a[230:231], v14 offset:9216
    v_mfma_f32_16x16x32_bf16 v[224:227], a[232:235], v[88:91], v[224:227]
    s_add_u32 m0, s39, 90112
    v_mfma_f32_16x16x32_bf16 v[224:227], a[236:239], v[92:95], v[224:227]
    buffer_load_dwordx4 v3, s[12:15], 0 offen lds
    v_mfma_f32_16x16x32_bf16 v[132:135], a[240:243], v[64:67], v[132:135]
    v_mfma_f32_16x16x32_bf16 v[132:135], a[244:247], v[68:71], v[132:135]
    ds_read_b64_tr_b16 a[232:233], v13 offset:256
    ds_read_b64_tr_b16 a[234:235], v13 offset:1280
    v_mfma_f32_16x16x32_bf16 v[164:167], a[240:243], v[72:75], v[164:167]
    ds_read_b64_tr_b16 a[236:237], v13 offset:8448
    ds_read_b64_tr_b16 a[238:239], v13 offset:9472
    v_mfma_f32_16x16x32_bf16 v[164:167], a[244:247], v[76:79], v[164:167]
    buffer_load_dwordx4 v3, s[12:15], s88 offen offset:1024 lds
    v_mfma_f32_16x16x32_bf16 v[196:199], a[240:243], v[80:83], v[196:199]
    v_mfma_f32_16x16x32_bf16 v[196:199], a[244:247], v[84:87], v[196:199]
    v_mfma_f32_16x16x32_bf16 v[228:231], a[240:243], v[88:91], v[228:231]
    v_mfma_f32_16x16x32_bf16 v[228:231], a[244:247], v[92:95], v[228:231]
    s_waitcnt lgkmcnt(0)
    buffer_load_dwordx4 v4, s[12:15], s89 offen offset:2048 lds
    v_mfma_f32_16x16x32_bf16 v[104:107], a[216:219], a[184:187], v[104:107]
    v_accvgpr_write_b32 a0, 0
    v_accvgpr_write_b32 a1, 0
    v_mfma_f32_16x16x32_bf16 v[104:107], a[220:223], a[188:191], v[104:107]
    ds_read_b64_tr_b16 a[240:241], v14 offset:256
    ds_read_b64_tr_b16 a[242:243], v14 offset:1280
    v_mfma_f32_16x16x32_bf16 v[136:139], a[216:219], a[192:195], v[136:139]
    ds_read_b64_tr_b16 a[244:245], v14 offset:8448
    ds_read_b64_tr_b16 a[246:247], v14 offset:9472
    v_mfma_f32_16x16x32_bf16 v[136:139], a[220:223], a[196:199], v[136:139]
    buffer_load_dwordx4 v4, s[12:15], s59 offen offset:3072 lds
    v_mfma_f32_16x16x32_bf16 v[168:171], a[216:219], a[200:203], v[168:171]
    v_accvgpr_write_b32 a2, 0
    v_accvgpr_write_b32 a3, 0
    v_mfma_f32_16x16x32_bf16 v[168:171], a[220:223], a[204:207], v[168:171]
    s_add_u32 s12, s12, 524288
    s_addc_u32 s13, s13, 0
    v_mfma_f32_16x16x32_bf16 v[200:203], a[216:219], a[208:211], v[200:203]
    s_add_u32 m0, s44, 53248
    v_accvgpr_write_b32 a4, 0
    v_mfma_f32_16x16x32_bf16 v[200:203], a[220:223], a[212:215], v[200:203]
    buffer_load_dwordx4 v2, s[8:11], 0 offen lds
    v_mfma_f32_16x16x32_bf16 v[232:235], a[216:219], a[248:251], v[232:235]
    v_accvgpr_write_b32 a5, 0
    v_accvgpr_write_b32 a6, 0
    v_mfma_f32_16x16x32_bf16 v[232:235], a[220:223], a[252:255], v[232:235]
    v_accvgpr_write_b32 a7, 0
    v_accvgpr_write_b32 a8, 0
    v_mfma_f32_16x16x32_bf16 v[108:111], a[224:227], a[184:187], v[108:111]
    v_accvgpr_write_b32 a9, 0
    v_accvgpr_write_b32 a10, 0
    v_mfma_f32_16x16x32_bf16 v[108:111], a[228:231], a[188:191], v[108:111]
    ds_read_b64_tr_b16 a[216:217], v15 offset:0
    ds_read_b64_tr_b16 a[218:219], v15 offset:1024
    v_mfma_f32_16x16x32_bf16 v[140:143], a[224:227], a[192:195], v[140:143]
    ds_read_b64_tr_b16 a[220:221], v15 offset:8192
    ds_read_b64_tr_b16 a[222:223], v15 offset:9216
    v_mfma_f32_16x16x32_bf16 v[140:143], a[228:231], a[196:199], v[140:143]
    buffer_load_dwordx4 v21, s[8:11], s48 offen offset:1024 lds
    v_mfma_f32_16x16x32_bf16 v[172:175], a[224:227], a[200:203], v[172:175]
    v_accvgpr_write_b32 a11, 0
    v_accvgpr_write_b32 a12, 0
    v_mfma_f32_16x16x32_bf16 v[172:175], a[228:231], a[204:207], v[172:175]
    v_accvgpr_write_b32 a13, 0
    v_accvgpr_write_b32 a14, 0
    v_mfma_f32_16x16x32_bf16 v[204:207], a[224:227], a[208:211], v[204:207]
    v_accvgpr_write_b32 a15, 0
    v_accvgpr_write_b32 a16, 0
    v_mfma_f32_16x16x32_bf16 v[204:207], a[228:231], a[212:215], v[204:207]
    buffer_load_dwordx4 v2, s[8:11], s49 offen offset:2048 lds
    v_mfma_f32_16x16x32_bf16 v[236:239], a[224:227], a[248:251], v[236:239]
    v_accvgpr_write_b32 a17, 0
    v_accvgpr_write_b32 a18, 0
    v_mfma_f32_16x16x32_bf16 v[236:239], a[228:231], a[252:255], v[236:239]
    v_accvgpr_write_b32 a19, 0
    v_accvgpr_write_b32 a20, 0
    v_mfma_f32_16x16x32_bf16 v[112:115], a[232:235], a[184:187], v[112:115]
    v_accvgpr_write_b32 a21, 0
    v_accvgpr_write_b32 a22, 0
    v_mfma_f32_16x16x32_bf16 v[112:115], a[236:239], a[188:191], v[112:115]
    ds_read_b64_tr_b16 a[224:225], v16 offset:0
    ds_read_b64_tr_b16 a[226:227], v16 offset:1024
    v_mfma_f32_16x16x32_bf16 v[144:147], a[232:235], a[192:195], v[144:147]
    ds_read_b64_tr_b16 a[228:229], v16 offset:8192
    ds_read_b64_tr_b16 a[230:231], v16 offset:9216
    v_mfma_f32_16x16x32_bf16 v[144:147], a[236:239], a[196:199], v[144:147]
    buffer_load_dwordx4 v21, s[8:11], s50 offen offset:3072 lds
    v_mfma_f32_16x16x32_bf16 v[176:179], a[232:235], a[200:203], v[176:179]
    v_accvgpr_write_b32 a23, 0
    v_accvgpr_write_b32 a24, 0
    v_mfma_f32_16x16x32_bf16 v[176:179], a[236:239], a[204:207], v[176:179]
    s_add_u32 m0, s44, 57344
    v_accvgpr_write_b32 a25, 0
    v_mfma_f32_16x16x32_bf16 v[208:211], a[232:235], a[208:211], v[208:211]
    buffer_load_dwordx4 v2, s[8:11], s51 offen lds
    v_mfma_f32_16x16x32_bf16 v[208:211], a[236:239], a[212:215], v[208:211]
    v_accvgpr_write_b32 a26, 0
    v_accvgpr_write_b32 a27, 0
    v_mfma_f32_16x16x32_bf16 v[240:243], a[232:235], a[248:251], v[240:243]
    v_accvgpr_write_b32 a28, 0
    v_accvgpr_write_b32 a29, 0
    v_mfma_f32_16x16x32_bf16 v[240:243], a[236:239], a[252:255], v[240:243]
    s_waitcnt lgkmcnt(0)
    v_accvgpr_write_b32 a30, 0
    v_mfma_f32_16x16x32_bf16 v[116:119], a[240:243], a[184:187], v[116:119]
    buffer_load_dwordx4 v21, s[8:11], s52 offen offset:1024 lds
    v_mfma_f32_16x16x32_bf16 v[116:119], a[244:247], a[188:191], v[116:119]
    ds_read_b64_tr_b16 a[232:233], v15 offset:256
    ds_read_b64_tr_b16 a[234:235], v15 offset:1280
    v_mfma_f32_16x16x32_bf16 v[148:151], a[240:243], a[192:195], v[148:151]
    ds_read_b64_tr_b16 a[236:237], v15 offset:8448
    ds_read_b64_tr_b16 a[238:239], v15 offset:9472
    v_mfma_f32_16x16x32_bf16 v[148:151], a[244:247], a[196:199], v[148:151]
    v_accvgpr_write_b32 a31, 0
    v_accvgpr_write_b32 a32, 0
    v_mfma_f32_16x16x32_bf16 v[180:183], a[240:243], a[200:203], v[180:183]
    buffer_load_dwordx4 v2, s[8:11], s53 offen offset:2048 lds
    v_mfma_f32_16x16x32_bf16 v[180:183], a[244:247], a[204:207], v[180:183]
    v_accvgpr_write_b32 a33, 0
    v_accvgpr_write_b32 a34, 0
    v_mfma_f32_16x16x32_bf16 v[212:215], a[240:243], a[208:211], v[212:215]
    v_accvgpr_write_b32 a35, 0
    v_accvgpr_write_b32 a36, 0
    v_mfma_f32_16x16x32_bf16 v[212:215], a[244:247], a[212:215], v[212:215]
    v_accvgpr_write_b32 a37, 0
    v_accvgpr_write_b32 a38, 0
    v_mfma_f32_16x16x32_bf16 v[244:247], a[240:243], a[248:251], v[244:247]
    buffer_load_dwordx4 v21, s[8:11], s86 offen offset:3072 lds
    v_mfma_f32_16x16x32_bf16 v[244:247], a[244:247], a[252:255], v[244:247]
    v_accvgpr_write_b32 a39, 0
    v_accvgpr_write_b32 a40, 0
    v_mfma_f32_16x16x32_bf16 v[120:123], a[216:219], a[184:187], v[120:123]
    s_add_u32 m0, s44, 61440
    v_accvgpr_write_b32 a41, 0
    v_mfma_f32_16x16x32_bf16 v[120:123], a[220:223], a[188:191], v[120:123]
    ds_read_b64_tr_b16 a[240:241], v16 offset:256
    ds_read_b64_tr_b16 a[242:243], v16 offset:1280
    v_mfma_f32_16x16x32_bf16 v[152:155], a[216:219], a[192:195], v[152:155]
    ds_read_b64_tr_b16 a[244:245], v16 offset:8448
    ds_read_b64_tr_b16 a[246:247], v16 offset:9472
    v_mfma_f32_16x16x32_bf16 v[152:155], a[220:223], a[196:199], v[152:155]
    buffer_load_dwordx4 v2, s[8:11], s87 offen lds
    v_mfma_f32_16x16x32_bf16 v[184:187], a[216:219], a[200:203], v[184:187]
    v_accvgpr_write_b32 a42, 0
    v_accvgpr_write_b32 a43, 0
    v_mfma_f32_16x16x32_bf16 v[184:187], a[220:223], a[204:207], v[184:187]
    s_add_u32 s8, s8, 128
    s_addc_u32 s9, s9, 0
    v_mfma_f32_16x16x32_bf16 v[216:219], a[216:219], a[208:211], v[216:219]
    v_accvgpr_write_b32 a44, 0
    v_accvgpr_write_b32 a45, 0
    v_mfma_f32_16x16x32_bf16 v[216:219], a[220:223], a[212:215], v[216:219]
    v_add_u32 v11, 0xfffe6000, v11
    v_add_u32 v13, 0xfffe6000, v13
    v_mfma_f32_16x16x32_bf16 v[124:127], a[224:227], a[184:187], v[124:127]
    v_add_u32 v14, 0xfffe6000, v14
    v_add_u32 v12, 0xfffe6000, v12
    v_mfma_f32_16x16x32_bf16 v[124:127], a[228:231], a[188:191], v[124:127]
    v_add_u32 v15, 0xfffe6000, v15
    v_add_u32 v16, 0xfffe6000, v16
    v_mfma_f32_16x16x32_bf16 v[156:159], a[224:227], a[192:195], v[156:159]
    v_accvgpr_write_b32 a46, 0
    v_accvgpr_write_b32 a47, 0
    v_mfma_f32_16x16x32_bf16 v[156:159], a[228:231], a[196:199], v[156:159]
    v_accvgpr_write_b32 a48, 0
    v_accvgpr_write_b32 a49, 0
    v_mfma_f32_16x16x32_bf16 v[188:191], a[224:227], a[200:203], v[188:191]
    s_waitcnt vmcnt(13) lgkmcnt(0)
    s_barrier
    v_mfma_f32_16x16x32_bf16 v[188:191], a[228:231], a[204:207], v[188:191]
    ds_read_b128 v[64:67], v11 offset:0
    ds_read_b128 v[68:71], v11 offset:512
    v_mfma_f32_16x16x32_bf16 v[220:223], a[224:227], a[208:211], v[220:223]
    ds_read_b64_tr_b16 a[216:217], v13 offset:0
    ds_read_b64_tr_b16 a[218:219], v13 offset:1024
    v_mfma_f32_16x16x32_bf16 v[220:223], a[228:231], a[212:215], v[220:223]
    ds_read_b64_tr_b16 a[220:221], v13 offset:8192
    ds_read_b64_tr_b16 a[222:223], v13 offset:9216
    v_mfma_f32_16x16x32_bf16 v[128:131], a[232:235], a[184:187], v[128:131]
    ds_read_b128 v[72:75], v11 offset:2048
    ds_read_b128 v[76:79], v11 offset:2560
    v_mfma_f32_16x16x32_bf16 v[128:131], a[236:239], a[188:191], v[128:131]
    ds_read_b128 v[80:83], v11 offset:4096
    ds_read_b128 v[84:87], v11 offset:4608
    v_mfma_f32_16x16x32_bf16 v[160:163], a[232:235], a[192:195], v[160:163]
    ds_read_b128 v[88:91], v11 offset:6144
    ds_read_b128 v[92:95], v11 offset:6656
    v_mfma_f32_16x16x32_bf16 v[160:163], a[236:239], a[196:199], v[160:163]
    ds_read_b128 v[96:99], v12 offset:0
    ds_read_b128 v[100:103], v12 offset:512
    v_mfma_f32_16x16x32_bf16 v[192:195], a[232:235], a[200:203], v[192:195]
    ds_read_b64_tr_b16 a[224:225], v14 offset:0
    ds_read_b64_tr_b16 a[226:227], v14 offset:1024
    v_mfma_f32_16x16x32_bf16 v[192:195], a[236:239], a[204:207], v[192:195]
    ds_read_b64_tr_b16 a[228:229], v14 offset:8192
    ds_read_b64_tr_b16 a[230:231], v14 offset:9216
    v_mfma_f32_16x16x32_bf16 v[224:227], a[232:235], a[208:211], v[224:227]
    s_add_u32 m0, s39, 143360
    v_accvgpr_write_b32 a50, 0
    v_mfma_f32_16x16x32_bf16 v[224:227], a[236:239], a[212:215], v[224:227]
    buffer_load_dwordx4 v3, s[12:15], 0 offen lds
    v_mfma_f32_16x16x32_bf16 v[132:135], a[240:243], a[184:187], v[132:135]
    v_accvgpr_write_b32 a51, 0
    v_accvgpr_write_b32 a52, 0
    v_mfma_f32_16x16x32_bf16 v[132:135], a[244:247], a[188:191], v[132:135]
    ds_read_b64_tr_b16 a[232:233], v13 offset:256
    ds_read_b64_tr_b16 a[234:235], v13 offset:1280
    v_mfma_f32_16x16x32_bf16 v[164:167], a[240:243], a[192:195], v[164:167]
    ds_read_b64_tr_b16 a[236:237], v13 offset:8448
    ds_read_b64_tr_b16 a[238:239], v13 offset:9472
    v_mfma_f32_16x16x32_bf16 v[164:167], a[244:247], a[196:199], v[164:167]
    buffer_load_dwordx4 v3, s[12:15], s88 offen offset:1024 lds
    v_mfma_f32_16x16x32_bf16 v[196:199], a[240:243], a[200:203], v[196:199]
    v_accvgpr_write_b32 a53, 0
    v_accvgpr_write_b32 a54, 0
    v_mfma_f32_16x16x32_bf16 v[196:199], a[244:247], a[204:207], v[196:199]
    v_accvgpr_write_b32 a55, 0
    v_accvgpr_write_b32 a56, 0
    v_mfma_f32_16x16x32_bf16 v[228:231], a[240:243], a[208:211], v[228:231]
    v_accvgpr_write_b32 a57, 0
    v_accvgpr_write_b32 a58, 0
    v_mfma_f32_16x16x32_bf16 v[228:231], a[244:247], a[212:215], v[228:231]
    s_waitcnt lgkmcnt(0)
    buffer_load_dwordx4 v4, s[12:15], s89 offen offset:2048 lds
    v_mfma_f32_16x16x32_bf16 v[104:107], a[216:219], v[64:67], v[104:107]
    v_accvgpr_write_b32 a59, 0
    v_accvgpr_write_b32 a60, 0
    v_mfma_f32_16x16x32_bf16 v[104:107], a[220:223], v[68:71], v[104:107]
    ds_read_b64_tr_b16 a[240:241], v14 offset:256
    ds_read_b64_tr_b16 a[242:243], v14 offset:1280
    v_mfma_f32_16x16x32_bf16 v[136:139], a[216:219], v[72:75], v[136:139]
    ds_read_b64_tr_b16 a[244:245], v14 offset:8448
    ds_read_b64_tr_b16 a[246:247], v14 offset:9472
    v_mfma_f32_16x16x32_bf16 v[136:139], a[220:223], v[76:79], v[136:139]
    buffer_load_dwordx4 v4, s[12:15], s59 offen offset:3072 lds
    v_mfma_f32_16x16x32_bf16 v[168:171], a[216:219], v[80:83], v[168:171]
    v_accvgpr_write_b32 a61, 0
    v_accvgpr_write_b32 a62, 0
    v_mfma_f32_16x16x32_bf16 v[168:171], a[220:223], v[84:87], v[168:171]
    s_add_u32 s12, s12, 524288
    s_addc_u32 s13, s13, 0
    v_mfma_f32_16x16x32_bf16 v[200:203], a[216:219], v[88:91], v[200:203]
    s_add_u32 m0, s44, 106496
    v_accvgpr_write_b32 a63, 0
    v_mfma_f32_16x16x32_bf16 v[200:203], a[220:223], v[92:95], v[200:203]
    buffer_load_dwordx4 v2, s[8:11], 0 offen lds
    v_mfma_f32_16x16x32_bf16 v[232:235], a[216:219], v[96:99], v[232:235]
    v_accvgpr_write_b32 a64, 0
    v_accvgpr_write_b32 a65, 0
    v_mfma_f32_16x16x32_bf16 v[232:235], a[220:223], v[100:103], v[232:235]
    v_accvgpr_write_b32 a66, 0
    v_accvgpr_write_b32 a67, 0
    v_mfma_f32_16x16x32_bf16 v[108:111], a[224:227], v[64:67], v[108:111]
    v_accvgpr_write_b32 a68, 0
    v_accvgpr_write_b32 a69, 0
    v_mfma_f32_16x16x32_bf16 v[108:111], a[228:231], v[68:71], v[108:111]
    ds_read_b64_tr_b16 a[216:217], v15 offset:0
    ds_read_b64_tr_b16 a[218:219], v15 offset:1024
    v_mfma_f32_16x16x32_bf16 v[140:143], a[224:227], v[72:75], v[140:143]
    ds_read_b64_tr_b16 a[220:221], v15 offset:8192
    ds_read_b64_tr_b16 a[222:223], v15 offset:9216
    v_mfma_f32_16x16x32_bf16 v[140:143], a[228:231], v[76:79], v[140:143]
    buffer_load_dwordx4 v21, s[8:11], s48 offen offset:1024 lds
    v_mfma_f32_16x16x32_bf16 v[172:175], a[224:227], v[80:83], v[172:175]
    v_accvgpr_write_b32 a70, 0
    v_accvgpr_write_b32 a71, 0
    v_mfma_f32_16x16x32_bf16 v[172:175], a[228:231], v[84:87], v[172:175]
    v_accvgpr_write_b32 a72, 0
    v_accvgpr_write_b32 a73, 0
    v_mfma_f32_16x16x32_bf16 v[204:207], a[224:227], v[88:91], v[204:207]
    v_accvgpr_write_b32 a74, 0
    v_accvgpr_write_b32 a75, 0
    v_mfma_f32_16x16x32_bf16 v[204:207], a[228:231], v[92:95], v[204:207]
    buffer_load_dwordx4 v2, s[8:11], s49 offen offset:2048 lds
    v_mfma_f32_16x16x32_bf16 v[236:239], a[224:227], v[96:99], v[236:239]
    v_accvgpr_write_b32 a76, 0
    v_accvgpr_write_b32 a77, 0
    v_mfma_f32_16x16x32_bf16 v[236:239], a[228:231], v[100:103], v[236:239]
    v_accvgpr_write_b32 a78, 0
    v_accvgpr_write_b32 a79, 0
    v_mfma_f32_16x16x32_bf16 v[112:115], a[232:235], v[64:67], v[112:115]
    v_accvgpr_write_b32 a80, 0
    v_accvgpr_write_b32 a81, 0
    v_mfma_f32_16x16x32_bf16 v[112:115], a[236:239], v[68:71], v[112:115]
    ds_read_b64_tr_b16 a[224:225], v16 offset:0
    ds_read_b64_tr_b16 a[226:227], v16 offset:1024
    v_mfma_f32_16x16x32_bf16 v[144:147], a[232:235], v[72:75], v[144:147]
    ds_read_b64_tr_b16 a[228:229], v16 offset:8192
    ds_read_b64_tr_b16 a[230:231], v16 offset:9216
    v_mfma_f32_16x16x32_bf16 v[144:147], a[236:239], v[76:79], v[144:147]
    buffer_load_dwordx4 v21, s[8:11], s50 offen offset:3072 lds
    v_mfma_f32_16x16x32_bf16 v[176:179], a[232:235], v[80:83], v[176:179]
    v_accvgpr_write_b32 a82, 0
    v_accvgpr_write_b32 a83, 0
    v_mfma_f32_16x16x32_bf16 v[176:179], a[236:239], v[84:87], v[176:179]
    s_add_u32 m0, s44, 110592
    v_accvgpr_write_b32 a84, 0
    v_mfma_f32_16x16x32_bf16 v[208:211], a[232:235], v[88:91], v[208:211]
    buffer_load_dwordx4 v2, s[8:11], s51 offen lds
    v_mfma_f32_16x16x32_bf16 v[208:211], a[236:239], v[92:95], v[208:211]
    v_accvgpr_write_b32 a85, 0
    v_accvgpr_write_b32 a86, 0
    v_mfma_f32_16x16x32_bf16 v[240:243], a[232:235], v[96:99], v[240:243]
    v_accvgpr_write_b32 a87, 0
    v_accvgpr_write_b32 a88, 0
    v_mfma_f32_16x16x32_bf16 v[240:243], a[236:239], v[100:103], v[240:243]
    s_waitcnt lgkmcnt(0)
    v_accvgpr_write_b32 a89, 0
    v_mfma_f32_16x16x32_bf16 v[116:119], a[240:243], v[64:67], v[116:119]
    buffer_load_dwordx4 v21, s[8:11], s52 offen offset:1024 lds
    v_mfma_f32_16x16x32_bf16 v[116:119], a[244:247], v[68:71], v[116:119]
    ds_read_b64_tr_b16 a[232:233], v15 offset:256
    ds_read_b64_tr_b16 a[234:235], v15 offset:1280
    v_mfma_f32_16x16x32_bf16 v[148:151], a[240:243], v[72:75], v[148:151]
    ds_read_b64_tr_b16 a[236:237], v15 offset:8448
    ds_read_b64_tr_b16 a[238:239], v15 offset:9472
    v_mfma_f32_16x16x32_bf16 v[148:151], a[244:247], v[76:79], v[148:151]
    v_accvgpr_write_b32 a90, 0
    v_accvgpr_write_b32 a91, 0
    v_mfma_f32_16x16x32_bf16 v[180:183], a[240:243], v[80:83], v[180:183]
    buffer_load_dwordx4 v2, s[8:11], s53 offen offset:2048 lds
    v_mfma_f32_16x16x32_bf16 v[180:183], a[244:247], v[84:87], v[180:183]
    v_accvgpr_write_b32 a92, 0
    v_accvgpr_write_b32 a93, 0
    v_mfma_f32_16x16x32_bf16 v[212:215], a[240:243], v[88:91], v[212:215]
    v_accvgpr_write_b32 a94, 0
    v_accvgpr_write_b32 a95, 0
    v_mfma_f32_16x16x32_bf16 v[212:215], a[244:247], v[92:95], v[212:215]
    v_accvgpr_write_b32 a96, 0
    v_accvgpr_write_b32 a97, 0
    v_mfma_f32_16x16x32_bf16 v[244:247], a[240:243], v[96:99], v[244:247]
    buffer_load_dwordx4 v21, s[8:11], s86 offen offset:3072 lds
    v_mfma_f32_16x16x32_bf16 v[244:247], a[244:247], v[100:103], v[244:247]
    v_accvgpr_write_b32 a98, 0
    v_accvgpr_write_b32 a99, 0
    v_mfma_f32_16x16x32_bf16 v[120:123], a[216:219], v[64:67], v[120:123]
    s_add_u32 m0, s44, 114688
    v_accvgpr_write_b32 a100, 0
    v_mfma_f32_16x16x32_bf16 v[120:123], a[220:223], v[68:71], v[120:123]
    ds_read_b64_tr_b16 a[240:241], v16 offset:256
    ds_read_b64_tr_b16 a[242:243], v16 offset:1280
    v_mfma_f32_16x16x32_bf16 v[152:155], a[216:219], v[72:75], v[152:155]
    ds_read_b64_tr_b16 a[244:245], v16 offset:8448
    ds_read_b64_tr_b16 a[246:247], v16 offset:9472
    v_mfma_f32_16x16x32_bf16 v[152:155], a[220:223], v[76:79], v[152:155]
    buffer_load_dwordx4 v2, s[8:11], s87 offen lds
    v_mfma_f32_16x16x32_bf16 v[184:187], a[216:219], v[80:83], v[184:187]
    v_accvgpr_write_b32 a101, 0
    v_accvgpr_write_b32 a102, 0
    v_mfma_f32_16x16x32_bf16 v[184:187], a[220:223], v[84:87], v[184:187]
    s_add_u32 s8, s8, 128
    s_addc_u32 s9, s9, 0
    v_mfma_f32_16x16x32_bf16 v[216:219], a[216:219], v[88:91], v[216:219]
    v_accvgpr_write_b32 a103, 0
    v_accvgpr_write_b32 a104, 0
    v_mfma_f32_16x16x32_bf16 v[216:219], a[220:223], v[92:95], v[216:219]
    v_add_u32 v11, 0xd000, v11
    v_add_u32 v13, 0xd000, v13
    v_mfma_f32_16x16x32_bf16 v[124:127], a[224:227], v[64:67], v[124:127]
    v_add_u32 v14, 0xd000, v14
    v_add_u32 v12, 0xd000, v12
    v_mfma_f32_16x16x32_bf16 v[124:127], a[228:231], v[68:71], v[124:127]
    v_add_u32 v15, 0xd000, v15
    v_add_u32 v16, 0xd000, v16
    v_mfma_f32_16x16x32_bf16 v[156:159], a[224:227], v[72:75], v[156:159]
    v_accvgpr_write_b32 a105, 0
    v_accvgpr_write_b32 a106, 0
    v_mfma_f32_16x16x32_bf16 v[156:159], a[228:231], v[76:79], v[156:159]
    v_accvgpr_write_b32 a107, 0
    v_accvgpr_write_b32 a108, 0
    v_mfma_f32_16x16x32_bf16 v[188:191], a[224:227], v[80:83], v[188:191]
    s_waitcnt vmcnt(13) lgkmcnt(0)
    s_barrier
    v_mfma_f32_16x16x32_bf16 v[188:191], a[228:231], v[84:87], v[188:191]
    ds_read_b128 a[184:187], v11 offset:0
    ds_read_b128 a[188:191], v11 offset:512
    v_mfma_f32_16x16x32_bf16 v[220:223], a[224:227], v[88:91], v[220:223]
    ds_read_b64_tr_b16 a[216:217], v13 offset:0
    ds_read_b64_tr_b16 a[218:219], v13 offset:1024
    v_mfma_f32_16x16x32_bf16 v[220:223], a[228:231], v[92:95], v[220:223]
    ds_read_b64_tr_b16 a[220:221], v13 offset:8192
    ds_read_b64_tr_b16 a[222:223], v13 offset:9216
    v_mfma_f32_16x16x32_bf16 v[128:131], a[232:235], v[64:67], v[128:131]
    ds_read_b128 a[192:195], v11 offset:2048
    ds_read_b128 a[196:199], v11 offset:2560
    v_mfma_f32_16x16x32_bf16 v[128:131], a[236:239], v[68:71], v[128:131]
    ds_read_b128 a[200:203], v11 offset:4096
    ds_read_b128 a[204:207], v11 offset:4608
    v_mfma_f32_16x16x32_bf16 v[160:163], a[232:235], v[72:75], v[160:163]
    ds_read_b128 a[208:211], v11 offset:6144
    ds_read_b128 a[212:215], v11 offset:6656
    v_mfma_f32_16x16x32_bf16 v[160:163], a[236:239], v[76:79], v[160:163]
    ds_read_b128 a[248:251], v12 offset:0
    ds_read_b128 a[252:255], v12 offset:512
    v_mfma_f32_16x16x32_bf16 v[192:195], a[232:235], v[80:83], v[192:195]
    ds_read_b64_tr_b16 a[224:225], v14 offset:0
    ds_read_b64_tr_b16 a[226:227], v14 offset:1024
    v_mfma_f32_16x16x32_bf16 v[192:195], a[236:239], v[84:87], v[192:195]
    ds_read_b64_tr_b16 a[228:229], v14 offset:8192
    ds_read_b64_tr_b16 a[230:231], v14 offset:9216
    v_mfma_f32_16x16x32_bf16 v[224:227], a[232:235], v[88:91], v[224:227]
    s_add_u32 m0, s39, 36864
    v_accvgpr_write_b32 a109, 0
    v_mfma_f32_16x16x32_bf16 v[224:227], a[236:239], v[92:95], v[224:227]
    buffer_load_dwordx4 v3, s[12:15], 0 offen lds
    v_mfma_f32_16x16x32_bf16 v[132:135], a[240:243], v[64:67], v[132:135]
    v_accvgpr_write_b32 a110, 0
    v_accvgpr_write_b32 a111, 0
    v_mfma_f32_16x16x32_bf16 v[132:135], a[244:247], v[68:71], v[132:135]
    ds_read_b64_tr_b16 a[232:233], v13 offset:256
    ds_read_b64_tr_b16 a[234:235], v13 offset:1280
    v_mfma_f32_16x16x32_bf16 v[164:167], a[240:243], v[72:75], v[164:167]
    ds_read_b64_tr_b16 a[236:237], v13 offset:8448
    ds_read_b64_tr_b16 a[238:239], v13 offset:9472
    v_mfma_f32_16x16x32_bf16 v[164:167], a[244:247], v[76:79], v[164:167]
    buffer_load_dwordx4 v3, s[12:15], s88 offen offset:1024 lds
    v_mfma_f32_16x16x32_bf16 v[196:199], a[240:243], v[80:83], v[196:199]
    v_accvgpr_write_b32 a112, 0
    v_accvgpr_write_b32 a113, 0
    v_mfma_f32_16x16x32_bf16 v[196:199], a[244:247], v[84:87], v[196:199]
    v_accvgpr_write_b32 a114, 0
    v_accvgpr_write_b32 a115, 0
    v_mfma_f32_16x16x32_bf16 v[228:231], a[240:243], v[88:91], v[228:231]
    v_accvgpr_write_b32 a116, 0
    v_accvgpr_write_b32 a117, 0
    v_mfma_f32_16x16x32_bf16 v[228:231], a[244:247], v[92:95], v[228:231]
    s_waitcnt lgkmcnt(0)
    buffer_load_dwordx4 v4, s[12:15], s89 offen offset:2048 lds
    v_mfma_f32_16x16x32_bf16 v[104:107], a[216:219], a[184:187], v[104:107]
    v_accvgpr_write_b32 a118, 0
    v_accvgpr_write_b32 a119, 0
    v_mfma_f32_16x16x32_bf16 v[104:107], a[220:223], a[188:191], v[104:107]
    ds_read_b64_tr_b16 a[240:241], v14 offset:256
    ds_read_b64_tr_b16 a[242:243], v14 offset:1280
    v_mfma_f32_16x16x32_bf16 v[136:139], a[216:219], a[192:195], v[136:139]
    ds_read_b64_tr_b16 a[244:245], v14 offset:8448
    ds_read_b64_tr_b16 a[246:247], v14 offset:9472
    v_mfma_f32_16x16x32_bf16 v[136:139], a[220:223], a[196:199], v[136:139]
    buffer_load_dwordx4 v4, s[12:15], s59 offen offset:3072 lds
    v_mfma_f32_16x16x32_bf16 v[168:171], a[216:219], a[200:203], v[168:171]
    v_accvgpr_write_b32 a120, 0
    v_accvgpr_write_b32 a121, 0
    v_mfma_f32_16x16x32_bf16 v[168:171], a[220:223], a[204:207], v[168:171]
    s_add_u32 s12, s12, 524288
    s_addc_u32 s13, s13, 0
    v_mfma_f32_16x16x32_bf16 v[200:203], a[216:219], a[208:211], v[200:203]
    s_add_u32 m0, s44, 0
    v_accvgpr_write_b32 a122, 0
    v_mfma_f32_16x16x32_bf16 v[200:203], a[220:223], a[212:215], v[200:203]
    buffer_load_dwordx4 v2, s[8:11], 0 offen lds
    v_mfma_f32_16x16x32_bf16 v[232:235], a[216:219], a[248:251], v[232:235]
    v_accvgpr_write_b32 a123, 0
    v_accvgpr_write_b32 a124, 0
    v_mfma_f32_16x16x32_bf16 v[232:235], a[220:223], a[252:255], v[232:235]
    v_accvgpr_write_b32 a125, 0
    v_accvgpr_write_b32 a126, 0
    v_mfma_f32_16x16x32_bf16 v[108:111], a[224:227], a[184:187], v[108:111]
    v_accvgpr_write_b32 a127, 0
    v_accvgpr_write_b32 a128, 0
    v_mfma_f32_16x16x32_bf16 v[108:111], a[228:231], a[188:191], v[108:111]
    ds_read_b64_tr_b16 a[216:217], v15 offset:0
    ds_read_b64_tr_b16 a[218:219], v15 offset:1024
    v_mfma_f32_16x16x32_bf16 v[140:143], a[224:227], a[192:195], v[140:143]
    ds_read_b64_tr_b16 a[220:221], v15 offset:8192
    ds_read_b64_tr_b16 a[222:223], v15 offset:9216
    v_mfma_f32_16x16x32_bf16 v[140:143], a[228:231], a[196:199], v[140:143]
    buffer_load_dwordx4 v21, s[8:11], s48 offen offset:1024 lds
    v_mfma_f32_16x16x32_bf16 v[172:175], a[224:227], a[200:203], v[172:175]
    v_accvgpr_write_b32 a129, 0
    v_accvgpr_write_b32 a130, 0
    v_mfma_f32_16x16x32_bf16 v[172:175], a[228:231], a[204:207], v[172:175]
    v_accvgpr_write_b32 a131, 0
    v_accvgpr_write_b32 a132, 0
    v_mfma_f32_16x16x32_bf16 v[204:207], a[224:227], a[208:211], v[204:207]
    v_accvgpr_write_b32 a133, 0
    v_accvgpr_write_b32 a134, 0
    v_mfma_f32_16x16x32_bf16 v[204:207], a[228:231], a[212:215], v[204:207]
    buffer_load_dwordx4 v2, s[8:11], s49 offen offset:2048 lds
    v_mfma_f32_16x16x32_bf16 v[236:239], a[224:227], a[248:251], v[236:239]
    v_accvgpr_write_b32 a135, 0
    v_accvgpr_write_b32 a136, 0
    v_mfma_f32_16x16x32_bf16 v[236:239], a[228:231], a[252:255], v[236:239]
    v_accvgpr_write_b32 a137, 0
    v_accvgpr_write_b32 a138, 0
    v_mfma_f32_16x16x32_bf16 v[112:115], a[232:235], a[184:187], v[112:115]
    v_accvgpr_write_b32 a139, 0
    v_accvgpr_write_b32 a140, 0
    v_mfma_f32_16x16x32_bf16 v[112:115], a[236:239], a[188:191], v[112:115]
    ds_read_b64_tr_b16 a[224:225], v16 offset:0
    ds_read_b64_tr_b16 a[226:227], v16 offset:1024
    v_mfma_f32_16x16x32_bf16 v[144:147], a[232:235], a[192:195], v[144:147]
    ds_read_b64_tr_b16 a[228:229], v16 offset:8192
    ds_read_b64_tr_b16 a[230:231], v16 offset:9216
    v_mfma_f32_16x16x32_bf16 v[144:147], a[236:239], a[196:199], v[144:147]
    buffer_load_dwordx4 v21, s[8:11], s50 offen offset:3072 lds
    v_mfma_f32_16x16x32_bf16 v[176:179], a[232:235], a[200:203], v[176:179]
    v_accvgpr_write_b32 a141, 0
    v_accvgpr_write_b32 a142, 0
    v_mfma_f32_16x16x32_bf16 v[176:179], a[236:239], a[204:207], v[176:179]
    s_add_u32 m0, s44, 4096
    v_accvgpr_write_b32 a143, 0
    v_mfma_f32_16x16x32_bf16 v[208:211], a[232:235], a[208:211], v[208:211]
    buffer_load_dwordx4 v2, s[8:11], s51 offen lds
    v_mfma_f32_16x16x32_bf16 v[208:211], a[236:239], a[212:215], v[208:211]
    v_accvgpr_write_b32 a144, 0
    v_accvgpr_write_b32 a145, 0
    v_mfma_f32_16x16x32_bf16 v[240:243], a[232:235], a[248:251], v[240:243]
    v_accvgpr_write_b32 a146, 0
    v_accvgpr_write_b32 a147, 0
    v_mfma_f32_16x16x32_bf16 v[240:243], a[236:239], a[252:255], v[240:243]
    s_waitcnt lgkmcnt(0)
    v_accvgpr_write_b32 a148, 0
    v_mfma_f32_16x16x32_bf16 v[116:119], a[240:243], a[184:187], v[116:119]
    buffer_load_dwordx4 v21, s[8:11], s52 offen offset:1024 lds
    v_mfma_f32_16x16x32_bf16 v[116:119], a[244:247], a[188:191], v[116:119]
    ds_read_b64_tr_b16 a[232:233], v15 offset:256
    ds_read_b64_tr_b16 a[234:235], v15 offset:1280
    v_mfma_f32_16x16x32_bf16 v[148:151], a[240:243], a[192:195], v[148:151]
    ds_read_b64_tr_b16 a[236:237], v15 offset:8448
    ds_read_b64_tr_b16 a[238:239], v15 offset:9472
    v_mfma_f32_16x16x32_bf16 v[148:151], a[244:247], a[196:199], v[148:151]
    v_accvgpr_write_b32 a149, 0
    v_accvgpr_write_b32 a150, 0
    v_mfma_f32_16x16x32_bf16 v[180:183], a[240:243], a[200:203], v[180:183]
    buffer_load_dwordx4 v2, s[8:11], s53 offen offset:2048 lds
    v_mfma_f32_16x16x32_bf16 v[180:183], a[244:247], a[204:207], v[180:183]
    v_accvgpr_write_b32 a151, 0
    v_accvgpr_write_b32 a152, 0
    v_mfma_f32_16x16x32_bf16 v[212:215], a[240:243], a[208:211], v[212:215]
    v_accvgpr_write_b32 a153, 0
    v_accvgpr_write_b32 a154, 0
    v_mfma_f32_16x16x32_bf16 v[212:215], a[244:247], a[212:215], v[212:215]
    v_accvgpr_write_b32 a155, 0
    v_accvgpr_write_b32 a156, 0
    v_mfma_f32_16x16x32_bf16 v[244:247], a[240:243], a[248:251], v[244:247]
    buffer_load_dwordx4 v21, s[8:11], s86 offen offset:3072 lds
    v_mfma_f32_16x16x32_bf16 v[244:247], a[244:247], a[252:255], v[244:247]
    v_accvgpr_write_b32 a157, 0
    v_accvgpr_write_b32 a158, 0
    v_mfma_f32_16x16x32_bf16 v[120:123], a[216:219], a[184:187], v[120:123]
    s_add_u32 m0, s44, 8192
    v_accvgpr_write_b32 a159, 0
    v_mfma_f32_16x16x32_bf16 v[120:123], a[220:223], a[188:191], v[120:123]
    ds_read_b64_tr_b16 a[240:241], v16 offset:256
    ds_read_b64_tr_b16 a[242:243], v16 offset:1280
    v_mfma_f32_16x16x32_bf16 v[152:155], a[216:219], a[192:195], v[152:155]
    ds_read_b64_tr_b16 a[244:245], v16 offset:8448
    ds_read_b64_tr_b16 a[246:247], v16 offset:9472
    v_mfma_f32_16x16x32_bf16 v[152:155], a[220:223], a[196:199], v[152:155]
    buffer_load_dwordx4 v2, s[8:11], s87 offen lds
    v_mfma_f32_16x16x32_bf16 v[184:187], a[216:219], a[200:203], v[184:187]
    v_accvgpr_write_b32 a160, 0
    v_accvgpr_write_b32 a161, 0
    v_mfma_f32_16x16x32_bf16 v[184:187], a[220:223], a[204:207], v[184:187]
    s_add_u32 s8, s8, 128
    s_addc_u32 s9, s9, 0
    v_mfma_f32_16x16x32_bf16 v[216:219], a[216:219], a[208:211], v[216:219]
    v_accvgpr_write_b32 a162, 0
    v_accvgpr_write_b32 a163, 0
    v_mfma_f32_16x16x32_bf16 v[216:219], a[220:223], a[212:215], v[216:219]
    v_add_u32 v11, 0xd000, v11
    v_add_u32 v13, 0xd000, v13
    v_mfma_f32_16x16x32_bf16 v[124:127], a[224:227], a[184:187], v[124:127]
    v_add_u32 v14, 0xd000, v14
    v_add_u32 v12, 0xd000, v12
    v_mfma_f32_16x16x32_bf16 v[124:127], a[228:231], a[188:191], v[124:127]
    v_add_u32 v15, 0xd000, v15
    v_add_u32 v16, 0xd000, v16
    v_mfma_f32_16x16x32_bf16 v[156:159], a[224:227], a[192:195], v[156:159]
    v_accvgpr_write_b32 a164, 0
    v_accvgpr_write_b32 a165, 0
    v_mfma_f32_16x16x32_bf16 v[156:159], a[228:231], a[196:199], v[156:159]
    v_accvgpr_write_b32 a166, 0
    v_accvgpr_write_b32 a167, 0
    v_mfma_f32_16x16x32_bf16 v[188:191], a[224:227], a[200:203], v[188:191]
    s_waitcnt vmcnt(13) lgkmcnt(0)
    s_barrier
    v_mfma_f32_16x16x32_bf16 v[188:191], a[228:231], a[204:207], v[188:191]
    ds_read_b128 v[64:67], v11 offset:0
    ds_read_b128 v[68:71], v11 offset:512
    v_mfma_f32_16x16x32_bf16 v[220:223], a[224:227], a[208:211], v[220:223]
    ds_read_b64_tr_b16 a[216:217], v13 offset:0
    ds_read_b64_tr_b16 a[218:219], v13 offset:1024
    v_mfma_f32_16x16x32_bf16 v[220:223], a[228:231], a[212:215], v[220:223]
    ds_read_b64_tr_b16 a[220:221], v13 offset:8192
    ds_read_b64_tr_b16 a[222:223], v13 offset:9216
    v_mfma_f32_16x16x32_bf16 v[128:131], a[232:235], a[184:187], v[128:131]
    ds_read_b128 v[72:75], v11 offset:2048
    ds_read_b128 v[76:79], v11 offset:2560
    v_mfma_f32_16x16x32_bf16 v[128:131], a[236:239], a[188:191], v[128:131]
    ds_read_b128 v[80:83], v11 offset:4096
    ds_read_b128 v[84:87], v11 offset:4608
    v_mfma_f32_16x16x32_bf16 v[160:163], a[232:235], a[192:195], v[160:163]
    ds_read_b128 v[88:91], v11 offset:6144
    ds_read_b128 v[92:95], v11 offset:6656
    v_mfma_f32_16x16x32_bf16 v[160:163], a[236:239], a[196:199], v[160:163]
    ds_read_b128 v[96:99], v12 offset:0
    ds_read_b128 v[100:103], v12 offset:512
    v_mfma_f32_16x16x32_bf16 v[192:195], a[232:235], a[200:203], v[192:195]
    ds_read_b64_tr_b16 a[224:225], v14 offset:0
    ds_read_b64_tr_b16 a[226:227], v14 offset:1024
    v_mfma_f32_16x16x32_bf16 v[192:195], a[236:239], a[204:207], v[192:195]
    ds_read_b64_tr_b16 a[228:229], v14 offset:8192
    ds_read_b64_tr_b16 a[230:231], v14 offset:9216
    v_mfma_f32_16x16x32_bf16 v[224:227], a[232:235], a[208:211], v[224:227]
    s_add_u32 m0, s39, 90112
    v_accvgpr_write_b32 a168, 0
    v_mfma_f32_16x16x32_bf16 v[224:227], a[236:239], a[212:215], v[224:227]
    buffer_load_dwordx4 v3, s[12:15], 0 offen lds
    v_mfma_f32_16x16x32_bf16 v[132:135], a[240:243], a[184:187], v[132:135]
    v_accvgpr_write_b32 a169, 0
    v_accvgpr_write_b32 a170, 0
    v_mfma_f32_16x16x32_bf16 v[132:135], a[244:247], a[188:191], v[132:135]
    ds_read_b64_tr_b16 a[232:233], v13 offset:256
    ds_read_b64_tr_b16 a[234:235], v13 offset:1280
    v_mfma_f32_16x16x32_bf16 v[164:167], a[240:243], a[192:195], v[164:167]
    ds_read_b64_tr_b16 a[236:237], v13 offset:8448
    ds_read_b64_tr_b16 a[238:239], v13 offset:9472
    v_mfma_f32_16x16x32_bf16 v[164:167], a[244:247], a[196:199], v[164:167]
    buffer_load_dwordx4 v3, s[12:15], s88 offen offset:1024 lds
    v_mfma_f32_16x16x32_bf16 v[196:199], a[240:243], a[200:203], v[196:199]
    v_accvgpr_write_b32 a171, 0
    v_accvgpr_write_b32 a172, 0
    v_mfma_f32_16x16x32_bf16 v[196:199], a[244:247], a[204:207], v[196:199]
    v_accvgpr_write_b32 a173, 0
    v_accvgpr_write_b32 a174, 0
    v_mfma_f32_16x16x32_bf16 v[228:231], a[240:243], a[208:211], v[228:231]
    v_accvgpr_write_b32 a175, 0
    v_accvgpr_write_b32 a176, 0
    v_mfma_f32_16x16x32_bf16 v[228:231], a[244:247], a[212:215], v[228:231]
    s_waitcnt lgkmcnt(0)
    buffer_load_dwordx4 v4, s[12:15], s89 offen offset:2048 lds
    v_mfma_f32_16x16x32_bf16 v[104:107], a[216:219], v[64:67], v[104:107]
    v_accvgpr_write_b32 a177, 0
    v_accvgpr_write_b32 a178, 0
    v_mfma_f32_16x16x32_bf16 v[104:107], a[220:223], v[68:71], v[104:107]
    ds_read_b64_tr_b16 a[240:241], v14 offset:256
    ds_read_b64_tr_b16 a[242:243], v14 offset:1280
    v_mfma_f32_16x16x32_bf16 v[136:139], a[216:219], v[72:75], v[136:139]
    ds_read_b64_tr_b16 a[244:245], v14 offset:8448
    ds_read_b64_tr_b16 a[246:247], v14 offset:9472
    v_mfma_f32_16x16x32_bf16 v[136:139], a[220:223], v[76:79], v[136:139]
    buffer_load_dwordx4 v4, s[12:15], s59 offen offset:3072 lds
    v_mfma_f32_16x16x32_bf16 v[168:171], a[216:219], v[80:83], v[168:171]
    v_accvgpr_write_b32 a179, 0
    v_mfma_f32_16x16x32_bf16 v[168:171], a[220:223], v[84:87], v[168:171]
    s_add_u32 s12, s12, 524288
    s_addc_u32 s13, s13, 0
    v_mfma_f32_16x16x32_bf16 v[200:203], a[216:219], v[88:91], v[200:203]
    s_add_u32 m0, s44, 53248
    v_mfma_f32_16x16x32_bf16 v[200:203], a[220:223], v[92:95], v[200:203]
    buffer_load_dwordx4 v2, s[8:11], 0 offen lds
    v_mfma_f32_16x16x32_bf16 v[232:235], a[216:219], v[96:99], v[232:235]
    v_mfma_f32_16x16x32_bf16 v[232:235], a[220:223], v[100:103], v[232:235]
    v_mfma_f32_16x16x32_bf16 v[108:111], a[224:227], v[64:67], v[108:111]
    v_mfma_f32_16x16x32_bf16 v[108:111], a[228:231], v[68:71], v[108:111]
    ds_read_b64_tr_b16 a[216:217], v15 offset:0
    ds_read_b64_tr_b16 a[218:219], v15 offset:1024
    v_mfma_f32_16x16x32_bf16 v[140:143], a[224:227], v[72:75], v[140:143]
    ds_read_b64_tr_b16 a[220:221], v15 offset:8192
    ds_read_b64_tr_b16 a[222:223], v15 offset:9216
    v_mfma_f32_16x16x32_bf16 v[140:143], a[228:231], v[76:79], v[140:143]
    buffer_load_dwordx4 v21, s[8:11], s48 offen offset:1024 lds
    v_mfma_f32_16x16x32_bf16 v[172:175], a[224:227], v[80:83], v[172:175]
    v_mfma_f32_16x16x32_bf16 v[172:175], a[228:231], v[84:87], v[172:175]
    v_mfma_f32_16x16x32_bf16 v[204:207], a[224:227], v[88:91], v[204:207]
    v_mfma_f32_16x16x32_bf16 v[204:207], a[228:231], v[92:95], v[204:207]
    buffer_load_dwordx4 v2, s[8:11], s49 offen offset:2048 lds
    v_mfma_f32_16x16x32_bf16 v[236:239], a[224:227], v[96:99], v[236:239]
    v_mfma_f32_16x16x32_bf16 v[236:239], a[228:231], v[100:103], v[236:239]
    v_mfma_f32_16x16x32_bf16 v[112:115], a[232:235], v[64:67], v[112:115]
    v_mfma_f32_16x16x32_bf16 v[112:115], a[236:239], v[68:71], v[112:115]
    ds_read_b64_tr_b16 a[224:225], v16 offset:0
    ds_read_b64_tr_b16 a[226:227], v16 offset:1024
    v_mfma_f32_16x16x32_bf16 v[144:147], a[232:235], v[72:75], v[144:147]
    ds_read_b64_tr_b16 a[228:229], v16 offset:8192
    ds_read_b64_tr_b16 a[230:231], v16 offset:9216
    v_mfma_f32_16x16x32_bf16 v[144:147], a[236:239], v[76:79], v[144:147]
    buffer_load_dwordx4 v21, s[8:11], s50 offen offset:3072 lds
    v_mfma_f32_16x16x32_bf16 v[176:179], a[232:235], v[80:83], v[176:179]
    v_mfma_f32_16x16x32_bf16 v[176:179], a[236:239], v[84:87], v[176:179]
    s_add_u32 m0, s44, 57344
    v_mfma_f32_16x16x32_bf16 v[208:211], a[232:235], v[88:91], v[208:211]
    buffer_load_dwordx4 v2, s[8:11], s51 offen lds
    v_mfma_f32_16x16x32_bf16 v[208:211], a[236:239], v[92:95], v[208:211]
    v_mfma_f32_16x16x32_bf16 v[240:243], a[232:235], v[96:99], v[240:243]
    v_mfma_f32_16x16x32_bf16 v[240:243], a[236:239], v[100:103], v[240:243]
    s_waitcnt lgkmcnt(0)
    v_mfma_f32_16x16x32_bf16 v[116:119], a[240:243], v[64:67], v[116:119]
    buffer_load_dwordx4 v21, s[8:11], s52 offen offset:1024 lds
    v_mfma_f32_16x16x32_bf16 v[116:119], a[244:247], v[68:71], v[116:119]
    ds_read_b64_tr_b16 a[232:233], v15 offset:256
    ds_read_b64_tr_b16 a[234:235], v15 offset:1280
    v_mfma_f32_16x16x32_bf16 v[148:151], a[240:243], v[72:75], v[148:151]
    ds_read_b64_tr_b16 a[236:237], v15 offset:8448
    ds_read_b64_tr_b16 a[238:239], v15 offset:9472
    v_mfma_f32_16x16x32_bf16 v[148:151], a[244:247], v[76:79], v[148:151]
    v_mfma_f32_16x16x32_bf16 v[180:183], a[240:243], v[80:83], v[180:183]
    buffer_load_dwordx4 v2, s[8:11], s53 offen offset:2048 lds
    v_mfma_f32_16x16x32_bf16 v[180:183], a[244:247], v[84:87], v[180:183]
    v_mfma_f32_16x16x32_bf16 v[212:215], a[240:243], v[88:91], v[212:215]
    v_mfma_f32_16x16x32_bf16 v[212:215], a[244:247], v[92:95], v[212:215]
    v_mfma_f32_16x16x32_bf16 v[244:247], a[240:243], v[96:99], v[244:247]
    buffer_load_dwordx4 v21, s[8:11], s86 offen offset:3072 lds
    v_mfma_f32_16x16x32_bf16 v[244:247], a[244:247], v[100:103], v[244:247]
    v_mfma_f32_16x16x32_bf16 v[120:123], a[216:219], v[64:67], v[120:123]
    s_add_u32 m0, s44, 61440
    v_mfma_f32_16x16x32_bf16 v[120:123], a[220:223], v[68:71], v[120:123]
    ds_read_b64_tr_b16 a[240:241], v16 offset:256
    ds_read_b64_tr_b16 a[242:243], v16 offset:1280
    v_mfma_f32_16x16x32_bf16 v[152:155], a[216:219], v[72:75], v[152:155]
    ds_read_b64_tr_b16 a[244:245], v16 offset:8448
    ds_read_b64_tr_b16 a[246:247], v16 offset:9472
    v_mfma_f32_16x16x32_bf16 v[152:155], a[220:223], v[76:79], v[152:155]
    buffer_load_dwordx4 v2, s[8:11], s87 offen lds
    v_mfma_f32_16x16x32_bf16 v[184:187], a[216:219], v[80:83], v[184:187]
    v_mfma_f32_16x16x32_bf16 v[184:187], a[220:223], v[84:87], v[184:187]
    s_add_u32 s8, s8, 128
    s_addc_u32 s9, s9, 0
    v_mfma_f32_16x16x32_bf16 v[216:219], a[216:219], v[88:91], v[216:219]
    v_mfma_f32_16x16x32_bf16 v[216:219], a[220:223], v[92:95], v[216:219]
    v_add_u32 v11, 0xfffe6000, v11
    v_add_u32 v13, 0xfffe6000, v13
    v_mfma_f32_16x16x32_bf16 v[124:127], a[224:227], v[64:67], v[124:127]
    v_add_u32 v14, 0xfffe6000, v14
    v_add_u32 v12, 0xfffe6000, v12
    v_mfma_f32_16x16x32_bf16 v[124:127], a[228:231], v[68:71], v[124:127]
    v_add_u32 v15, 0xfffe6000, v15
    v_add_u32 v16, 0xfffe6000, v16
    v_mfma_f32_16x16x32_bf16 v[156:159], a[224:227], v[72:75], v[156:159]
    v_mfma_f32_16x16x32_bf16 v[156:159], a[228:231], v[76:79], v[156:159]
    v_mfma_f32_16x16x32_bf16 v[188:191], a[224:227], v[80:83], v[188:191]
    s_waitcnt vmcnt(13) lgkmcnt(0)
    s_barrier
    v_mfma_f32_16x16x32_bf16 v[188:191], a[228:231], v[84:87], v[188:191]
    ds_read_b128 a[184:187], v11 offset:0
    ds_read_b128 a[188:191], v11 offset:512
    v_mfma_f32_16x16x32_bf16 v[220:223], a[224:227], v[88:91], v[220:223]
    ds_read_b64_tr_b16 a[216:217], v13 offset:0
    ds_read_b64_tr_b16 a[218:219], v13 offset:1024
    v_mfma_f32_16x16x32_bf16 v[220:223], a[228:231], v[92:95], v[220:223]
    ds_read_b64_tr_b16 a[220:221], v13 offset:8192
    ds_read_b64_tr_b16 a[222:223], v13 offset:9216
    v_mfma_f32_16x16x32_bf16 v[128:131], a[232:235], v[64:67], v[128:131]
    ds_read_b128 a[192:195], v11 offset:2048
    ds_read_b128 a[196:199], v11 offset:2560
    v_mfma_f32_16x16x32_bf16 v[128:131], a[236:239], v[68:71], v[128:131]
    ds_read_b128 a[200:203], v11 offset:4096
    ds_read_b128 a[204:207], v11 offset:4608
    v_mfma_f32_16x16x32_bf16 v[160:163], a[232:235], v[72:75], v[160:163]
    ds_read_b128 a[208:211], v11 offset:6144
    ds_read_b128 a[212:215], v11 offset:6656
    v_mfma_f32_16x16x32_bf16 v[160:163], a[236:239], v[76:79], v[160:163]
    ds_read_b128 a[248:251], v12 offset:0
    ds_read_b128 a[252:255], v12 offset:512
    v_mfma_f32_16x16x32_bf16 v[192:195], a[232:235], v[80:83], v[192:195]
    ds_read_b64_tr_b16 a[224:225], v14 offset:0
    ds_read_b64_tr_b16 a[226:227], v14 offset:1024
    v_mfma_f32_16x16x32_bf16 v[192:195], a[236:239], v[84:87], v[192:195]
    ds_read_b64_tr_b16 a[228:229], v14 offset:8192
    ds_read_b64_tr_b16 a[230:231], v14 offset:9216
    v_mfma_f32_16x16x32_bf16 v[224:227], a[232:235], v[88:91], v[224:227]
    s_add_u32 m0, s39, 143360
    v_mfma_f32_16x16x32_bf16 v[224:227], a[236:239], v[92:95], v[224:227]
    buffer_load_dwordx4 v3, s[12:15], 0 offen lds
    v_mfma_f32_16x16x32_bf16 v[132:135], a[240:243], v[64:67], v[132:135]
    v_mfma_f32_16x16x32_bf16 v[132:135], a[244:247], v[68:71], v[132:135]
    ds_read_b64_tr_b16 a[232:233], v13 offset:256
    ds_read_b64_tr_b16 a[234:235], v13 offset:1280
    v_mfma_f32_16x16x32_bf16 v[164:167], a[240:243], v[72:75], v[164:167]
    ds_read_b64_tr_b16 a[236:237], v13 offset:8448
    ds_read_b64_tr_b16 a[238:239], v13 offset:9472
    v_mfma_f32_16x16x32_bf16 v[164:167], a[244:247], v[76:79], v[164:167]
    buffer_load_dwordx4 v3, s[12:15], s88 offen offset:1024 lds
    v_mfma_f32_16x16x32_bf16 v[196:199], a[240:243], v[80:83], v[196:199]
    v_mfma_f32_16x16x32_bf16 v[196:199], a[244:247], v[84:87], v[196:199]
    v_mfma_f32_16x16x32_bf16 v[228:231], a[240:243], v[88:91], v[228:231]
    v_mfma_f32_16x16x32_bf16 v[228:231], a[244:247], v[92:95], v[228:231]
    s_waitcnt lgkmcnt(0)
    buffer_load_dwordx4 v4, s[12:15], s89 offen offset:2048 lds
    v_mfma_f32_16x16x32_bf16 v[104:107], a[216:219], a[184:187], v[104:107]
    v_mfma_f32_16x16x32_bf16 v[104:107], a[220:223], a[188:191], v[104:107]
    ds_read_b64_tr_b16 a[240:241], v14 offset:256
    ds_read_b64_tr_b16 a[242:243], v14 offset:1280
    v_mfma_f32_16x16x32_bf16 v[136:139], a[216:219], a[192:195], v[136:139]
    ds_read_b64_tr_b16 a[244:245], v14 offset:8448
    ds_read_b64_tr_b16 a[246:247], v14 offset:9472
    v_mfma_f32_16x16x32_bf16 v[136:139], a[220:223], a[196:199], v[136:139]
    buffer_load_dwordx4 v4, s[12:15], s59 offen offset:3072 lds
    v_mfma_f32_16x16x32_bf16 v[168:171], a[216:219], a[200:203], v[168:171]
    v_mfma_f32_16x16x32_bf16 v[168:171], a[220:223], a[204:207], v[168:171]
    s_add_u32 s12, s12, 524288
    s_addc_u32 s13, s13, 0
    v_mfma_f32_16x16x32_bf16 v[200:203], a[216:219], a[208:211], v[200:203]
    s_add_u32 m0, s44, 106496
    v_mfma_f32_16x16x32_bf16 v[200:203], a[220:223], a[212:215], v[200:203]
    buffer_load_dwordx4 v2, s[8:11], 0 offen lds
    v_mfma_f32_16x16x32_bf16 v[232:235], a[216:219], a[248:251], v[232:235]
    v_mfma_f32_16x16x32_bf16 v[232:235], a[220:223], a[252:255], v[232:235]
    v_mfma_f32_16x16x32_bf16 v[108:111], a[224:227], a[184:187], v[108:111]
    v_mfma_f32_16x16x32_bf16 v[108:111], a[228:231], a[188:191], v[108:111]
    ds_read_b64_tr_b16 a[216:217], v15 offset:0
    ds_read_b64_tr_b16 a[218:219], v15 offset:1024
    v_mfma_f32_16x16x32_bf16 v[140:143], a[224:227], a[192:195], v[140:143]
    ds_read_b64_tr_b16 a[220:221], v15 offset:8192
    ds_read_b64_tr_b16 a[222:223], v15 offset:9216
    v_mfma_f32_16x16x32_bf16 v[140:143], a[228:231], a[196:199], v[140:143]
    buffer_load_dwordx4 v21, s[8:11], s48 offen offset:1024 lds
    v_mfma_f32_16x16x32_bf16 v[172:175], a[224:227], a[200:203], v[172:175]
    v_mfma_f32_16x16x32_bf16 v[172:175], a[228:231], a[204:207], v[172:175]
    v_mfma_f32_16x16x32_bf16 v[204:207], a[224:227], a[208:211], v[204:207]
    v_mfma_f32_16x16x32_bf16 v[204:207], a[228:231], a[212:215], v[204:207]
    buffer_load_dwordx4 v2, s[8:11], s49 offen offset:2048 lds
    v_mfma_f32_16x16x32_bf16 v[236:239], a[224:227], a[248:251], v[236:239]
    v_mfma_f32_16x16x32_bf16 v[236:239], a[228:231], a[252:255], v[236:239]
    v_mfma_f32_16x16x32_bf16 v[112:115], a[232:235], a[184:187], v[112:115]
    v_mfma_f32_16x16x32_bf16 v[112:115], a[236:239], a[188:191], v[112:115]
    ds_read_b64_tr_b16 a[224:225], v16 offset:0
    ds_read_b64_tr_b16 a[226:227], v16 offset:1024
    v_mfma_f32_16x16x32_bf16 v[144:147], a[232:235], a[192:195], v[144:147]
    ds_read_b64_tr_b16 a[228:229], v16 offset:8192
    ds_read_b64_tr_b16 a[230:231], v16 offset:9216
    v_mfma_f32_16x16x32_bf16 v[144:147], a[236:239], a[196:199], v[144:147]
    buffer_load_dwordx4 v21, s[8:11], s50 offen offset:3072 lds
    v_mfma_f32_16x16x32_bf16 v[176:179], a[232:235], a[200:203], v[176:179]
    v_mfma_f32_16x16x32_bf16 v[176:179], a[236:239], a[204:207], v[176:179]
    s_add_u32 m0, s44, 110592
    v_mfma_f32_16x16x32_bf16 v[208:211], a[232:235], a[208:211], v[208:211]
    buffer_load_dwordx4 v2, s[8:11], s51 offen lds
    v_mfma_f32_16x16x32_bf16 v[208:211], a[236:239], a[212:215], v[208:211]
    v_mfma_f32_16x16x32_bf16 v[240:243], a[232:235], a[248:251], v[240:243]
    v_mfma_f32_16x16x32_bf16 v[240:243], a[236:239], a[252:255], v[240:243]
    s_waitcnt lgkmcnt(0)
    v_mfma_f32_16x16x32_bf16 v[116:119], a[240:243], a[184:187], v[116:119]
    buffer_load_dwordx4 v21, s[8:11], s52 offen offset:1024 lds
    v_mfma_f32_16x16x32_bf16 v[116:119], a[244:247], a[188:191], v[116:119]
    ds_read_b64_tr_b16 a[232:233], v15 offset:256
    ds_read_b64_tr_b16 a[234:235], v15 offset:1280
    v_mfma_f32_16x16x32_bf16 v[148:151], a[240:243], a[192:195], v[148:151]
    ds_read_b64_tr_b16 a[236:237], v15 offset:8448
    ds_read_b64_tr_b16 a[238:239], v15 offset:9472
    v_mfma_f32_16x16x32_bf16 v[148:151], a[244:247], a[196:199], v[148:151]
    v_mfma_f32_16x16x32_bf16 v[180:183], a[240:243], a[200:203], v[180:183]
    buffer_load_dwordx4 v2, s[8:11], s53 offen offset:2048 lds
    v_mfma_f32_16x16x32_bf16 v[180:183], a[244:247], a[204:207], v[180:183]
    v_mfma_f32_16x16x32_bf16 v[212:215], a[240:243], a[208:211], v[212:215]
    v_mfma_f32_16x16x32_bf16 v[212:215], a[244:247], a[212:215], v[212:215]
    v_mfma_f32_16x16x32_bf16 v[244:247], a[240:243], a[248:251], v[244:247]
    buffer_load_dwordx4 v21, s[8:11], s86 offen offset:3072 lds
    v_mfma_f32_16x16x32_bf16 v[244:247], a[244:247], a[252:255], v[244:247]
    v_mfma_f32_16x16x32_bf16 v[120:123], a[216:219], a[184:187], v[120:123]
    s_add_u32 m0, s44, 114688
    v_mfma_f32_16x16x32_bf16 v[120:123], a[220:223], a[188:191], v[120:123]
    ds_read_b64_tr_b16 a[240:241], v16 offset:256
    ds_read_b64_tr_b16 a[242:243], v16 offset:1280
    v_mfma_f32_16x16x32_bf16 v[152:155], a[216:219], a[192:195], v[152:155]
    ds_read_b64_tr_b16 a[244:245], v16 offset:8448
    ds_read_b64_tr_b16 a[246:247], v16 offset:9472
    v_mfma_f32_16x16x32_bf16 v[152:155], a[220:223], a[196:199], v[152:155]
    buffer_load_dwordx4 v2, s[8:11], s87 offen lds
    v_mfma_f32_16x16x32_bf16 v[184:187], a[216:219], a[200:203], v[184:187]
    v_mfma_f32_16x16x32_bf16 v[184:187], a[220:223], a[204:207], v[184:187]
    s_add_u32 s8, s8, 128
    s_addc_u32 s9, s9, 0
    v_mfma_f32_16x16x32_bf16 v[216:219], a[216:219], a[208:211], v[216:219]
    v_mfma_f32_16x16x32_bf16 v[216:219], a[220:223], a[212:215], v[216:219]
    v_add_u32 v11, 0xd000, v11
    v_add_u32 v13, 0xd000, v13
    v_mfma_f32_16x16x32_bf16 v[124:127], a[224:227], a[184:187], v[124:127]
    v_add_u32 v14, 0xd000, v14
    v_add_u32 v12, 0xd000, v12
    v_mfma_f32_16x16x32_bf16 v[124:127], a[228:231], a[188:191], v[124:127]
    v_add_u32 v15, 0xd000, v15
    v_add_u32 v16, 0xd000, v16
    v_mfma_f32_16x16x32_bf16 v[156:159], a[224:227], a[192:195], v[156:159]
    v_mfma_f32_16x16x32_bf16 v[156:159], a[228:231], a[196:199], v[156:159]
    v_mfma_f32_16x16x32_bf16 v[188:191], a[224:227], a[200:203], v[188:191]
    s_waitcnt vmcnt(13) lgkmcnt(0)
    s_barrier
    v_mfma_f32_16x16x32_bf16 v[188:191], a[228:231], a[204:207], v[188:191]
    ds_read_b128 v[64:67], v11 offset:0
    ds_read_b128 v[68:71], v11 offset:512
    v_mfma_f32_16x16x32_bf16 v[220:223], a[224:227], a[208:211], v[220:223]
    ds_read_b64_tr_b16 a[216:217], v13 offset:0
    ds_read_b64_tr_b16 a[218:219], v13 offset:1024
    v_mfma_f32_16x16x32_bf16 v[220:223], a[228:231], a[212:215], v[220:223]
    ds_read_b64_tr_b16 a[220:221], v13 offset:8192
    ds_read_b64_tr_b16 a[222:223], v13 offset:9216
    v_mfma_f32_16x16x32_bf16 v[128:131], a[232:235], a[184:187], v[128:131]
    ds_read_b128 v[72:75], v11 offset:2048
    ds_read_b128 v[76:79], v11 offset:2560
    v_mfma_f32_16x16x32_bf16 v[128:131], a[236:239], a[188:191], v[128:131]
    ds_read_b128 v[80:83], v11 offset:4096
    ds_read_b128 v[84:87], v11 offset:4608
    v_mfma_f32_16x16x32_bf16 v[160:163], a[232:235], a[192:195], v[160:163]
    ds_read_b128 v[88:91], v11 offset:6144
    ds_read_b128 v[92:95], v11 offset:6656
    v_mfma_f32_16x16x32_bf16 v[160:163], a[236:239], a[196:199], v[160:163]
    ds_read_b128 v[96:99], v12 offset:0
    ds_read_b128 v[100:103], v12 offset:512
    v_mfma_f32_16x16x32_bf16 v[192:195], a[232:235], a[200:203], v[192:195]
    ds_read_b64_tr_b16 a[224:225], v14 offset:0
    ds_read_b64_tr_b16 a[226:227], v14 offset:1024
    v_mfma_f32_16x16x32_bf16 v[192:195], a[236:239], a[204:207], v[192:195]
    ds_read_b64_tr_b16 a[228:229], v14 offset:8192
    ds_read_b64_tr_b16 a[230:231], v14 offset:9216
    v_mfma_f32_16x16x32_bf16 v[224:227], a[232:235], a[208:211], v[224:227]
    s_add_u32 m0, s39, 0
    s_mov_b32 s40, 0
    v_mfma_f32_16x16x32_bf16 v[224:227], a[236:239], a[212:215], v[224:227]
    buffer_load_dwordx4 v5, s[16:19], s40 offen nt lds
    v_mfma_f32_16x16x32_bf16 v[132:135], a[240:243], a[184:187], v[132:135]
    s_mov_b32 s47, 0
    s_lshr_b32 s4, s2, 3
    v_mfma_f32_16x16x32_bf16 v[132:135], a[244:247], a[188:191], v[132:135]
    ds_read_b64_tr_b16 a[232:233], v13 offset:256
    ds_read_b64_tr_b16 a[234:235], v13 offset:1280
    v_mfma_f32_16x16x32_bf16 v[164:167], a[240:243], a[192:195], v[164:167]
    ds_read_b64_tr_b16 a[236:237], v13 offset:8448
    ds_read_b64_tr_b16 a[238:239], v13 offset:9472
    v_mfma_f32_16x16x32_bf16 v[164:167], a[244:247], a[196:199], v[164:167]
    s_and_b32 s3, s2, 7
    s_mul_i32 s88, s4, 57
    v_mfma_f32_16x16x32_bf16 v[196:199], a[240:243], a[200:203], v[196:199]
    s_lshr_b32 s88, s88, 9
    s_mul_i32 s6, s88, 9
    v_mfma_f32_16x16x32_bf16 v[196:199], a[244:247], a[204:207], v[196:199]
    s_sub_u32 s89, s4, s6
    s_bfe_u32 s6, s2, 0x20001
    v_mfma_f32_16x16x32_bf16 v[228:231], a[240:243], a[208:211], v[228:231]
    s_mul_i32 s7, s6, 3
    s_add_u32 s7, s7, s88
    v_mfma_f32_16x16x32_bf16 v[228:231], a[244:247], a[212:215], v[228:231]
    s_waitcnt lgkmcnt(0)
    s_mul_i32 s5, s7, 5
    v_mfma_f32_16x16x32_bf16 v[104:107], a[216:219], v[64:67], v[104:107]
    s_add_u32 s5, s5, 84
    v_bfe_u32 v18, v1, 6, 3
    v_mfma_f32_16x16x32_bf16 v[104:107], a[220:223], v[68:71], v[104:107]
    ds_read_b64_tr_b16 a[240:241], v14 offset:256
    ds_read_b64_tr_b16 a[242:243], v14 offset:1280
    v_mfma_f32_16x16x32_bf16 v[136:139], a[216:219], v[72:75], v[136:139]
    ds_read_b64_tr_b16 a[244:245], v14 offset:8448
    ds_read_b64_tr_b16 a[246:247], v14 offset:9472
    v_mfma_f32_16x16x32_bf16 v[136:139], a[220:223], v[76:79], v[136:139]
    s_cmp_eq_u32 s7, 3
    s_cselect_b32 s7, 12, s7
    v_mfma_f32_16x16x32_bf16 v[168:171], a[216:219], v[80:83], v[168:171]
    s_cmp_eq_u32 s7, 9
    s_cselect_b32 s7, 13, s7
    v_mfma_f32_16x16x32_bf16 v[168:171], a[220:223], v[84:87], v[168:171]
    buffer_load_dwordx4 v6, s[16:19], s40 offen offset:1024 nt lds
    v_mfma_f32_16x16x32_bf16 v[200:203], a[216:219], v[88:91], v[200:203]
    s_mul_i32 s3, s7, 6
    v_add_u32 v20, s56, v18
    v_mfma_f32_16x16x32_bf16 v[200:203], a[220:223], v[92:95], v[200:203]
    s_bitcmp1_b32 s2, 0
    s_cselect_b32 s7, s5, s3
    v_mfma_f32_16x16x32_bf16 v[232:235], a[216:219], v[96:99], v[232:235]
    s_bfe_u32 s5, s2, 0x10001
    s_mul_i32 s5, s5, 5
    v_mfma_f32_16x16x32_bf16 v[232:235], a[220:223], v[100:103], v[232:235]
    s_add_u32 s5, s5, s89
    s_and_b32 s3, s2, 1
    v_mfma_f32_16x16x32_bf16 v[108:111], a[224:227], v[64:67], v[108:111]
    s_lshl_b32 s3, s3, 4
    s_add_u32 s5, s5, s3
    v_mfma_f32_16x16x32_bf16 v[108:111], a[228:231], v[68:71], v[108:111]
    ds_read_b64_tr_b16 a[216:217], v15 offset:0
    ds_read_b64_tr_b16 a[218:219], v15 offset:1024
    v_mfma_f32_16x16x32_bf16 v[140:143], a[224:227], v[72:75], v[140:143]
    ds_read_b64_tr_b16 a[220:221], v15 offset:8192
    ds_read_b64_tr_b16 a[222:223], v15 offset:9216
    v_mfma_f32_16x16x32_bf16 v[140:143], a[228:231], v[76:79], v[140:143]
    s_bfe_u32 s6, s2, 0x10002
    s_mul_i32 s6, s6, 36
    v_mfma_f32_16x16x32_bf16 v[172:175], a[224:227], v[80:83], v[172:175]
    s_add_u32 s6, s6, 18
    v_mul_u32_u24 v20, 1152, v20
    v_mfma_f32_16x16x32_bf16 v[172:175], a[228:231], v[84:87], v[172:175]
    s_cmp_eq_u32 s88, 3
    s_cselect_b32 s7, s6, s7
    v_mfma_f32_16x16x32_bf16 v[204:207], a[224:227], v[88:91], v[204:207]
    s_cmp_eq_u32 s88, 3
    s_cselect_b32 s89, s5, s89
    v_mfma_f32_16x16x32_bf16 v[204:207], a[228:231], v[92:95], v[204:207]
    s_cmp_eq_u32 s88, 3
    s_cselect_b32 s88, 0, s88
    v_mfma_f32_16x16x32_bf16 v[236:239], a[224:227], v[96:99], v[236:239]
    s_cmp_ge_u32 s89, 9
    s_cselect_b32 s88, 3, s88
    v_mfma_f32_16x16x32_bf16 v[236:239], a[228:231], v[100:103], v[236:239]
    buffer_load_dwordx4 v5, s[16:19], s40 offen offset:2048 nt lds
    v_mfma_f32_16x16x32_bf16 v[112:115], a[232:235], v[64:67], v[112:115]
    s_min_u32 s89, s89, 8
    s_mul_i32 s3, s7, 57
    v_mfma_f32_16x16x32_bf16 v[112:115], a[236:239], v[68:71], v[112:115]
    ds_read_b64_tr_b16 a[224:225], v16 offset:0
    ds_read_b64_tr_b16 a[226:227], v16 offset:1024
    v_mfma_f32_16x16x32_bf16 v[144:147], a[232:235], v[72:75], v[144:147]
    ds_read_b64_tr_b16 a[228:229], v16 offset:8192
    ds_read_b64_tr_b16 a[230:231], v16 offset:9216
    v_mfma_f32_16x16x32_bf16 v[144:147], a[236:239], v[76:79], v[144:147]
    s_add_u32 s6, s3, 228
    s_lshr_b32 s3, s3, 10
    v_mfma_f32_16x16x32_bf16 v[176:179], a[232:235], v[80:83], v[176:179]
    s_lshr_b32 s6, s6, 10
    v_lshrrev_b32 v19, 9, v1
    v_mfma_f32_16x16x32_bf16 v[176:179], a[236:239], v[84:87], v[176:179]
    s_cmp_lg_u32 s3, s6
    s_cselect_b32 s55, 32, 0
    v_mfma_f32_16x16x32_bf16 v[208:211], a[232:235], v[88:91], v[208:211]
    s_mul_i32 s59, s88, 3
    s_add_u32 s59, s59, s89
    v_mfma_f32_16x16x32_bf16 v[208:211], a[236:239], v[92:95], v[208:211]
    s_mul_i32 s59, s59, 228
    s_lshr_b32 s59, s59, 8
    v_mfma_f32_16x16x32_bf16 v[240:243], a[232:235], v[96:99], v[240:243]
    s_lshl_b32 s5, s89, 7
    v_lshl_add_u32 v20, v19, 6, v20
    v_mfma_f32_16x16x32_bf16 v[240:243], a[236:239], v[100:103], v[240:243]
    s_waitcnt lgkmcnt(0)
    v_lshlrev_b32 v18, 6, v18
    v_mfma_f32_16x16x32_bf16 v[116:119], a[240:243], v[64:67], v[116:119]
    s_add_u32 s8, s96, s5
    s_addc_u32 s9, s97, 0
    v_mfma_f32_16x16x32_bf16 v[116:119], a[244:247], v[68:71], v[116:119]
    ds_read_b64_tr_b16 a[232:233], v15 offset:256
    ds_read_b64_tr_b16 a[234:235], v15 offset:1280
    v_mfma_f32_16x16x32_bf16 v[148:151], a[240:243], v[72:75], v[148:151]
    ds_read_b64_tr_b16 a[236:237], v15 offset:8448
    ds_read_b64_tr_b16 a[238:239], v15 offset:9472
    v_mfma_f32_16x16x32_bf16 v[148:151], a[244:247], v[76:79], v[148:151]
    buffer_load_dwordx4 v6, s[16:19], s40 offen offset:3072 nt lds
    v_mfma_f32_16x16x32_bf16 v[180:183], a[240:243], v[80:83], v[180:183]
    s_sub_u32 s10, 4718592, s5
    v_lshl_add_u32 v18, v19, 10, v18
    v_mfma_f32_16x16x32_bf16 v[180:183], a[244:247], v[84:87], v[180:183]
    s_cmp_ge_u32 s88, 3
    s_cselect_b32 s10, 0, s10
    v_mfma_f32_16x16x32_bf16 v[212:215], a[240:243], v[88:91], v[212:215]
    s_add_u32 s4, s59, 0
    s_and_b32 s4, s4, 7
    v_mfma_f32_16x16x32_bf16 v[212:215], a[244:247], v[92:95], v[212:215]
    s_mul_i32 s48, s4, 36864
    s_add_u32 s4, s59, 1
    v_mfma_f32_16x16x32_bf16 v[244:247], a[240:243], v[96:99], v[244:247]
    s_and_b32 s4, s4, 7
    s_mul_i32 s49, s4, 36864
    v_mfma_f32_16x16x32_bf16 v[244:247], a[244:247], v[100:103], v[244:247]
    s_add_u32 s4, s59, 2
    s_and_b32 s4, s4, 7
    v_mfma_f32_16x16x32_bf16 v[120:123], a[216:219], v[64:67], v[120:123]
    s_mul_i32 s50, s4, 36864
    s_add_u32 s4, s59, 3
    v_mfma_f32_16x16x32_bf16 v[120:123], a[220:223], v[68:71], v[120:123]
    ds_read_b64_tr_b16 a[240:241], v16 offset:256
    ds_read_b64_tr_b16 a[242:243], v16 offset:1280
    v_mfma_f32_16x16x32_bf16 v[152:155], a[216:219], v[72:75], v[152:155]
    ds_read_b64_tr_b16 a[244:245], v16 offset:8448
    ds_read_b64_tr_b16 a[246:247], v16 offset:9472
    v_mfma_f32_16x16x32_bf16 v[152:155], a[220:223], v[76:79], v[152:155]
    s_and_b32 s4, s4, 7
    s_mul_i32 s51, s4, 36864
    v_mfma_f32_16x16x32_bf16 v[184:187], a[216:219], v[80:83], v[184:187]
    s_add_u32 s4, s59, 4
    s_and_b32 s4, s4, 7
    v_mfma_f32_16x16x32_bf16 v[184:187], a[220:223], v[84:87], v[184:187]
    s_mul_i32 s52, s4, 36864
    s_add_u32 s4, s59, 5
    v_mfma_f32_16x16x32_bf16 v[216:219], a[216:219], v[88:91], v[216:219]
    s_and_b32 s4, s4, 7
    s_mul_i32 s53, s4, 36864
    v_mfma_f32_16x16x32_bf16 v[216:219], a[220:223], v[92:95], v[216:219]
    v_add_u32 v11, 0xd000, v11
    v_add_u32 v13, 0xd000, v13
    v_mfma_f32_16x16x32_bf16 v[124:127], a[224:227], v[64:67], v[124:127]
    v_add_u32 v14, 0xd000, v14
    v_add_u32 v12, 0xd000, v12
    v_mfma_f32_16x16x32_bf16 v[124:127], a[228:231], v[68:71], v[124:127]
    v_add_u32 v15, 0xd000, v15
    v_add_u32 v16, 0xd000, v16
    v_mfma_f32_16x16x32_bf16 v[156:159], a[224:227], v[72:75], v[156:159]
    s_add_u32 s4, s59, 6
    s_and_b32 s4, s4, 7
    v_mfma_f32_16x16x32_bf16 v[156:159], a[228:231], v[76:79], v[156:159]
    s_mul_i32 s86, s4, 36864
    s_add_u32 s4, s59, 7
    v_mfma_f32_16x16x32_bf16 v[188:191], a[224:227], v[80:83], v[188:191]
    s_waitcnt vmcnt(4) lgkmcnt(0)
    s_barrier
    v_mfma_f32_16x16x32_bf16 v[188:191], a[228:231], v[84:87], v[188:191]
    ds_read_b128 a[184:187], v11 offset:0
    ds_read_b128 a[188:191], v11 offset:512
    v_mfma_f32_16x16x32_bf16 v[220:223], a[224:227], v[88:91], v[220:223]
    ds_read_b64_tr_b16 a[216:217], v13 offset:0
    ds_read_b64_tr_b16 a[218:219], v13 offset:1024
    v_mfma_f32_16x16x32_bf16 v[220:223], a[228:231], v[92:95], v[220:223]
    ds_read_b64_tr_b16 a[220:221], v13 offset:8192
    ds_read_b64_tr_b16 a[222:223], v13 offset:9216
    v_mfma_f32_16x16x32_bf16 v[128:131], a[232:235], v[64:67], v[128:131]
    ds_read_b128 a[192:195], v11 offset:2048
    ds_read_b128 a[196:199], v11 offset:2560
    v_mfma_f32_16x16x32_bf16 v[128:131], a[236:239], v[68:71], v[128:131]
    ds_read_b128 a[200:203], v11 offset:4096
    ds_read_b128 a[204:207], v11 offset:4608
    v_mfma_f32_16x16x32_bf16 v[160:163], a[232:235], v[72:75], v[160:163]
    ds_read_b128 a[208:211], v11 offset:6144
    ds_read_b128 a[212:215], v11 offset:6656
    v_mfma_f32_16x16x32_bf16 v[160:163], a[236:239], v[76:79], v[160:163]
    ds_read_b128 a[248:251], v12 offset:0
    ds_read_b128 a[252:255], v12 offset:512
    v_mfma_f32_16x16x32_bf16 v[192:195], a[232:235], v[80:83], v[192:195]
    ds_read_b64_tr_b16 a[224:225], v14 offset:0
    ds_read_b64_tr_b16 a[226:227], v14 offset:1024
    v_mfma_f32_16x16x32_bf16 v[192:195], a[236:239], v[84:87], v[192:195]
    ds_read_b64_tr_b16 a[228:229], v14 offset:8192
    ds_read_b64_tr_b16 a[230:231], v14 offset:9216
    v_mfma_f32_16x16x32_bf16 v[224:227], a[232:235], v[88:91], v[224:227]
    s_add_u32 m0, s39, 32768
    s_mov_b32 s40, 16384
    v_mfma_f32_16x16x32_bf16 v[224:227], a[236:239], v[92:95], v[224:227]
    buffer_load_dwordx4 v5, s[16:19], s40 offen nt lds
    v_mfma_f32_16x16x32_bf16 v[132:135], a[240:243], v[64:67], v[132:135]
    s_and_b32 s4, s4, 7
    s_mul_i32 s87, s4, 36864
    v_mfma_f32_16x16x32_bf16 v[132:135], a[244:247], v[68:71], v[132:135]
    ds_read_b64_tr_b16 a[232:233], v13 offset:256
    ds_read_b64_tr_b16 a[234:235], v13 offset:1280
    v_mfma_f32_16x16x32_bf16 v[164:167], a[240:243], v[72:75], v[164:167]
    ds_read_b64_tr_b16 a[236:237], v13 offset:8448
    ds_read_b64_tr_b16 a[238:239], v13 offset:9472
    v_mfma_f32_16x16x32_bf16 v[164:167], a[244:247], v[76:79], v[164:167]
    s_mul_i32 s4, s7, 131072
    v_bfe_u32 v19, v1, 8, 1
    v_mfma_f32_16x16x32_bf16 v[196:199], a[240:243], v[80:83], v[196:199]
    s_add_u32 s12, s36, s4
    s_addc_u32 s13, s37, 0
    v_mfma_f32_16x16x32_bf16 v[196:199], a[244:247], v[84:87], v[196:199]
    s_mul_i32 s4, s7, 18432
    s_add_u32 s44, s4, s5
    v_mfma_f32_16x16x32_bf16 v[228:231], a[240:243], v[88:91], v[228:231]
    s_lshl_b32 s3, s3, 2
    s_mov_b32 s14, 786432
    v_mfma_f32_16x16x32_bf16 v[228:231], a[244:247], v[92:95], v[228:231]
    s_waitcnt lgkmcnt(0)
    s_mov_b32 s32, s94
    v_mfma_f32_16x16x32_bf16 v[104:107], a[216:219], a[184:187], v[104:107]
    s_mov_b32 s33, s95
    s_mov_b32 s34, 256
    v_mfma_f32_16x16x32_bf16 v[104:107], a[220:223], a[188:191], v[104:107]
    ds_read_b64_tr_b16 a[240:241], v14 offset:256
    ds_read_b64_tr_b16 a[242:243], v14 offset:1280
    v_mfma_f32_16x16x32_bf16 v[136:139], a[216:219], a[192:195], v[136:139]
    ds_read_b64_tr_b16 a[244:245], v14 offset:8448
    ds_read_b64_tr_b16 a[246:247], v14 offset:9472
    v_mfma_f32_16x16x32_bf16 v[136:139], a[220:223], a[196:199], v[136:139]
    buffer_load_dwordx4 v6, s[16:19], s40 offen offset:1024 nt lds
    v_mfma_f32_16x16x32_bf16 v[168:171], a[216:219], a[200:203], v[168:171]
    s_mov_b32 s35, 0x20000
    v_lshlrev_b32 v19, 5, v19
    v_mfma_f32_16x16x32_bf16 v[168:171], a[220:223], a[204:207], v[168:171]
    v_add_u32 v18, v18, v19
    v_and_b32 v17, 48, v1
    v_mfma_f32_16x16x32_bf16 v[200:203], a[216:219], a[208:211], v[200:203]
    v_xor_b32 v19, v19, v17
    v_add_u32 v2, v19, v20
    v_mfma_f32_16x16x32_bf16 v[200:203], a[220:223], a[212:215], v[200:203]
    v_add_u32 v3, 8192, v2
    v_add_u32 v4, 16384, v2
    v_mfma_f32_16x16x32_bf16 v[232:235], a[216:219], a[248:251], v[232:235]
    v_add_u32 v21, 24576, v2
    v_lshrrev_b32 v17, 1, v17
    v_mfma_f32_16x16x32_bf16 v[232:235], a[220:223], a[252:255], v[232:235]
    v_add_u32 v17, v17, v18
    v_add_u32 v17, s39, v17
    v_mfma_f32_16x16x32_bf16 v[108:111], a[224:227], a[184:187], v[108:111]
    v_mfma_f32_16x16x32_bf16 v[108:111], a[228:231], a[188:191], v[108:111]
    ds_read_b64_tr_b16 a[216:217], v15 offset:0
    ds_read_b64_tr_b16 a[218:219], v15 offset:1024
    v_mfma_f32_16x16x32_bf16 v[140:143], a[224:227], a[192:195], v[140:143]
    ds_read_b64_tr_b16 a[220:221], v15 offset:8192
    ds_read_b64_tr_b16 a[222:223], v15 offset:9216
    v_mfma_f32_16x16x32_bf16 v[140:143], a[228:231], a[196:199], v[140:143]
    buffer_load_dwordx4 v5, s[16:19], s40 offen offset:2048 nt lds
    v_mfma_f32_16x16x32_bf16 v[172:175], a[224:227], a[200:203], v[172:175]
    v_mfma_f32_16x16x32_bf16 v[172:175], a[228:231], a[204:207], v[172:175]
    v_mfma_f32_16x16x32_bf16 v[204:207], a[224:227], a[208:211], v[204:207]
    v_mfma_f32_16x16x32_bf16 v[204:207], a[228:231], a[212:215], v[204:207]
    v_mfma_f32_16x16x32_bf16 v[236:239], a[224:227], a[248:251], v[236:239]
    v_mfma_f32_16x16x32_bf16 v[236:239], a[228:231], a[252:255], v[236:239]
    v_mov_b32 v248, 0xff800000
    v_mov_b32 v249, 0xff800000
    v_mov_b32 v250, 0xff800000
    v_mov_b32 v251, 0xff800000
    v_mov_b32 v252, 0xff800000
    s_bitcmp1_b32 s38, 0
    s_cbranch_scc0 L1_even
    v_mfma_f32_16x16x32_bf16 v[112:115], a[232:235], a[184:187], v[112:115]
    s_lshl_b32 s42, s38, 11
    s_add_u32 s42, s42, 16384
    v_mfma_f32_16x16x32_bf16 v[112:115], a[236:239], a[188:191], v[112:115]
    ds_read_b64_tr_b16 a[224:225], v16 offset:0
    ds_read_b64_tr_b16 a[226:227], v16 offset:1024
    v_mfma_f32_16x16x32_bf16 v[144:147], a[232:235], a[192:195], v[144:147]
    ds_read_b64_tr_b16 a[228:229], v16 offset:8192
    ds_read_b64_tr_b16 a[230:231], v16 offset:9216
    v_mfma_f32_16x16x32_bf16 v[144:147], a[236:239], a[196:199], v[144:147]
    buffer_load_dwordx4 v6, s[16:19], s40 offen offset:3072 nt lds
    v_add_u32 v19, s42, v1
    v_mfma_f32_16x16x32_bf16 v[176:179], a[232:235], a[200:203], v[176:179]
    s_and_b32 s42, s42, 0xfffff000
    v_add_u32 v18, s42, v1
    v_mfma_f32_16x16x32_bf16 v[176:179], a[236:239], a[204:207], v[176:179]
    v_mul_f32 v232, s54, v232
    v_mul_f32 v233, s54, v233
    v_mfma_f32_16x16x32_bf16 v[208:211], a[232:235], a[208:211], v[208:211]
    v_mul_f32 v234, s54, v234
    v_mul_f32 v235, s54, v235
    v_mfma_f32_16x16x32_bf16 v[208:211], a[236:239], a[212:215], v[208:211]
    v_mul_f32 v236, s54, v236
    v_mul_f32 v237, s54, v237
    v_mfma_f32_16x16x32_bf16 v[240:243], a[232:235], a[248:251], v[240:243]
    v_mul_f32 v238, s54, v238
    v_mul_f32 v239, s54, v239
    v_mfma_f32_16x16x32_bf16 v[240:243], a[236:239], a[252:255], v[240:243]
    s_waitcnt lgkmcnt(0)
    v_cvt_pk_bf16_f32 v88, v232, v233
    v_mfma_f32_16x16x32_bf16 v[116:119], a[240:243], a[184:187], v[116:119]
    v_cvt_pk_bf16_f32 v89, v234, v235
    v_cvt_pk_bf16_f32 v90, v236, v237
    v_mfma_f32_16x16x32_bf16 v[116:119], a[244:247], a[188:191], v[116:119]
    ds_read_b64_tr_b16 a[232:233], v15 offset:256
    ds_read_b64_tr_b16 a[234:235], v15 offset:1280
    v_mfma_f32_16x16x32_bf16 v[148:151], a[240:243], a[192:195], v[148:151]
    ds_read_b64_tr_b16 a[236:237], v15 offset:8448
    ds_read_b64_tr_b16 a[238:239], v15 offset:9472
    v_mfma_f32_16x16x32_bf16 v[148:151], a[244:247], a[196:199], v[148:151]
    s_add_u32 m0, s39, 49152
    s_mov_b32 s40, 0
    v_mfma_f32_16x16x32_bf16 v[180:183], a[240:243], a[200:203], v[180:183]
    buffer_load_dwordx4 v5, s[20:23], s40 offen nt lds
    v_cvt_pk_bf16_f32 v91, v238, v239
    v_mfma_f32_16x16x32_bf16 v[180:183], a[244:247], a[204:207], v[180:183]
    v_permlane16_swap_b32 v88, v90
    v_permlane16_swap_b32 v89, v91
    v_mfma_f32_16x16x32_bf16 v[212:215], a[240:243], a[208:211], v[212:215]
    v_mul_f32 v240, s54, v240
    v_mul_f32 v241, s54, v241
    v_mfma_f32_16x16x32_bf16 v[212:215], a[244:247], a[212:215], v[212:215]
    v_mul_f32 v242, s54, v242
    v_mul_f32 v243, s54, v243
    v_mfma_f32_16x16x32_bf16 v[244:247], a[240:243], a[248:251], v[244:247]
    v_cvt_pk_bf16_f32 v92, v240, v241
    v_cvt_pk_bf16_f32 v93, v242, v243
    v_mfma_f32_16x16x32_bf16 v[244:247], a[244:247], a[252:255], v[244:247]
    v_mul_f32 v104, s54, v104
    v_mul_f32 v105, s54, v105
    v_mfma_f32_16x16x32_bf16 v[120:123], a[216:219], a[184:187], v[120:123]
    v_mul_f32 v106, s54, v106
    v_mul_f32 v107, s54, v107
    v_mfma_f32_16x16x32_bf16 v[120:123], a[220:223], a[188:191], v[120:123]
    ds_read_b64_tr_b16 a[240:241], v16 offset:256
    ds_read_b64_tr_b16 a[242:243], v16 offset:1280
    v_mfma_f32_16x16x32_bf16 v[152:155], a[216:219], a[192:195], v[152:155]
    ds_read_b64_tr_b16 a[244:245], v16 offset:8448
    ds_read_b64_tr_b16 a[246:247], v16 offset:9472
    v_mfma_f32_16x16x32_bf16 v[152:155], a[220:223], a[196:199], v[152:155]
    s_mov_b32 s43, 0
    v_add_u32 v11, s43, v7
    v_mfma_f32_16x16x32_bf16 v[184:187], a[216:219], a[200:203], v[184:187]
    buffer_load_dwordx4 v6, s[20:23], s40 offen offset:1024 nt lds
    v_add_u32 v13, s43, v9
    v_mfma_f32_16x16x32_bf16 v[184:187], a[220:223], a[204:207], v[184:187]
    v_add_u32 v15, s43, v10
    v_xor_b32 v14, 32, v13
    v_mfma_f32_16x16x32_bf16 v[216:219], a[216:219], a[208:211], v[216:219]
    v_xor_b32 v16, 32, v15
    v_add_u32 v12, s43, v8
    v_mfma_f32_16x16x32_bf16 v[216:219], a[220:223], a[212:215], v[216:219]
    v_mul_f32 v244, s54, v244
    v_mul_f32 v245, s54, v245
    v_mfma_f32_16x16x32_bf16 v[124:127], a[224:227], a[184:187], v[124:127]
    v_mul_f32 v246, s54, v246
    v_mul_f32 v247, s54, v247
    v_mfma_f32_16x16x32_bf16 v[124:127], a[228:231], a[188:191], v[124:127]
    v_cvt_pk_bf16_f32 v94, v244, v245
    v_cvt_pk_bf16_f32 v95, v246, v247
    v_mfma_f32_16x16x32_bf16 v[156:159], a[224:227], a[192:195], v[156:159]
    v_permlane16_swap_b32 v92, v94
    v_permlane16_swap_b32 v93, v95
    v_mfma_f32_16x16x32_bf16 v[156:159], a[228:231], a[196:199], v[156:159]
    ds_write_b128 v19, v[88:91]
    ds_write_b128 v19, v[92:95] offset:1024
    v_mfma_f32_16x16x32_bf16 v[188:191], a[224:227], a[200:203], v[188:191]
    v_mul_f32 v108, s54, v108
    v_mul_f32 v109, s54, v109
    v_mfma_f32_16x16x32_bf16 v[188:191], a[228:231], a[204:207], v[188:191]
    v_mul_f32 v110, s54, v110
    v_mul_f32 v111, s54, v111
    v_mfma_f32_16x16x32_bf16 v[220:223], a[224:227], a[208:211], v[220:223]
    buffer_load_dwordx4 v5, s[20:23], s40 offen offset:2048 nt lds
    v_cvt_pk_bf16_f32 v32, v104, v105
    v_mfma_f32_16x16x32_bf16 v[220:223], a[228:231], a[212:215], v[220:223]
    s_waitcnt lgkmcnt(0)
    v_cvt_pk_bf16_f32 v33, v106, v107
    v_mfma_f32_16x16x32_bf16 v[128:131], a[232:235], a[184:187], v[128:131]
    s_waitcnt vmcnt(7) lgkmcnt(0)
    s_barrier
    v_mfma_f32_16x16x32_bf16 v[128:131], a[236:239], a[188:191], v[128:131]
    ds_read_b128 v[88:91], v18 offset:0
    ds_read_b128 v[92:95], v18 offset:1024
    ds_read_b128 v[96:99], v18 offset:2048
    ds_read_b128 v[100:103], v18 offset:3072
    v_mfma_f32_16x16x32_bf16 v[160:163], a[232:235], a[192:195], v[160:163]
    v_cvt_pk_bf16_f32 v34, v108, v109
    v_cvt_pk_bf16_f32 v35, v110, v111
    v_mfma_f32_16x16x32_bf16 v[160:163], a[236:239], a[196:199], v[160:163]
    v_permlane16_swap_b32 v32, v34
    v_permlane16_swap_b32 v33, v35
    v_mfma_f32_16x16x32_bf16 v[192:195], a[232:235], a[200:203], v[192:195]
    v_mul_f32 v112, s54, v112
    v_mul_f32 v113, s54, v113
    v_mfma_f32_16x16x32_bf16 v[192:195], a[236:239], a[204:207], v[192:195]
    v_mul_f32 v114, s54, v114
    v_mul_f32 v115, s54, v115
    v_mfma_f32_16x16x32_bf16 v[224:227], a[232:235], a[208:211], v[224:227]
    v_mul_f32 v116, s54, v116
    v_mul_f32 v117, s54, v117
    v_mfma_f32_16x16x32_bf16 v[224:227], a[236:239], a[212:215], v[224:227]
    v_mul_f32 v118, s54, v118
    v_mul_f32 v119, s54, v119
    v_mfma_f32_16x16x32_bf16 v[132:135], a[240:243], a[184:187], v[132:135]
    buffer_load_dwordx4 v6, s[20:23], s40 offen offset:3072 nt lds
    v_cvt_pk_bf16_f32 v36, v112, v113
    v_mfma_f32_16x16x32_bf16 v[132:135], a[244:247], a[188:191], v[132:135]
    v_cvt_pk_bf16_f32 v37, v114, v115
    v_cvt_pk_bf16_f32 v38, v116, v117
    v_mfma_f32_16x16x32_bf16 v[164:167], a[240:243], a[192:195], v[164:167]
    v_cvt_pk_bf16_f32 v39, v118, v119
    v_permlane16_swap_b32 v36, v38
    v_mfma_f32_16x16x32_bf16 v[164:167], a[244:247], a[196:199], v[164:167]
    v_permlane16_swap_b32 v37, v39
    v_mul_f32 v120, s54, v120
    v_mfma_f32_16x16x32_bf16 v[196:199], a[240:243], a[200:203], v[196:199]
    v_mul_f32 v121, s54, v121
    v_mul_f32 v122, s54, v122
    v_mfma_f32_16x16x32_bf16 v[196:199], a[244:247], a[204:207], v[196:199]
    v_mul_f32 v123, s54, v123
    v_mul_f32 v124, s54, v124
    v_mfma_f32_16x16x32_bf16 v[228:231], a[240:243], a[208:211], v[228:231]
    v_mul_f32 v125, s54, v125
    v_mul_f32 v126, s54, v126
    v_mfma_f32_16x16x32_bf16 v[228:231], a[244:247], a[212:215], v[228:231]
    v_mul_f32 v127, s54, v127
    ds_read_b128 a[184:187], v11 offset:0
    ds_read_b128 a[188:191], v11 offset:256
    ds_read_b128 a[192:195], v11 offset:512
    ds_read_b128 a[196:199], v11 offset:768
    ds_read_b128 a[200:203], v11 offset:4096
    ds_read_b128 a[204:207], v11 offset:4352
    ds_read_b128 a[208:211], v11 offset:4608
    ds_read_b128 a[212:215], v11 offset:4864
    s_add_u32 m0, s39, 65536
    s_mov_b32 s42, 32768
    buffer_load_dwordx4 v5, s[16:19], s42 offen nt lds
    v_cvt_pk_bf16_f32 v24, v120, v121
    v_cvt_pk_bf16_f32 v25, v122, v123
    v_cvt_pk_bf16_f32 v26, v124, v125
    v_cvt_pk_bf16_f32 v27, v126, v127
    v_mul_f32 v128, s54, v128
    v_permlane16_swap_b32 v24, v26
    v_permlane16_swap_b32 v25, v27
    v_mul_f32 v129, s54, v129
    v_mul_f32 v130, s54, v130
    v_mul_f32 v131, s54, v131
    v_mul_f32 v132, s54, v132
    v_mul_f32 v133, s54, v133
    v_mul_f32 v134, s54, v134
    v_mul_f32 v135, s54, v135
    v_cvt_pk_bf16_f32 v28, v128, v129
    v_cvt_pk_bf16_f32 v29, v130, v131
    v_cvt_pk_bf16_f32 v30, v132, v133
    s_waitcnt lgkmcnt(0)
    v_mfma_f32_16x16x32_bf16 v[232:235], a[184:187], v[88:91], 0
    s_mov_b32 s45, 49152
    v_cvt_pk_bf16_f32 v31, v134, v135
    v_mfma_f32_16x16x32_bf16 v[232:235], a[188:191], v[92:95], v[232:235]
    s_mov_b32 s1, 32768
    v_permlane16_swap_b32 v28, v30
    v_mfma_f32_16x16x32_bf16 v[232:235], a[192:195], v[96:99], v[232:235]
    s_mov_b32 s46, 0
    v_permlane16_swap_b32 v29, v31
    v_mfma_f32_16x16x32_bf16 v[232:235], a[196:199], v[100:103], v[232:235]
    s_mov_b32 s43, 32768
    v_mul_f32 v136, s54, v136
    v_mfma_f32_16x16x32_bf16 v[236:239], a[184:187], v[24:27], 0
    s_mov_b32 s100, 0xffce0000
    v_mul_f32 v137, s54, v137
    v_mfma_f32_16x16x32_bf16 v[236:239], a[188:191], v[28:31], v[236:239]
    s_mov_b32 s28, s96
    v_mul_f32 v138, s54, v138
    v_mfma_f32_16x16x32_bf16 v[236:239], a[192:195], v[32:35], v[236:239]
    s_mov_b32 s29, s97
    v_max3_f32 v252, v252, v232, v233
    v_mfma_f32_16x16x32_bf16 v[236:239], a[196:199], v[36:39], v[236:239]
    s_mov_b32 s30, 0
    v_max3_f32 v252, v252, v234, v235
    s_mov_b32 s31, 0x20000
    v_mov_b32 v20, v252
    s_mov_b32 s101, 0
    buffer_load_dwordx4 v6, s[16:19], s42 offen offset:1024 nt lds
    s_mul_i32 s4, s38, 1179648
    v_permlane32_swap_b32 v20, v252
    s_lshr_b32 s5, s2, 3
    v_max_f32 v252, v252, v20
    s_mul_i32 s5, s5, 4096
    v_mov_b32 v20, v252
    s_add_u32 s4, s4, s5
    v_max3_f32 v248, v248, v236, v237
    s_add_u32 s4, s4, 294912
    v_permlane16_swap_b32 v20, v252
    v_cmp_gt_u32 vcc, 512, v1
    v_max_f32 v252, v252, v20
    v_lshlrev_b32 v22, 3, v1
    v_sub_f32 v120, 0, v252
    v_add_u32 v22, s4, v22
    v_sub_f32 v121, 0, v252
    v_mov_b32 v23, 0x40000000
    v_sub_f32 v122, 0, v252
    v_cndmask_b32 v22, v23, v22, vcc
    v_sub_f32 v123, 0, v252
    v_max3_f32 v248, v248, v238, v239
    v_mov_b32 v253, v248
    v_mul_f32 v139, s54, v139
    v_mul_f32 v140, s54, v140
    v_permlane32_swap_b32 v253, v248
    v_max_f32 v248, v248, v253
    v_mov_b32 v253, v248
    v_mul_f32 v141, s54, v141
    v_mul_f32 v142, s54, v142
    v_permlane16_swap_b32 v253, v248
    v_max_f32 v248, v248, v253
    v_sub_f32 v104, 0, v248
    v_sub_f32 v105, 0, v248
    v_sub_f32 v106, 0, v248
    v_sub_f32 v107, 0, v248
    v_mul_f32 v143, s54, v143
    v_cvt_pk_bf16_f32 v48, v136, v137
    v_cvt_pk_bf16_f32 v49, v138, v139
    v_cvt_pk_bf16_f32 v50, v140, v141
    v_cvt_pk_bf16_f32 v51, v142, v143
    v_mul_f32 v144, s54, v144
    v_permlane16_swap_b32 v48, v50
    v_permlane16_swap_b32 v49, v51
    v_mul_f32 v145, s54, v145
    buffer_load_dwordx4 v5, s[16:19], s42 offen offset:2048 nt lds
    v_mul_f32 v146, s54, v146
    v_mul_f32 v147, s54, v147
    v_mul_f32 v148, s54, v148
    v_mul_f32 v149, s54, v149
    v_mul_f32 v150, s54, v150
    v_mul_f32 v151, s54, v151
    v_cvt_pk_bf16_f32 v52, v144, v145
    v_cvt_pk_bf16_f32 v53, v146, v147
    v_cvt_pk_bf16_f32 v54, v148, v149
    v_cvt_pk_bf16_f32 v55, v150, v151
    v_mul_f32 v152, s54, v152
    v_permlane16_swap_b32 v52, v54
    v_permlane16_swap_b32 v53, v55
    v_mul_f32 v153, s54, v153
    v_mul_f32 v154, s54, v154
    v_mul_f32 v155, s54, v155
    v_mul_f32 v156, s54, v156
    v_mul_f32 v157, s54, v157
    v_mul_f32 v158, s54, v158
    v_mul_f32 v159, s54, v159
    v_cvt_pk_bf16_f32 v40, v152, v153
    v_cvt_pk_bf16_f32 v41, v154, v155
    v_cvt_pk_bf16_f32 v42, v156, v157
    v_cvt_pk_bf16_f32 v43, v158, v159
    v_mul_f32 v160, s54, v160
    v_permlane16_swap_b32 v40, v42
    v_permlane16_swap_b32 v41, v43
    v_mul_f32 v161, s54, v161
    v_mul_f32 v162, s54, v162
    v_mul_f32 v163, s54, v163
    v_mul_f32 v164, s54, v164
    v_mul_f32 v165, s54, v165
    v_mul_f32 v166, s54, v166
    v_mul_f32 v167, s54, v167
    v_cvt_pk_bf16_f32 v44, v160, v161
    v_cvt_pk_bf16_f32 v45, v162, v163
    v_cvt_pk_bf16_f32 v46, v164, v165
    v_cvt_pk_bf16_f32 v47, v166, v167
    v_mul_f32 v168, s54, v168
    v_permlane16_swap_b32 v44, v46
    v_permlane16_swap_b32 v45, v47
    v_mul_f32 v169, s54, v169
    v_mul_f32 v170, s54, v170
    v_mfma_f32_16x16x32_bf16 v[240:243], a[184:187], v[40:43], 0
    buffer_load_dwordx4 v6, s[16:19], s42 offen offset:3072 nt lds
    v_mul_f32 v171, s54, v171
    v_mfma_f32_16x16x32_bf16 v[240:243], a[188:191], v[44:47], v[240:243]
    v_mul_f32 v172, s54, v172
    v_mul_f32 v173, s54, v173
    v_mfma_f32_16x16x32_bf16 v[240:243], a[192:195], v[48:51], v[240:243]
    v_mul_f32 v174, s54, v174
    v_mul_f32 v175, s54, v175
    v_mfma_f32_16x16x32_bf16 v[240:243], a[196:199], v[52:55], v[240:243]
    v_cvt_pk_bf16_f32 v64, v168, v169
    v_cvt_pk_bf16_f32 v65, v170, v171
    v_mfma_f32_16x16x32_bf16 v[244:247], a[200:203], v[88:91], v[120:123]
    v_cvt_pk_bf16_f32 v66, v172, v173
    v_cvt_pk_bf16_f32 v67, v174, v175
    v_mfma_f32_16x16x32_bf16 v[244:247], a[204:207], v[92:95], v[244:247]
    v_permlane16_swap_b32 v64, v66
    v_permlane16_swap_b32 v65, v67
    v_mfma_f32_16x16x32_bf16 v[244:247], a[208:211], v[96:99], v[244:247]
    v_max3_f32 v249, v249, v240, v241
    v_max3_f32 v249, v249, v242, v243
    v_mfma_f32_16x16x32_bf16 v[244:247], a[212:215], v[100:103], v[244:247]
    v_mov_b32 v254, v249
    v_mul_f32 v176, s54, v176
    v_mfma_f32_16x16x32_bf16 v[164:167], a[200:203], v[24:27], v[104:107]
    v_permlane32_swap_b32 v254, v249
    v_max_f32 v249, v249, v254
    v_mfma_f32_16x16x32_bf16 v[164:167], a[204:207], v[28:31], v[164:167]
    v_mov_b32 v254, v249
    v_mul_f32 v177, s54, v177
    v_mfma_f32_16x16x32_bf16 v[164:167], a[208:211], v[32:35], v[164:167]
    v_permlane16_swap_b32 v254, v249
    v_max_f32 v249, v249, v254
    v_mfma_f32_16x16x32_bf16 v[164:167], a[212:215], v[36:39], v[164:167]
    v_sub_f32 v108, 0, v249
    v_sub_f32 v109, 0, v249
    v_sub_f32 v110, 0, v249
    v_sub_f32 v111, 0, v249
    v_mul_f32 v178, s54, v178
    v_mul_f32 v179, s54, v179
    v_mul_f32 v180, s54, v180
    v_mul_f32 v181, s54, v181
    v_mul_f32 v182, s54, v182
    v_mul_f32 v183, s54, v183
    v_cvt_pk_bf16_f32 v68, v176, v177
    v_cvt_pk_bf16_f32 v69, v178, v179
    s_add_u32 m0, s39, 81920
    s_mov_b32 s42, 16384
    buffer_load_dwordx4 v5, s[20:23], s42 offen nt lds
    v_cvt_pk_bf16_f32 v70, v180, v181
    v_cvt_pk_bf16_f32 v71, v182, v183
    v_mul_f32 v184, s54, v184
    v_permlane16_swap_b32 v68, v70
    v_permlane16_swap_b32 v69, v71
    v_mul_f32 v185, s54, v185
    v_mul_f32 v186, s54, v186
    v_mul_f32 v187, s54, v187
    v_mul_f32 v188, s54, v188
    v_mul_f32 v189, s54, v189
    v_mul_f32 v190, s54, v190
    v_mul_f32 v191, s54, v191
    v_cvt_pk_bf16_f32 v56, v184, v185
    v_cvt_pk_bf16_f32 v57, v186, v187
    v_cvt_pk_bf16_f32 v58, v188, v189
    v_cvt_pk_bf16_f32 v59, v190, v191
    v_mul_f32 v192, s54, v192
    v_permlane16_swap_b32 v56, v58
    v_permlane16_swap_b32 v57, v59
    v_mul_f32 v193, s54, v193
    v_mul_f32 v194, s54, v194
    v_mul_f32 v195, s54, v195
    v_mul_f32 v196, s54, v196
    v_mul_f32 v197, s54, v197
    v_mul_f32 v198, s54, v198
    v_mul_f32 v199, s54, v199
    v_cvt_pk_bf16_f32 v60, v192, v193
    v_cvt_pk_bf16_f32 v61, v194, v195
    v_cvt_pk_bf16_f32 v62, v196, v197
    v_cvt_pk_bf16_f32 v63, v198, v199
    v_mul_f32 v200, s54, v200
    v_permlane16_swap_b32 v60, v62
    v_permlane16_swap_b32 v61, v63
    v_mul_f32 v201, s54, v201
    v_mul_f32 v202, s54, v202
    v_mfma_f32_16x16x32_bf16 v[168:171], a[184:187], v[56:59], 0
    v_mul_f32 v203, s54, v203
    v_mul_f32 v204, s54, v204
    v_mfma_f32_16x16x32_bf16 v[168:171], a[188:191], v[60:63], v[168:171]
    v_mul_f32 v205, s54, v205
    v_mul_f32 v206, s54, v206
    v_mfma_f32_16x16x32_bf16 v[168:171], a[192:195], v[64:67], v[168:171]
    v_mul_f32 v207, s54, v207
    v_cvt_pk_bf16_f32 v80, v200, v201
    v_mfma_f32_16x16x32_bf16 v[168:171], a[196:199], v[68:71], v[168:171]
    buffer_load_dwordx4 v6, s[20:23], s42 offen offset:1024 nt lds
    v_cvt_pk_bf16_f32 v81, v202, v203
    v_mfma_f32_16x16x32_bf16 v[172:175], a[200:203], v[40:43], v[108:111]
    v_cvt_pk_bf16_f32 v82, v204, v205
    v_cvt_pk_bf16_f32 v83, v206, v207
    v_mfma_f32_16x16x32_bf16 v[172:175], a[204:207], v[44:47], v[172:175]
    v_permlane16_swap_b32 v80, v82
    v_permlane16_swap_b32 v81, v83
    v_mfma_f32_16x16x32_bf16 v[172:175], a[208:211], v[48:51], v[172:175]
    v_max3_f32 v250, v250, v168, v169
    v_max3_f32 v250, v250, v170, v171
    v_mfma_f32_16x16x32_bf16 v[172:175], a[212:215], v[52:55], v[172:175]
    v_mov_b32 v255, v250
    v_mul_f32 v208, s54, v208
    v_mul_f32 v209, s54, v209
    v_permlane32_swap_b32 v255, v250
    v_max_f32 v250, v250, v255
    v_mov_b32 v255, v250
    v_mul_f32 v210, s54, v210
    v_mul_f32 v211, s54, v211
    v_permlane16_swap_b32 v255, v250
    v_max_f32 v250, v250, v255
    v_sub_f32 v112, 0, v250
    v_sub_f32 v113, 0, v250
    v_sub_f32 v114, 0, v250
    v_sub_f32 v115, 0, v250
    v_mul_f32 v212, s54, v212
    v_mul_f32 v213, s54, v213
    v_mul_f32 v214, s54, v214
    v_mul_f32 v215, s54, v215
    v_cvt_pk_bf16_f32 v84, v208, v209
    v_cvt_pk_bf16_f32 v85, v210, v211
    v_cvt_pk_bf16_f32 v86, v212, v213
    v_cvt_pk_bf16_f32 v87, v214, v215
    v_mul_f32 v216, s54, v216
    v_permlane16_swap_b32 v84, v86
    v_permlane16_swap_b32 v85, v87
    v_mul_f32 v217, s54, v217
    v_mul_f32 v218, s54, v218
    v_mul_f32 v219, s54, v219
    v_mul_f32 v220, s54, v220
    v_mul_f32 v221, s54, v221
    v_mul_f32 v222, s54, v222
    v_mul_f32 v223, s54, v223
    v_cvt_pk_bf16_f32 v72, v216, v217
    buffer_load_dwordx4 v5, s[20:23], s42 offen offset:2048 nt lds
    v_cvt_pk_bf16_f32 v73, v218, v219
    v_cvt_pk_bf16_f32 v74, v220, v221
    v_cvt_pk_bf16_f32 v75, v222, v223
    v_mul_f32 v224, s54, v224
    v_permlane16_swap_b32 v72, v74
    v_permlane16_swap_b32 v73, v75
    v_mul_f32 v225, s54, v225
    v_mul_f32 v226, s54, v226
    v_mul_f32 v227, s54, v227
    v_mul_f32 v228, s54, v228
    v_mul_f32 v229, s54, v229
    v_mul_f32 v230, s54, v230
    v_mul_f32 v231, s54, v231
    v_cvt_pk_bf16_f32 v76, v224, v225
    v_cvt_pk_bf16_f32 v77, v226, v227
    v_cvt_pk_bf16_f32 v78, v228, v229
    v_cvt_pk_bf16_f32 v79, v230, v231
    v_sub_f32 v232, v232, v252
    v_permlane16_swap_b32 v76, v78
    v_permlane16_swap_b32 v77, v79
    v_exp_f32 v232, v232
    v_sub_f32 v233, v233, v252
    v_mfma_f32_16x16x32_bf16 v[176:179], a[184:187], v[72:75], 0
    v_exp_f32 v233, v233
    v_mfma_f32_16x16x32_bf16 v[176:179], a[188:191], v[76:79], v[176:179]
    v_sub_f32 v234, v234, v252
    v_exp_f32 v234, v234
    v_mfma_f32_16x16x32_bf16 v[176:179], a[192:195], v[80:83], v[176:179]
    v_sub_f32 v235, v235, v252
    v_exp_f32 v235, v235
    v_mfma_f32_16x16x32_bf16 v[176:179], a[196:199], v[84:87], v[176:179]
    v_cvt_pk_bf16_f32 v156, v232, v233
    v_cvt_pk_bf16_f32 v157, v234, v235
    v_mfma_f32_16x16x32_bf16 v[180:183], a[200:203], v[56:59], v[112:115]
    ds_read_b128 a[184:187], v12 offset:0
    ds_read_b128 a[188:191], v12 offset:256
    v_mfma_f32_16x16x32_bf16 v[180:183], a[204:207], v[60:63], v[180:183]
    ds_read_b128 a[192:195], v12 offset:512
    ds_read_b128 a[196:199], v12 offset:768
    v_mfma_f32_16x16x32_bf16 v[180:183], a[208:211], v[64:67], v[180:183]
    v_max3_f32 v251, v251, v176, v177
    v_max3_f32 v251, v251, v178, v179
    v_mfma_f32_16x16x32_bf16 v[180:183], a[212:215], v[68:71], v[180:183]
    v_mov_b32 v19, v251
    buffer_load_dwordx4 v6, s[20:23], s42 offen offset:3072 nt lds
    v_sub_f32 v236, v236, v248
    v_permlane32_swap_b32 v19, v251
    v_max_f32 v251, v251, v19
    v_mov_b32 v19, v251
    v_exp_f32 v236, v236
    v_sub_f32 v237, v237, v248
    v_permlane16_swap_b32 v19, v251
    v_max_f32 v251, v251, v19
    v_sub_f32 v116, 0, v251
    v_sub_f32 v117, 0, v251
    v_sub_f32 v118, 0, v251
    v_sub_f32 v119, 0, v251
    v_exp_f32 v237, v237
    v_sub_f32 v238, v238, v248
    v_mfma_f32_16x16x32_bf16 v[184:187], a[200:203], v[72:75], v[116:119]
    v_exp_f32 v238, v238
    v_mfma_f32_16x16x32_bf16 v[184:187], a[204:207], v[76:79], v[184:187]
    v_sub_f32 v239, v239, v248
    s_waitcnt lgkmcnt(0)
    v_mfma_f32_16x16x32_bf16 v[184:187], a[208:211], v[80:83], v[184:187]
    v_exp_f32 v239, v239
    v_mfma_f32_16x16x32_bf16 v[184:187], a[212:215], v[84:87], v[184:187]
    v_cvt_pk_bf16_f32 v124, v236, v237
    v_cvt_pk_bf16_f32 v125, v238, v239
    v_mfma_f32_16x16x32_bf16 v[188:191], a[184:187], v[24:27], v[104:107]
    ds_read_b128 a[200:203], v12 offset:4096
    ds_read_b128 a[204:207], v12 offset:4352
    v_mfma_f32_16x16x32_bf16 v[188:191], a[188:191], v[28:31], v[188:191]
    ds_read_b128 a[208:211], v12 offset:4608
    ds_read_b128 a[212:215], v12 offset:4864
    v_mfma_f32_16x16x32_bf16 v[188:191], a[192:195], v[32:35], v[188:191]
    v_sub_f32 v240, v240, v249
    v_exp_f32 v240, v240
    v_mfma_f32_16x16x32_bf16 v[188:191], a[196:199], v[36:39], v[188:191]
    v_sub_f32 v241, v241, v249
    v_exp_f32 v241, v241
    v_mfma_f32_16x16x32_bf16 v[192:195], a[184:187], v[40:43], v[108:111]
    v_sub_f32 v242, v242, v249
    v_exp_f32 v242, v242
    v_mfma_f32_16x16x32_bf16 v[192:195], a[188:191], v[44:47], v[192:195]
    v_sub_f32 v243, v243, v249
    v_exp_f32 v243, v243
    v_mfma_f32_16x16x32_bf16 v[192:195], a[192:195], v[48:51], v[192:195]
    v_cvt_pk_bf16_f32 v132, v240, v241
    v_cvt_pk_bf16_f32 v133, v242, v243
    v_mfma_f32_16x16x32_bf16 v[192:195], a[196:199], v[52:55], v[192:195]
    v_exp_f32 v244, v244
    v_mfma_f32_16x16x32_bf16 v[196:199], a[184:187], v[56:59], v[112:115]
    v_exp_f32 v245, v245
    v_mfma_f32_16x16x32_bf16 v[196:199], a[188:191], v[60:63], v[196:199]
    v_exp_f32 v246, v246
    v_mfma_f32_16x16x32_bf16 v[196:199], a[192:195], v[64:67], v[196:199]
    v_exp_f32 v247, v247
    v_mfma_f32_16x16x32_bf16 v[196:199], a[196:199], v[68:71], v[196:199]
    s_waitcnt lgkmcnt(0)
    v_add_u32 v11, s43, v7
    v_mfma_f32_16x16x32_bf16 v[200:203], a[184:187], v[72:75], v[116:119]
    v_add_u32 v13, s43, v9
    v_add_u32 v15, s43, v10
    v_mfma_f32_16x16x32_bf16 v[200:203], a[188:191], v[76:79], v[200:203]
    v_xor_b32 v14, 32, v13
    v_xor_b32 v16, 32, v15
    v_mfma_f32_16x16x32_bf16 v[200:203], a[192:195], v[80:83], v[200:203]
    v_add_u32 v12, s43, v8
    s_waitcnt vmcnt(8)
    s_barrier
    buffer_load_dword v0, v22, s[28:31], s101 offen sc1
    v_mfma_f32_16x16x32_bf16 v[200:203], a[196:199], v[84:87], v[200:203]
    ds_read_b64_tr_b16 a[216:217], v13 offset:16384
    v_cvt_pk_bf16_f32 v158, v244, v245
    v_mfma_f32_16x16x32_bf16 v[204:207], a[200:203], v[24:27], v[104:107]
    ds_read_b64_tr_b16 a[218:219], v13 offset:20480
    ds_read_b128 a[184:187], v11 offset:0
    v_mfma_f32_16x16x32_bf16 v[204:207], a[204:207], v[28:31], v[204:207]
    ds_read_b64_tr_b16 a[220:221], v15 offset:16384
    ds_read_b128 a[188:191], v11 offset:256
    v_mfma_f32_16x16x32_bf16 v[204:207], a[208:211], v[32:35], v[204:207]
    ds_read_b64_tr_b16 a[222:223], v15 offset:20480
    ds_read_b128 a[192:195], v11 offset:512
    v_mfma_f32_16x16x32_bf16 v[204:207], a[212:215], v[36:39], v[204:207]
    ds_read_b64_tr_b16 a[224:225], v14 offset:16384
    ds_read_b128 a[196:199], v11 offset:768
    v_mfma_f32_16x16x32_bf16 v[208:211], a[200:203], v[40:43], v[108:111]
    ds_read_b64_tr_b16 a[226:227], v14 offset:20480
    v_cvt_pk_bf16_f32 v159, v246, v247
    v_mfma_f32_16x16x32_bf16 v[208:211], a[204:207], v[44:47], v[208:211]
    ds_read_b64_tr_b16 a[228:229], v16 offset:16384
    v_exp_f32 v164, v164
    v_mfma_f32_16x16x32_bf16 v[208:211], a[208:211], v[48:51], v[208:211]
    ds_read_b64_tr_b16 a[230:231], v16 offset:20480
    v_exp_f32 v165, v165
    v_mfma_f32_16x16x32_bf16 v[208:211], a[212:215], v[52:55], v[208:211]
    v_exp_f32 v166, v166
    v_mfma_f32_16x16x32_bf16 v[212:215], a[200:203], v[56:59], v[112:115]
    v_exp_f32 v167, v167
    v_mfma_f32_16x16x32_bf16 v[212:215], a[204:207], v[60:63], v[212:215]
    v_cvt_pk_bf16_f32 v126, v164, v165
    v_cvt_pk_bf16_f32 v127, v166, v167
    v_mfma_f32_16x16x32_bf16 v[212:215], a[208:211], v[64:67], v[212:215]
    v_sub_f32 v168, v168, v250
    v_exp_f32 v168, v168
    v_mfma_f32_16x16x32_bf16 v[212:215], a[212:215], v[68:71], v[212:215]
    v_sub_f32 v169, v169, v250
    v_exp_f32 v169, v169
    v_mfma_f32_16x16x32_bf16 v[216:219], a[200:203], v[72:75], v[116:119]
    v_sub_f32 v170, v170, v250
    v_exp_f32 v170, v170
    v_mfma_f32_16x16x32_bf16 v[216:219], a[204:207], v[76:79], v[216:219]
    v_sub_f32 v171, v171, v250
    v_exp_f32 v171, v171
    v_mfma_f32_16x16x32_bf16 v[216:219], a[208:211], v[80:83], v[216:219]
    v_cvt_pk_bf16_f32 v140, v168, v169
    v_cvt_pk_bf16_f32 v141, v170, v171
    v_mfma_f32_16x16x32_bf16 v[216:219], a[212:215], v[84:87], v[216:219]
    v_exp_f32 v172, v172
    v_exp_f32 v173, v173
    v_exp_f32 v174, v174
    v_exp_f32 v175, v175
    v_cvt_pk_bf16_f32 v134, v172, v173
    v_cvt_pk_bf16_f32 v135, v174, v175
    v_sub_f32 v176, v176, v251
    v_exp_f32 v176, v176
    v_sub_f32 v177, v177, v251
    v_exp_f32 v177, v177
    v_sub_f32 v178, v178, v251
    v_exp_f32 v178, v178
    v_sub_f32 v179, v179, v251
    v_exp_f32 v179, v179
    v_cvt_pk_bf16_f32 v148, v176, v177
    v_cvt_pk_bf16_f32 v149, v178, v179
    v_exp_f32 v180, v180
    v_exp_f32 v181, v181
    v_exp_f32 v182, v182
    v_exp_f32 v183, v183
    v_cvt_pk_bf16_f32 v142, v180, v181
    v_cvt_pk_bf16_f32 v143, v182, v183
    v_exp_f32 v184, v184
    v_exp_f32 v185, v185
    v_exp_f32 v186, v186
    v_exp_f32 v187, v187
    v_cvt_pk_bf16_f32 v150, v184, v185
    v_cvt_pk_bf16_f32 v151, v186, v187
    v_exp_f32 v188, v188
    v_exp_f32 v189, v189
    v_exp_f32 v190, v190
    v_exp_f32 v191, v191
    v_cvt_pk_bf16_f32 v128, v188, v189
    v_cvt_pk_bf16_f32 v129, v190, v191
    v_exp_f32 v192, v192
    v_exp_f32 v193, v193
    v_exp_f32 v194, v194
    v_exp_f32 v195, v195
    v_cvt_pk_bf16_f32 v136, v192, v193
    v_cvt_pk_bf16_f32 v137, v194, v195
    v_exp_f32 v196, v196
    v_exp_f32 v197, v197
    v_exp_f32 v198, v198
    v_exp_f32 v199, v199
    v_cvt_pk_bf16_f32 v144, v196, v197
    v_cvt_pk_bf16_f32 v145, v198, v199
    v_exp_f32 v200, v200
    v_exp_f32 v201, v201
    v_exp_f32 v202, v202
    v_exp_f32 v203, v203
    v_cvt_pk_bf16_f32 v152, v200, v201
    v_cvt_pk_bf16_f32 v153, v202, v203
    v_exp_f32 v204, v204
    v_exp_f32 v205, v205
    v_exp_f32 v206, v206
    v_exp_f32 v207, v207
    v_cvt_pk_bf16_f32 v130, v204, v205
    v_cvt_pk_bf16_f32 v131, v206, v207
    v_exp_f32 v208, v208
    v_exp_f32 v209, v209
    v_exp_f32 v210, v210
    v_exp_f32 v211, v211
    v_cvt_pk_bf16_f32 v138, v208, v209
    v_cvt_pk_bf16_f32 v139, v210, v211
    v_exp_f32 v212, v212
    v_exp_f32 v213, v213
    v_exp_f32 v214, v214
    v_exp_f32 v215, v215
    v_cvt_pk_bf16_f32 v146, v212, v213
    v_cvt_pk_bf16_f32 v147, v214, v215
    v_exp_f32 v216, v216
    v_exp_f32 v217, v217
    v_exp_f32 v218, v218
    v_exp_f32 v219, v219
    v_cvt_pk_bf16_f32 v154, v216, v217
    v_cvt_pk_bf16_f32 v155, v218, v219
    s_waitcnt lgkmcnt(0)
    s_branch L1_enter
L1_even:
    v_mfma_f32_16x16x32_bf16 v[112:115], a[232:235], a[184:187], v[112:115]
    s_lshl_b32 s42, s38, 11
    s_add_u32 s42, s42, 16384
    v_mfma_f32_16x16x32_bf16 v[112:115], a[236:239], a[188:191], v[112:115]
    ds_read_b64_tr_b16 a[224:225], v16 offset:0
    ds_read_b64_tr_b16 a[226:227], v16 offset:1024
    v_mfma_f32_16x16x32_bf16 v[144:147], a[232:235], a[192:195], v[144:147]
    ds_read_b64_tr_b16 a[228:229], v16 offset:8192
    ds_read_b64_tr_b16 a[230:231], v16 offset:9216
    v_mfma_f32_16x16x32_bf16 v[144:147], a[236:239], a[196:199], v[144:147]
    buffer_load_dwordx4 v6, s[16:19], s40 offen offset:3072 nt lds
    v_add_u32 v19, s42, v1
    v_mfma_f32_16x16x32_bf16 v[176:179], a[232:235], a[200:203], v[176:179]
    s_and_b32 s42, s42, 0xfffff000
    v_add_u32 v18, s42, v1
    v_mfma_f32_16x16x32_bf16 v[176:179], a[236:239], a[204:207], v[176:179]
    v_mul_f32 v232, s54, v232
    v_mul_f32 v233, s54, v233
    v_mfma_f32_16x16x32_bf16 v[208:211], a[232:235], a[208:211], v[208:211]
    v_mul_f32 v234, s54, v234
    v_mul_f32 v235, s54, v235
    v_mfma_f32_16x16x32_bf16 v[208:211], a[236:239], a[212:215], v[208:211]
    v_mul_f32 v236, s54, v236
    v_mul_f32 v237, s54, v237
    v_mfma_f32_16x16x32_bf16 v[240:243], a[232:235], a[248:251], v[240:243]
    v_mul_f32 v238, s54, v238
    v_mul_f32 v239, s54, v239
    v_mfma_f32_16x16x32_bf16 v[240:243], a[236:239], a[252:255], v[240:243]
    s_waitcnt lgkmcnt(0)
    v_cvt_pk_bf16_f32 v88, v232, v233
    v_mfma_f32_16x16x32_bf16 v[116:119], a[240:243], a[184:187], v[116:119]
    v_cvt_pk_bf16_f32 v89, v234, v235
    v_cvt_pk_bf16_f32 v90, v236, v237
    v_mfma_f32_16x16x32_bf16 v[116:119], a[244:247], a[188:191], v[116:119]
    ds_read_b64_tr_b16 a[232:233], v15 offset:256
    ds_read_b64_tr_b16 a[234:235], v15 offset:1280
    v_mfma_f32_16x16x32_bf16 v[148:151], a[240:243], a[192:195], v[148:151]
    ds_read_b64_tr_b16 a[236:237], v15 offset:8448
    ds_read_b64_tr_b16 a[238:239], v15 offset:9472
    v_mfma_f32_16x16x32_bf16 v[148:151], a[244:247], a[196:199], v[148:151]
    s_add_u32 m0, s39, 49152
    s_mov_b32 s40, 0
    v_mfma_f32_16x16x32_bf16 v[180:183], a[240:243], a[200:203], v[180:183]
    buffer_load_dwordx4 v5, s[20:23], s40 offen nt lds
    v_cvt_pk_bf16_f32 v91, v238, v239
    v_mfma_f32_16x16x32_bf16 v[180:183], a[244:247], a[204:207], v[180:183]
    v_permlane16_swap_b32 v88, v90
    v_permlane16_swap_b32 v89, v91
    v_mfma_f32_16x16x32_bf16 v[212:215], a[240:243], a[208:211], v[212:215]
    v_mul_f32 v240, s54, v240
    v_mul_f32 v241, s54, v241
    v_mfma_f32_16x16x32_bf16 v[212:215], a[244:247], a[212:215], v[212:215]
    v_mul_f32 v242, s54, v242
    v_mul_f32 v243, s54, v243
    v_mfma_f32_16x16x32_bf16 v[244:247], a[240:243], a[248:251], v[244:247]
    v_cvt_pk_bf16_f32 v92, v240, v241
    v_cvt_pk_bf16_f32 v93, v242, v243
    v_mfma_f32_16x16x32_bf16 v[244:247], a[244:247], a[252:255], v[244:247]
    v_mul_f32 v104, s54, v104
    v_mul_f32 v105, s54, v105
    v_mfma_f32_16x16x32_bf16 v[120:123], a[216:219], a[184:187], v[120:123]
    v_mul_f32 v106, s54, v106
    v_mul_f32 v107, s54, v107
    v_mfma_f32_16x16x32_bf16 v[120:123], a[220:223], a[188:191], v[120:123]
    ds_read_b64_tr_b16 a[240:241], v16 offset:256
    ds_read_b64_tr_b16 a[242:243], v16 offset:1280
    v_mfma_f32_16x16x32_bf16 v[152:155], a[216:219], a[192:195], v[152:155]
    ds_read_b64_tr_b16 a[244:245], v16 offset:8448
    ds_read_b64_tr_b16 a[246:247], v16 offset:9472
    v_mfma_f32_16x16x32_bf16 v[152:155], a[220:223], a[196:199], v[152:155]
    s_mov_b32 s43, 0
    v_add_u32 v11, s43, v7
    v_mfma_f32_16x16x32_bf16 v[184:187], a[216:219], a[200:203], v[184:187]
    buffer_load_dwordx4 v6, s[20:23], s40 offen offset:1024 nt lds
    v_add_u32 v13, s43, v9
    v_mfma_f32_16x16x32_bf16 v[184:187], a[220:223], a[204:207], v[184:187]
    v_add_u32 v15, s43, v10
    v_xor_b32 v14, 32, v13
    v_mfma_f32_16x16x32_bf16 v[216:219], a[216:219], a[208:211], v[216:219]
    v_xor_b32 v16, 32, v15
    v_add_u32 v12, s43, v8
    v_mfma_f32_16x16x32_bf16 v[216:219], a[220:223], a[212:215], v[216:219]
    v_mul_f32 v244, s54, v244
    v_mul_f32 v245, s54, v245
    v_mfma_f32_16x16x32_bf16 v[124:127], a[224:227], a[184:187], v[124:127]
    v_mul_f32 v246, s54, v246
    v_mul_f32 v247, s54, v247
    v_mfma_f32_16x16x32_bf16 v[124:127], a[228:231], a[188:191], v[124:127]
    v_cvt_pk_bf16_f32 v94, v244, v245
    v_cvt_pk_bf16_f32 v95, v246, v247
    v_mfma_f32_16x16x32_bf16 v[156:159], a[224:227], a[192:195], v[156:159]
    v_permlane16_swap_b32 v92, v94
    v_permlane16_swap_b32 v93, v95
    v_mfma_f32_16x16x32_bf16 v[156:159], a[228:231], a[196:199], v[156:159]
    ds_write_b128 v19, v[88:91]
    ds_write_b128 v19, v[92:95] offset:1024
    v_mfma_f32_16x16x32_bf16 v[188:191], a[224:227], a[200:203], v[188:191]
    v_mul_f32 v108, s54, v108
    v_mul_f32 v109, s54, v109
    v_mfma_f32_16x16x32_bf16 v[188:191], a[228:231], a[204:207], v[188:191]
    v_mul_f32 v110, s54, v110
    v_mul_f32 v111, s54, v111
    v_mfma_f32_16x16x32_bf16 v[220:223], a[224:227], a[208:211], v[220:223]
    buffer_load_dwordx4 v5, s[20:23], s40 offen offset:2048 nt lds
    v_cvt_pk_bf16_f32 v24, v104, v105
    v_mfma_f32_16x16x32_bf16 v[220:223], a[228:231], a[212:215], v[220:223]
    s_waitcnt lgkmcnt(0)
    v_cvt_pk_bf16_f32 v25, v106, v107
    v_mfma_f32_16x16x32_bf16 v[128:131], a[232:235], a[184:187], v[128:131]
    s_waitcnt vmcnt(7) lgkmcnt(0)
    s_barrier
    v_mfma_f32_16x16x32_bf16 v[128:131], a[236:239], a[188:191], v[128:131]
    ds_read_b128 v[88:91], v18 offset:0
    ds_read_b128 v[92:95], v18 offset:1024
    ds_read_b128 v[96:99], v18 offset:2048
    ds_read_b128 v[100:103], v18 offset:3072
    v_mfma_f32_16x16x32_bf16 v[160:163], a[232:235], a[192:195], v[160:163]
    v_cvt_pk_bf16_f32 v26, v108, v109
    v_cvt_pk_bf16_f32 v27, v110, v111
    v_mfma_f32_16x16x32_bf16 v[160:163], a[236:239], a[196:199], v[160:163]
    v_permlane16_swap_b32 v24, v26
    v_permlane16_swap_b32 v25, v27
    v_mfma_f32_16x16x32_bf16 v[192:195], a[232:235], a[200:203], v[192:195]
    v_mul_f32 v112, s54, v112
    v_mul_f32 v113, s54, v113
    v_mfma_f32_16x16x32_bf16 v[192:195], a[236:239], a[204:207], v[192:195]
    v_mul_f32 v114, s54, v114
    v_mul_f32 v115, s54, v115
    v_mfma_f32_16x16x32_bf16 v[224:227], a[232:235], a[208:211], v[224:227]
    v_mul_f32 v116, s54, v116
    v_mul_f32 v117, s54, v117
    v_mfma_f32_16x16x32_bf16 v[224:227], a[236:239], a[212:215], v[224:227]
    v_mul_f32 v118, s54, v118
    v_mul_f32 v119, s54, v119
    v_mfma_f32_16x16x32_bf16 v[132:135], a[240:243], a[184:187], v[132:135]
    buffer_load_dwordx4 v6, s[20:23], s40 offen offset:3072 nt lds
    v_cvt_pk_bf16_f32 v28, v112, v113
    v_mfma_f32_16x16x32_bf16 v[132:135], a[244:247], a[188:191], v[132:135]
    v_cvt_pk_bf16_f32 v29, v114, v115
    v_cvt_pk_bf16_f32 v30, v116, v117
    v_mfma_f32_16x16x32_bf16 v[164:167], a[240:243], a[192:195], v[164:167]
    v_cvt_pk_bf16_f32 v31, v118, v119
    v_permlane16_swap_b32 v28, v30
    v_mfma_f32_16x16x32_bf16 v[164:167], a[244:247], a[196:199], v[164:167]
    v_permlane16_swap_b32 v29, v31
    v_mul_f32 v120, s54, v120
    v_mfma_f32_16x16x32_bf16 v[196:199], a[240:243], a[200:203], v[196:199]
    v_mul_f32 v121, s54, v121
    v_mul_f32 v122, s54, v122
    v_mfma_f32_16x16x32_bf16 v[196:199], a[244:247], a[204:207], v[196:199]
    v_mul_f32 v123, s54, v123
    v_mul_f32 v124, s54, v124
    v_mfma_f32_16x16x32_bf16 v[228:231], a[240:243], a[208:211], v[228:231]
    v_mul_f32 v125, s54, v125
    v_mul_f32 v126, s54, v126
    v_mfma_f32_16x16x32_bf16 v[228:231], a[244:247], a[212:215], v[228:231]
    v_mul_f32 v127, s54, v127
    ds_read_b128 a[184:187], v11 offset:0
    ds_read_b128 a[188:191], v11 offset:256
    ds_read_b128 a[192:195], v11 offset:512
    ds_read_b128 a[196:199], v11 offset:768
    ds_read_b128 a[200:203], v11 offset:4096
    ds_read_b128 a[204:207], v11 offset:4352
    ds_read_b128 a[208:211], v11 offset:4608
    ds_read_b128 a[212:215], v11 offset:4864
    s_add_u32 m0, s39, 65536
    s_mov_b32 s42, 32768
    buffer_load_dwordx4 v5, s[16:19], s42 offen nt lds
    v_cvt_pk_bf16_f32 v32, v120, v121
    v_cvt_pk_bf16_f32 v33, v122, v123
    v_cvt_pk_bf16_f32 v34, v124, v125
    v_cvt_pk_bf16_f32 v35, v126, v127
    v_mul_f32 v128, s54, v128
    v_permlane16_swap_b32 v32, v34
    v_permlane16_swap_b32 v33, v35
    v_mul_f32 v129, s54, v129
    v_mul_f32 v130, s54, v130
    v_mul_f32 v131, s54, v131
    v_mul_f32 v132, s54, v132
    v_mul_f32 v133, s54, v133
    v_mul_f32 v134, s54, v134
    v_mul_f32 v135, s54, v135
    v_cvt_pk_bf16_f32 v36, v128, v129
    v_cvt_pk_bf16_f32 v37, v130, v131
    v_cvt_pk_bf16_f32 v38, v132, v133
    s_waitcnt lgkmcnt(0)
    v_mfma_f32_16x16x32_bf16 v[232:235], a[184:187], v[88:91], 0
    s_mov_b32 s45, 49152
    v_cvt_pk_bf16_f32 v39, v134, v135
    v_mfma_f32_16x16x32_bf16 v[232:235], a[188:191], v[92:95], v[232:235]
    s_mov_b32 s1, 32768
    v_permlane16_swap_b32 v36, v38
    v_mfma_f32_16x16x32_bf16 v[232:235], a[192:195], v[96:99], v[232:235]
    s_mov_b32 s46, 0
    v_permlane16_swap_b32 v37, v39
    v_mfma_f32_16x16x32_bf16 v[232:235], a[196:199], v[100:103], v[232:235]
    s_mov_b32 s43, 32768
    v_mul_f32 v136, s54, v136
    v_mfma_f32_16x16x32_bf16 v[236:239], a[184:187], v[24:27], 0
    s_mov_b32 s100, 0xffce0000
    v_mul_f32 v137, s54, v137
    v_mfma_f32_16x16x32_bf16 v[236:239], a[188:191], v[28:31], v[236:239]
    s_mov_b32 s28, s96
    v_mul_f32 v138, s54, v138
    v_mfma_f32_16x16x32_bf16 v[236:239], a[192:195], v[32:35], v[236:239]
    s_mov_b32 s29, s97
    v_max3_f32 v252, v252, v232, v233
    v_mfma_f32_16x16x32_bf16 v[236:239], a[196:199], v[36:39], v[236:239]
    s_mov_b32 s30, 0
    v_max3_f32 v252, v252, v234, v235
    s_mov_b32 s31, 0x20000
    v_mov_b32 v20, v252
    s_mov_b32 s101, 0
    buffer_load_dwordx4 v6, s[16:19], s42 offen offset:1024 nt lds
    s_mul_i32 s4, s38, 1179648
    v_permlane32_swap_b32 v20, v252
    s_lshr_b32 s5, s2, 3
    v_max_f32 v252, v252, v20
    s_mul_i32 s5, s5, 4096
    v_mov_b32 v20, v252
    s_add_u32 s4, s4, s5
    v_max3_f32 v248, v248, v236, v237
    s_add_u32 s4, s4, 294912
    v_permlane16_swap_b32 v20, v252
    v_cmp_gt_u32 vcc, 512, v1
    v_max_f32 v252, v252, v20
    v_lshlrev_b32 v22, 3, v1
    v_sub_f32 v120, 0, v252
    v_add_u32 v22, s4, v22
    v_sub_f32 v121, 0, v252
    v_mov_b32 v23, 0x40000000
    v_sub_f32 v122, 0, v252
    v_cndmask_b32 v22, v23, v22, vcc
    v_sub_f32 v123, 0, v252
    v_max3_f32 v248, v248, v238, v239
    v_mov_b32 v253, v248
    v_mul_f32 v139, s54, v139
    v_mul_f32 v140, s54, v140
    v_permlane32_swap_b32 v253, v248
    v_max_f32 v248, v248, v253
    v_mov_b32 v253, v248
    v_mul_f32 v141, s54, v141
    v_mul_f32 v142, s54, v142
    v_permlane16_swap_b32 v253, v248
    v_max_f32 v248, v248, v253
    v_sub_f32 v104, 0, v248
    v_sub_f32 v105, 0, v248
    v_sub_f32 v106, 0, v248
    v_sub_f32 v107, 0, v248
    v_mul_f32 v143, s54, v143
    v_cvt_pk_bf16_f32 v40, v136, v137
    v_cvt_pk_bf16_f32 v41, v138, v139
    v_cvt_pk_bf16_f32 v42, v140, v141
    v_cvt_pk_bf16_f32 v43, v142, v143
    v_mul_f32 v144, s54, v144
    v_permlane16_swap_b32 v40, v42
    v_permlane16_swap_b32 v41, v43
    v_mul_f32 v145, s54, v145
    buffer_load_dwordx4 v5, s[16:19], s42 offen offset:2048 nt lds
    v_mul_f32 v146, s54, v146
    v_mul_f32 v147, s54, v147
    v_mul_f32 v148, s54, v148
    v_mul_f32 v149, s54, v149
    v_mul_f32 v150, s54, v150
    v_mul_f32 v151, s54, v151
    v_cvt_pk_bf16_f32 v44, v144, v145
    v_cvt_pk_bf16_f32 v45, v146, v147
    v_cvt_pk_bf16_f32 v46, v148, v149
    v_cvt_pk_bf16_f32 v47, v150, v151
    v_mul_f32 v152, s54, v152
    v_permlane16_swap_b32 v44, v46
    v_permlane16_swap_b32 v45, v47
    v_mul_f32 v153, s54, v153
    v_mul_f32 v154, s54, v154
    v_mul_f32 v155, s54, v155
    v_mul_f32 v156, s54, v156
    v_mul_f32 v157, s54, v157
    v_mul_f32 v158, s54, v158
    v_mul_f32 v159, s54, v159
    v_cvt_pk_bf16_f32 v48, v152, v153
    v_cvt_pk_bf16_f32 v49, v154, v155
    v_cvt_pk_bf16_f32 v50, v156, v157
    v_cvt_pk_bf16_f32 v51, v158, v159
    v_mul_f32 v160, s54, v160
    v_permlane16_swap_b32 v48, v50
    v_permlane16_swap_b32 v49, v51
    v_mul_f32 v161, s54, v161
    v_mul_f32 v162, s54, v162
    v_mul_f32 v163, s54, v163
    v_mul_f32 v164, s54, v164
    v_mul_f32 v165, s54, v165
    v_mul_f32 v166, s54, v166
    v_mul_f32 v167, s54, v167
    v_cvt_pk_bf16_f32 v52, v160, v161
    v_cvt_pk_bf16_f32 v53, v162, v163
    v_cvt_pk_bf16_f32 v54, v164, v165
    v_cvt_pk_bf16_f32 v55, v166, v167
    v_mul_f32 v168, s54, v168
    v_permlane16_swap_b32 v52, v54
    v_permlane16_swap_b32 v53, v55
    v_mul_f32 v169, s54, v169
    v_mul_f32 v170, s54, v170
    v_mfma_f32_16x16x32_bf16 v[240:243], a[184:187], v[40:43], 0
    buffer_load_dwordx4 v6, s[16:19], s42 offen offset:3072 nt lds
    v_mul_f32 v171, s54, v171
    v_mfma_f32_16x16x32_bf16 v[240:243], a[188:191], v[44:47], v[240:243]
    v_mul_f32 v172, s54, v172
    v_mul_f32 v173, s54, v173
    v_mfma_f32_16x16x32_bf16 v[240:243], a[192:195], v[48:51], v[240:243]
    v_mul_f32 v174, s54, v174
    v_mul_f32 v175, s54, v175
    v_mfma_f32_16x16x32_bf16 v[240:243], a[196:199], v[52:55], v[240:243]
    v_cvt_pk_bf16_f32 v56, v168, v169
    v_cvt_pk_bf16_f32 v57, v170, v171
    v_mfma_f32_16x16x32_bf16 v[244:247], a[200:203], v[88:91], v[120:123]
    v_cvt_pk_bf16_f32 v58, v172, v173
    v_cvt_pk_bf16_f32 v59, v174, v175
    v_mfma_f32_16x16x32_bf16 v[244:247], a[204:207], v[92:95], v[244:247]
    v_permlane16_swap_b32 v56, v58
    v_permlane16_swap_b32 v57, v59
    v_mfma_f32_16x16x32_bf16 v[244:247], a[208:211], v[96:99], v[244:247]
    v_max3_f32 v249, v249, v240, v241
    v_max3_f32 v249, v249, v242, v243
    v_mfma_f32_16x16x32_bf16 v[244:247], a[212:215], v[100:103], v[244:247]
    v_mov_b32 v254, v249
    v_mul_f32 v176, s54, v176
    v_mfma_f32_16x16x32_bf16 v[164:167], a[200:203], v[24:27], v[104:107]
    v_permlane32_swap_b32 v254, v249
    v_max_f32 v249, v249, v254
    v_mfma_f32_16x16x32_bf16 v[164:167], a[204:207], v[28:31], v[164:167]
    v_mov_b32 v254, v249
    v_mul_f32 v177, s54, v177
    v_mfma_f32_16x16x32_bf16 v[164:167], a[208:211], v[32:35], v[164:167]
    v_permlane16_swap_b32 v254, v249
    v_max_f32 v249, v249, v254
    v_mfma_f32_16x16x32_bf16 v[164:167], a[212:215], v[36:39], v[164:167]
    v_sub_f32 v108, 0, v249
    v_sub_f32 v109, 0, v249
    v_sub_f32 v110, 0, v249
    v_sub_f32 v111, 0, v249
    v_mul_f32 v178, s54, v178
    v_mul_f32 v179, s54, v179
    v_mul_f32 v180, s54, v180
    v_mul_f32 v181, s54, v181
    v_mul_f32 v182, s54, v182
    v_mul_f32 v183, s54, v183
    v_cvt_pk_bf16_f32 v60, v176, v177
    v_cvt_pk_bf16_f32 v61, v178, v179
    s_add_u32 m0, s39, 81920
    s_mov_b32 s42, 16384
    buffer_load_dwordx4 v5, s[20:23], s42 offen nt lds
    v_cvt_pk_bf16_f32 v62, v180, v181
    v_cvt_pk_bf16_f32 v63, v182, v183
    v_mul_f32 v184, s54, v184
    v_permlane16_swap_b32 v60, v62
    v_permlane16_swap_b32 v61, v63
    v_mul_f32 v185, s54, v185
    v_mul_f32 v186, s54, v186
    v_mul_f32 v187, s54, v187
    v_mul_f32 v188, s54, v188
    v_mul_f32 v189, s54, v189
    v_mul_f32 v190, s54, v190
    v_mul_f32 v191, s54, v191
    v_cvt_pk_bf16_f32 v64, v184, v185
    v_cvt_pk_bf16_f32 v65, v186, v187
    v_cvt_pk_bf16_f32 v66, v188, v189
    v_cvt_pk_bf16_f32 v67, v190, v191
    v_mul_f32 v192, s54, v192
    v_permlane16_swap_b32 v64, v66
    v_permlane16_swap_b32 v65, v67
    v_mul_f32 v193, s54, v193
    v_mul_f32 v194, s54, v194
    v_mul_f32 v195, s54, v195
    v_mul_f32 v196, s54, v196
    v_mul_f32 v197, s54, v197
    v_mul_f32 v198, s54, v198
    v_mul_f32 v199, s54, v199
    v_cvt_pk_bf16_f32 v68, v192, v193
    v_cvt_pk_bf16_f32 v69, v194, v195
    v_cvt_pk_bf16_f32 v70, v196, v197
    v_cvt_pk_bf16_f32 v71, v198, v199
    v_mul_f32 v200, s54, v200
    v_permlane16_swap_b32 v68, v70
    v_permlane16_swap_b32 v69, v71
    v_mul_f32 v201, s54, v201
    v_mul_f32 v202, s54, v202
    v_mfma_f32_16x16x32_bf16 v[168:171], a[184:187], v[56:59], 0
    v_mul_f32 v203, s54, v203
    v_mul_f32 v204, s54, v204
    v_mfma_f32_16x16x32_bf16 v[168:171], a[188:191], v[60:63], v[168:171]
    v_mul_f32 v205, s54, v205
    v_mul_f32 v206, s54, v206
    v_mfma_f32_16x16x32_bf16 v[168:171], a[192:195], v[64:67], v[168:171]
    v_mul_f32 v207, s54, v207
    v_cvt_pk_bf16_f32 v72, v200, v201
    v_mfma_f32_16x16x32_bf16 v[168:171], a[196:199], v[68:71], v[168:171]
    buffer_load_dwordx4 v6, s[20:23], s42 offen offset:1024 nt lds
    v_cvt_pk_bf16_f32 v73, v202, v203
    v_mfma_f32_16x16x32_bf16 v[172:175], a[200:203], v[40:43], v[108:111]
    v_cvt_pk_bf16_f32 v74, v204, v205
    v_cvt_pk_bf16_f32 v75, v206, v207
    v_mfma_f32_16x16x32_bf16 v[172:175], a[204:207], v[44:47], v[172:175]
    v_permlane16_swap_b32 v72, v74
    v_permlane16_swap_b32 v73, v75
    v_mfma_f32_16x16x32_bf16 v[172:175], a[208:211], v[48:51], v[172:175]
    v_max3_f32 v250, v250, v168, v169
    v_max3_f32 v250, v250, v170, v171
    v_mfma_f32_16x16x32_bf16 v[172:175], a[212:215], v[52:55], v[172:175]
    v_mov_b32 v255, v250
    v_mul_f32 v208, s54, v208
    v_mul_f32 v209, s54, v209
    v_permlane32_swap_b32 v255, v250
    v_max_f32 v250, v250, v255
    v_mov_b32 v255, v250
    v_mul_f32 v210, s54, v210
    v_mul_f32 v211, s54, v211
    v_permlane16_swap_b32 v255, v250
    v_max_f32 v250, v250, v255
    v_sub_f32 v112, 0, v250
    v_sub_f32 v113, 0, v250
    v_sub_f32 v114, 0, v250
    v_sub_f32 v115, 0, v250
    v_mul_f32 v212, s54, v212
    v_mul_f32 v213, s54, v213
    v_mul_f32 v214, s54, v214
    v_mul_f32 v215, s54, v215
    v_cvt_pk_bf16_f32 v76, v208, v209
    v_cvt_pk_bf16_f32 v77, v210, v211
    v_cvt_pk_bf16_f32 v78, v212, v213
    v_cvt_pk_bf16_f32 v79, v214, v215
    v_mul_f32 v216, s54, v216
    v_permlane16_swap_b32 v76, v78
    v_permlane16_swap_b32 v77, v79
    v_mul_f32 v217, s54, v217
    v_mul_f32 v218, s54, v218
    v_mul_f32 v219, s54, v219
    v_mul_f32 v220, s54, v220
    v_mul_f32 v221, s54, v221
    v_mul_f32 v222, s54, v222
    v_mul_f32 v223, s54, v223
    v_cvt_pk_bf16_f32 v80, v216, v217
    buffer_load_dwordx4 v5, s[20:23], s42 offen offset:2048 nt lds
    v_cvt_pk_bf16_f32 v81, v218, v219
    v_cvt_pk_bf16_f32 v82, v220, v221
    v_cvt_pk_bf16_f32 v83, v222, v223
    v_mul_f32 v224, s54, v224
    v_permlane16_swap_b32 v80, v82
    v_permlane16_swap_b32 v81, v83
    v_mul_f32 v225, s54, v225
    v_mul_f32 v226, s54, v226
    v_mul_f32 v227, s54, v227
    v_mul_f32 v228, s54, v228
    v_mul_f32 v229, s54, v229
    v_mul_f32 v230, s54, v230
    v_mul_f32 v231, s54, v231
    v_cvt_pk_bf16_f32 v84, v224, v225
    v_cvt_pk_bf16_f32 v85, v226, v227
    v_cvt_pk_bf16_f32 v86, v228, v229
    v_cvt_pk_bf16_f32 v87, v230, v231
    v_sub_f32 v232, v232, v252
    v_permlane16_swap_b32 v84, v86
    v_permlane16_swap_b32 v85, v87
    v_exp_f32 v232, v232
    v_sub_f32 v233, v233, v252
    v_mfma_f32_16x16x32_bf16 v[176:179], a[184:187], v[72:75], 0
    v_exp_f32 v233, v233
    v_mfma_f32_16x16x32_bf16 v[176:179], a[188:191], v[76:79], v[176:179]
    v_sub_f32 v234, v234, v252
    v_exp_f32 v234, v234
    v_mfma_f32_16x16x32_bf16 v[176:179], a[192:195], v[80:83], v[176:179]
    v_sub_f32 v235, v235, v252
    v_exp_f32 v235, v235
    v_mfma_f32_16x16x32_bf16 v[176:179], a[196:199], v[84:87], v[176:179]
    v_cvt_pk_bf16_f32 v156, v232, v233
    v_cvt_pk_bf16_f32 v157, v234, v235
    v_mfma_f32_16x16x32_bf16 v[180:183], a[200:203], v[56:59], v[112:115]
    ds_read_b128 a[184:187], v12 offset:0
    ds_read_b128 a[188:191], v12 offset:256
    v_mfma_f32_16x16x32_bf16 v[180:183], a[204:207], v[60:63], v[180:183]
    ds_read_b128 a[192:195], v12 offset:512
    ds_read_b128 a[196:199], v12 offset:768
    v_mfma_f32_16x16x32_bf16 v[180:183], a[208:211], v[64:67], v[180:183]
    v_max3_f32 v251, v251, v176, v177
    v_max3_f32 v251, v251, v178, v179
    v_mfma_f32_16x16x32_bf16 v[180:183], a[212:215], v[68:71], v[180:183]
    v_mov_b32 v19, v251
    buffer_load_dwordx4 v6, s[20:23], s42 offen offset:3072 nt lds
    v_sub_f32 v236, v236, v248
    v_permlane32_swap_b32 v19, v251
    v_max_f32 v251, v251, v19
    v_mov_b32 v19, v251
    v_exp_f32 v236, v236
    v_sub_f32 v237, v237, v248
    v_permlane16_swap_b32 v19, v251
    v_max_f32 v251, v251, v19
    v_sub_f32 v116, 0, v251
    v_sub_f32 v117, 0, v251
    v_sub_f32 v118, 0, v251
    v_sub_f32 v119, 0, v251
    v_exp_f32 v237, v237
    v_sub_f32 v238, v238, v248
    v_mfma_f32_16x16x32_bf16 v[184:187], a[200:203], v[72:75], v[116:119]
    v_exp_f32 v238, v238
    v_mfma_f32_16x16x32_bf16 v[184:187], a[204:207], v[76:79], v[184:187]
    v_sub_f32 v239, v239, v248
    s_waitcnt lgkmcnt(0)
    v_mfma_f32_16x16x32_bf16 v[184:187], a[208:211], v[80:83], v[184:187]
    v_exp_f32 v239, v239
    v_mfma_f32_16x16x32_bf16 v[184:187], a[212:215], v[84:87], v[184:187]
    v_cvt_pk_bf16_f32 v124, v236, v237
    v_cvt_pk_bf16_f32 v125, v238, v239
    v_mfma_f32_16x16x32_bf16 v[188:191], a[184:187], v[24:27], v[104:107]
    ds_read_b128 a[200:203], v12 offset:4096
    ds_read_b128 a[204:207], v12 offset:4352
    v_mfma_f32_16x16x32_bf16 v[188:191], a[188:191], v[28:31], v[188:191]
    ds_read_b128 a[208:211], v12 offset:4608
    ds_read_b128 a[212:215], v12 offset:4864
    v_mfma_f32_16x16x32_bf16 v[188:191], a[192:195], v[32:35], v[188:191]
    v_sub_f32 v240, v240, v249
    v_exp_f32 v240, v240
    v_mfma_f32_16x16x32_bf16 v[188:191], a[196:199], v[36:39], v[188:191]
    v_sub_f32 v241, v241, v249
    v_exp_f32 v241, v241
    v_mfma_f32_16x16x32_bf16 v[192:195], a[184:187], v[40:43], v[108:111]
    v_sub_f32 v242, v242, v249
    v_exp_f32 v242, v242
    v_mfma_f32_16x16x32_bf16 v[192:195], a[188:191], v[44:47], v[192:195]
    v_sub_f32 v243, v243, v249
    v_exp_f32 v243, v243
    v_mfma_f32_16x16x32_bf16 v[192:195], a[192:195], v[48:51], v[192:195]
    v_cvt_pk_bf16_f32 v132, v240, v241
    v_cvt_pk_bf16_f32 v133, v242, v243
    v_mfma_f32_16x16x32_bf16 v[192:195], a[196:199], v[52:55], v[192:195]
    v_exp_f32 v244, v244
    v_mfma_f32_16x16x32_bf16 v[196:199], a[184:187], v[56:59], v[112:115]
    v_exp_f32 v245, v245
    v_mfma_f32_16x16x32_bf16 v[196:199], a[188:191], v[60:63], v[196:199]
    v_exp_f32 v246, v246
    v_mfma_f32_16x16x32_bf16 v[196:199], a[192:195], v[64:67], v[196:199]
    v_exp_f32 v247, v247
    v_mfma_f32_16x16x32_bf16 v[196:199], a[196:199], v[68:71], v[196:199]
    s_waitcnt lgkmcnt(0)
    v_add_u32 v11, s43, v7
    v_mfma_f32_16x16x32_bf16 v[200:203], a[184:187], v[72:75], v[116:119]
    v_add_u32 v13, s43, v9
    v_add_u32 v15, s43, v10
    v_mfma_f32_16x16x32_bf16 v[200:203], a[188:191], v[76:79], v[200:203]
    v_xor_b32 v14, 32, v13
    v_xor_b32 v16, 32, v15
    v_mfma_f32_16x16x32_bf16 v[200:203], a[192:195], v[80:83], v[200:203]
    v_add_u32 v12, s43, v8
    s_waitcnt vmcnt(8)
    s_barrier
    buffer_load_dword v0, v22, s[28:31], s101 offen sc1
    v_mfma_f32_16x16x32_bf16 v[200:203], a[196:199], v[84:87], v[200:203]
    ds_read_b64_tr_b16 a[216:217], v13 offset:16384
    v_cvt_pk_bf16_f32 v158, v244, v245
    v_mfma_f32_16x16x32_bf16 v[204:207], a[200:203], v[24:27], v[104:107]
    ds_read_b64_tr_b16 a[218:219], v13 offset:20480
    ds_read_b128 a[184:187], v11 offset:0
    v_mfma_f32_16x16x32_bf16 v[204:207], a[204:207], v[28:31], v[204:207]
    ds_read_b64_tr_b16 a[220:221], v15 offset:16384
    ds_read_b128 a[188:191], v11 offset:256
    v_mfma_f32_16x16x32_bf16 v[204:207], a[208:211], v[32:35], v[204:207]
    ds_read_b64_tr_b16 a[222:223], v15 offset:20480
    ds_read_b128 a[192:195], v11 offset:512
    v_mfma_f32_16x16x32_bf16 v[204:207], a[212:215], v[36:39], v[204:207]
    ds_read_b64_tr_b16 a[224:225], v14 offset:16384
    ds_read_b128 a[196:199], v11 offset:768
    v_mfma_f32_16x16x32_bf16 v[208:211], a[200:203], v[40:43], v[108:111]
    ds_read_b64_tr_b16 a[226:227], v14 offset:20480
    v_cvt_pk_bf16_f32 v159, v246, v247
    v_mfma_f32_16x16x32_bf16 v[208:211], a[204:207], v[44:47], v[208:211]
    ds_read_b64_tr_b16 a[228:229], v16 offset:16384
    v_exp_f32 v164, v164
    v_mfma_f32_16x16x32_bf16 v[208:211], a[208:211], v[48:51], v[208:211]
    ds_read_b64_tr_b16 a[230:231], v16 offset:20480
    v_exp_f32 v165, v165
    v_mfma_f32_16x16x32_bf16 v[208:211], a[212:215], v[52:55], v[208:211]
    v_exp_f32 v166, v166
    v_mfma_f32_16x16x32_bf16 v[212:215], a[200:203], v[56:59], v[112:115]
    v_exp_f32 v167, v167
    v_mfma_f32_16x16x32_bf16 v[212:215], a[204:207], v[60:63], v[212:215]
    v_cvt_pk_bf16_f32 v126, v164, v165
    v_cvt_pk_bf16_f32 v127, v166, v167
    v_mfma_f32_16x16x32_bf16 v[212:215], a[208:211], v[64:67], v[212:215]
    v_sub_f32 v168, v168, v250
    v_exp_f32 v168, v168
    v_mfma_f32_16x16x32_bf16 v[212:215], a[212:215], v[68:71], v[212:215]
    v_sub_f32 v169, v169, v250
    v_exp_f32 v169, v169
    v_mfma_f32_16x16x32_bf16 v[216:219], a[200:203], v[72:75], v[116:119]
    v_sub_f32 v170, v170, v250
    v_exp_f32 v170, v170
    v_mfma_f32_16x16x32_bf16 v[216:219], a[204:207], v[76:79], v[216:219]
    v_sub_f32 v171, v171, v250
    v_exp_f32 v171, v171
    v_mfma_f32_16x16x32_bf16 v[216:219], a[208:211], v[80:83], v[216:219]
    v_cvt_pk_bf16_f32 v140, v168, v169
    v_cvt_pk_bf16_f32 v141, v170, v171
    v_mfma_f32_16x16x32_bf16 v[216:219], a[212:215], v[84:87], v[216:219]
    v_exp_f32 v172, v172
    v_exp_f32 v173, v173
    v_exp_f32 v174, v174
    v_exp_f32 v175, v175
    v_cvt_pk_bf16_f32 v134, v172, v173
    v_cvt_pk_bf16_f32 v135, v174, v175
    v_sub_f32 v176, v176, v251
    v_exp_f32 v176, v176
    v_sub_f32 v177, v177, v251
    v_exp_f32 v177, v177
    v_sub_f32 v178, v178, v251
    v_exp_f32 v178, v178
    v_sub_f32 v179, v179, v251
    v_exp_f32 v179, v179
    v_cvt_pk_bf16_f32 v148, v176, v177
    v_cvt_pk_bf16_f32 v149, v178, v179
    v_exp_f32 v180, v180
    v_exp_f32 v181, v181
    v_exp_f32 v182, v182
    v_exp_f32 v183, v183
    v_cvt_pk_bf16_f32 v142, v180, v181
    v_cvt_pk_bf16_f32 v143, v182, v183
    v_exp_f32 v184, v184
    v_exp_f32 v185, v185
    v_exp_f32 v186, v186
    v_exp_f32 v187, v187
    v_cvt_pk_bf16_f32 v150, v184, v185
    v_cvt_pk_bf16_f32 v151, v186, v187
    v_exp_f32 v188, v188
    v_exp_f32 v189, v189
    v_exp_f32 v190, v190
    v_exp_f32 v191, v191
    v_cvt_pk_bf16_f32 v128, v188, v189
    v_cvt_pk_bf16_f32 v129, v190, v191
    v_exp_f32 v192, v192
    v_exp_f32 v193, v193
    v_exp_f32 v194, v194
    v_exp_f32 v195, v195
    v_cvt_pk_bf16_f32 v136, v192, v193
    v_cvt_pk_bf16_f32 v137, v194, v195
    v_exp_f32 v196, v196
    v_exp_f32 v197, v197
    v_exp_f32 v198, v198
    v_exp_f32 v199, v199
    v_cvt_pk_bf16_f32 v144, v196, v197
    v_cvt_pk_bf16_f32 v145, v198, v199
    v_exp_f32 v200, v200
    v_exp_f32 v201, v201
    v_exp_f32 v202, v202
    v_exp_f32 v203, v203
    v_cvt_pk_bf16_f32 v152, v200, v201
    v_cvt_pk_bf16_f32 v153, v202, v203
    v_exp_f32 v204, v204
    v_exp_f32 v205, v205
    v_exp_f32 v206, v206
    v_exp_f32 v207, v207
    v_cvt_pk_bf16_f32 v130, v204, v205
    v_cvt_pk_bf16_f32 v131, v206, v207
    v_exp_f32 v208, v208
    v_exp_f32 v209, v209
    v_exp_f32 v210, v210
    v_exp_f32 v211, v211
    v_cvt_pk_bf16_f32 v138, v208, v209
    v_cvt_pk_bf16_f32 v139, v210, v211
    v_exp_f32 v212, v212
    v_exp_f32 v213, v213
    v_exp_f32 v214, v214
    v_exp_f32 v215, v215
    v_cvt_pk_bf16_f32 v146, v212, v213
    v_cvt_pk_bf16_f32 v147, v214, v215
    v_exp_f32 v216, v216
    v_exp_f32 v217, v217
    v_exp_f32 v218, v218
    v_exp_f32 v219, v219
    v_cvt_pk_bf16_f32 v154, v216, v217
    v_cvt_pk_bf16_f32 v155, v218, v219
    s_waitcnt lgkmcnt(0)
L1_enter:
.p2align 6
L1_loop:
    v_mfma_f32_16x16x32_bf16 v[204:207], a[184:187], v[24:27], v[104:107]
    ds_read_b128 a[200:203], v11 offset:4096
    v_mfma_f32_16x16x32_bf16 v[204:207], a[188:191], v[28:31], v[204:207]
    ds_read_b128 a[204:207], v11 offset:4352
    s_add_u32 s41, s43, 65536
    v_mfma_f32_16x16x32_bf16 v[204:207], a[192:195], v[32:35], v[204:207]
    ds_read_b128 a[208:211], v11 offset:4608
    s_sub_u32 s40, s41, 163840
    v_mfma_f32_16x16x32_bf16 v[204:207], a[196:199], v[36:39], v[204:207]
    ds_read_b128 a[212:215], v11 offset:4864
    s_min_u32 s41, s41, s40
    v_mfma_f32_16x16x32_bf16 a[0:3], a[216:219], v[124:127], a[0:3]
    ds_read_b64_tr_b16 a[232:233], v13 offset:16640
    s_add_u32 s41, s41, s39
    v_mfma_f32_16x16x32_bf16 a[0:3], a[220:223], v[128:131], a[0:3]
    ds_read_b64_tr_b16 a[234:235], v13 offset:20736
    s_add_u32 s43, s43, 32768
    v_mfma_f32_16x16x32_bf16 a[32:35], a[216:219], v[132:135], a[32:35]
    ds_read_b64_tr_b16 a[236:237], v15 offset:16640
    s_sub_u32 s40, s43, 163840
    v_mfma_f32_16x16x32_bf16 a[32:35], a[220:223], v[136:139], a[32:35]
    ds_read_b64_tr_b16 a[238:239], v15 offset:20736
    s_min_u32 s43, s43, s40
    v_mfma_f32_16x16x32_bf16 v[208:211], a[184:187], v[40:43], v[108:111]
    s_mov_b32 m0, s41
    v_add_u32 v11, s43, v7
    v_mfma_f32_16x16x32_bf16 v[208:211], a[188:191], v[44:47], v[208:211]
    v_exp_f32 v204, v204
    v_mfma_f32_16x16x32_bf16 v[208:211], a[192:195], v[48:51], v[208:211]
    v_mfma_f32_16x16x32_bf16 v[208:211], a[196:199], v[52:55], v[208:211]
    v_exp_f32 v205, v205
    v_mfma_f32_16x16x32_bf16 a[64:67], a[216:219], v[140:143], a[64:67]
    v_cvt_pk_bf16_f32 v164, v204, v205
    v_mfma_f32_16x16x32_bf16 a[64:67], a[220:223], v[144:147], a[64:67]
    v_exp_f32 v206, v206
    v_mfma_f32_16x16x32_bf16 a[96:99], a[216:219], v[148:151], a[96:99]
    v_mfma_f32_16x16x32_bf16 a[96:99], a[220:223], v[152:155], a[96:99]
    v_exp_f32 v207, v207
    v_mfma_f32_16x16x32_bf16 v[212:215], a[184:187], v[56:59], v[112:115]
    v_cvt_pk_bf16_f32 v165, v206, v207
    v_mfma_f32_16x16x32_bf16 v[212:215], a[188:191], v[60:63], v[212:215]
    v_exp_f32 v208, v208
    v_mfma_f32_16x16x32_bf16 v[212:215], a[192:195], v[64:67], v[212:215]
    buffer_load_dwordx4 v5, s[16:19], s45 offen nt lds
    v_mfma_f32_16x16x32_bf16 v[212:215], a[196:199], v[68:71], v[212:215]
    v_exp_f32 v209, v209
    v_mfma_f32_16x16x32_bf16 a[128:131], a[216:219], v[156:159], a[128:131]
    ds_read_b64_tr_b16 a[240:241], v14 offset:16640
    v_cvt_pk_bf16_f32 v172, v208, v209
    v_mfma_f32_16x16x32_bf16 a[160:163], a[180:183], v[124:127], a[160:163]
    v_exp_f32 v210, v210
    v_mfma_f32_16x16x32_bf16 a[4:7], a[224:227], v[124:127], a[4:7]
    ds_read_b64_tr_b16 a[242:243], v14 offset:20736
    s_add_u32 s46, s46, 1
    v_mfma_f32_16x16x32_bf16 a[4:7], a[228:231], v[128:131], a[4:7]
    v_exp_f32 v211, v211
    v_mfma_f32_16x16x32_bf16 v[204:207], a[184:187], v[72:75], v[116:119]
    ds_read_b64_tr_b16 a[244:245], v16 offset:16640
    v_cvt_pk_bf16_f32 v173, v210, v211
    v_mfma_f32_16x16x32_bf16 v[204:207], a[188:191], v[76:79], v[204:207]
    v_exp_f32 v212, v212
    v_mfma_f32_16x16x32_bf16 v[204:207], a[192:195], v[80:83], v[204:207]
    ds_read_b64_tr_b16 a[246:247], v16 offset:20736
    v_mfma_f32_16x16x32_bf16 v[204:207], a[196:199], v[84:87], v[204:207]
    v_exp_f32 v213, v213
    v_mfma_f32_16x16x32_bf16 a[36:39], a[224:227], v[132:135], a[36:39]
    v_cvt_pk_bf16_f32 v180, v212, v213
    v_mfma_f32_16x16x32_bf16 a[36:39], a[228:231], v[136:139], a[36:39]
    v_exp_f32 v214, v214
    v_mfma_f32_16x16x32_bf16 a[68:71], a[224:227], v[140:143], a[68:71]
    buffer_load_dwordx4 v6, s[16:19], s45 offen offset:1024 nt lds
    v_mfma_f32_16x16x32_bf16 a[68:71], a[228:231], v[144:147], a[68:71]
    v_exp_f32 v215, v215
    v_mfma_f32_16x16x32_bf16 v[208:211], a[184:187], v[88:91], v[120:123]
    v_cvt_pk_bf16_f32 v181, v214, v215
    v_mfma_f32_16x16x32_bf16 v[208:211], a[188:191], v[92:95], v[208:211]
    v_exp_f32 v204, v204
    v_mfma_f32_16x16x32_bf16 v[208:211], a[192:195], v[96:99], v[208:211]
    v_mfma_f32_16x16x32_bf16 v[208:211], a[196:199], v[100:103], v[208:211]
    v_exp_f32 v205, v205
    v_mfma_f32_16x16x32_bf16 a[100:103], a[224:227], v[148:151], a[100:103]
    v_cvt_pk_bf16_f32 v188, v204, v205
    v_mfma_f32_16x16x32_bf16 a[100:103], a[228:231], v[152:155], a[100:103]
    v_exp_f32 v206, v206
    v_mfma_f32_16x16x32_bf16 a[132:135], a[224:227], v[156:159], a[132:135]
    s_waitcnt lgkmcnt(0)
    ds_read_b128 a[184:187], v12 offset:0
    v_mfma_f32_16x16x32_bf16 a[160:163], a[180:183], v[128:131], a[160:163]
    v_exp_f32 v207, v207
    v_mfma_f32_16x16x32_bf16 v[212:215], a[200:203], v[24:27], v[104:107]
    ds_read_b128 a[188:191], v12 offset:256
    v_cvt_pk_bf16_f32 v189, v206, v207
    v_mfma_f32_16x16x32_bf16 v[212:215], a[204:207], v[28:31], v[212:215]
    v_exp_f32 v208, v208
    v_mfma_f32_16x16x32_bf16 v[212:215], a[208:211], v[32:35], v[212:215]
    buffer_load_dwordx4 v5, s[16:19], s45 offen offset:2048 nt lds
    v_mfma_f32_16x16x32_bf16 v[212:215], a[212:215], v[36:39], v[212:215]
    v_exp_f32 v209, v209
    v_mfma_f32_16x16x32_bf16 a[8:11], a[232:235], v[124:127], a[8:11]
    ds_read_b128 a[192:195], v12 offset:512
    v_cvt_pk_bf16_f32 v196, v208, v209
    v_mfma_f32_16x16x32_bf16 a[8:11], a[236:239], v[128:131], a[8:11]
    v_exp_f32 v210, v210
    v_mfma_f32_16x16x32_bf16 a[40:43], a[232:235], v[132:135], a[40:43]
    ds_read_b128 a[196:199], v12 offset:768
    v_mfma_f32_16x16x32_bf16 a[40:43], a[236:239], v[136:139], a[40:43]
    v_exp_f32 v211, v211
    v_mfma_f32_16x16x32_bf16 v[204:207], a[200:203], v[40:43], v[108:111]
    ds_read_b64_tr_b16 a[216:217], v13 offset:16896
    v_cvt_pk_bf16_f32 v197, v210, v211
    v_mfma_f32_16x16x32_bf16 v[204:207], a[204:207], v[44:47], v[204:207]
    v_exp_f32 v212, v212
    v_mfma_f32_16x16x32_bf16 v[204:207], a[208:211], v[48:51], v[204:207]
    ds_read_b64_tr_b16 a[218:219], v13 offset:20992
    v_mfma_f32_16x16x32_bf16 v[204:207], a[212:215], v[52:55], v[204:207]
    v_exp_f32 v213, v213
    v_mfma_f32_16x16x32_bf16 a[72:75], a[232:235], v[140:143], a[72:75]
    ds_read_b64_tr_b16 a[220:221], v15 offset:16896
    v_cvt_pk_bf16_f32 v166, v212, v213
    v_mfma_f32_16x16x32_bf16 a[72:75], a[236:239], v[144:147], a[72:75]
    v_exp_f32 v214, v214
    v_mfma_f32_16x16x32_bf16 a[104:107], a[232:235], v[148:151], a[104:107]
    buffer_load_dwordx4 v6, s[16:19], s45 offen offset:3072 nt lds
    v_mfma_f32_16x16x32_bf16 a[104:107], a[236:239], v[152:155], a[104:107]
    v_exp_f32 v215, v215
    v_mfma_f32_16x16x32_bf16 v[208:211], a[200:203], v[56:59], v[112:115]
    ds_read_b64_tr_b16 a[222:223], v15 offset:20992
    v_cvt_pk_bf16_f32 v167, v214, v215
    v_mfma_f32_16x16x32_bf16 v[208:211], a[204:207], v[60:63], v[208:211]
    v_exp_f32 v204, v204
    v_mfma_f32_16x16x32_bf16 v[208:211], a[208:211], v[64:67], v[208:211]
    ds_read_b64_tr_b16 a[224:225], v14 offset:16896
    s_add_u32 m0, s41, 16384
    v_mfma_f32_16x16x32_bf16 v[208:211], a[212:215], v[68:71], v[208:211]
    v_exp_f32 v205, v205
    v_mfma_f32_16x16x32_bf16 a[136:139], a[232:235], v[156:159], a[136:139]
    ds_read_b64_tr_b16 a[226:227], v14 offset:20992
    v_cvt_pk_bf16_f32 v174, v204, v205
    v_mfma_f32_16x16x32_bf16 a[164:167], a[180:183], v[132:135], a[164:167]
    v_exp_f32 v206, v206
    v_mfma_f32_16x16x32_bf16 a[12:15], a[240:243], v[124:127], a[12:15]
    ds_read_b64_tr_b16 a[228:229], v16 offset:16896
    v_mfma_f32_16x16x32_bf16 a[12:15], a[244:247], v[128:131], a[12:15]
    v_exp_f32 v207, v207
    v_mfma_f32_16x16x32_bf16 v[212:215], a[200:203], v[72:75], v[116:119]
    ds_read_b64_tr_b16 a[230:231], v16 offset:20992
    v_cvt_pk_bf16_f32 v175, v206, v207
    v_mfma_f32_16x16x32_bf16 v[212:215], a[204:207], v[76:79], v[212:215]
    v_exp_f32 v208, v208
    v_mfma_f32_16x16x32_bf16 v[212:215], a[208:211], v[80:83], v[212:215]
    buffer_load_dwordx4 v5, s[20:23], s1 offen nt lds
    v_mfma_f32_16x16x32_bf16 v[212:215], a[212:215], v[84:87], v[212:215]
    v_exp_f32 v209, v209
    v_mfma_f32_16x16x32_bf16 a[44:47], a[240:243], v[132:135], a[44:47]
    v_cvt_pk_bf16_f32 v182, v208, v209
    v_mfma_f32_16x16x32_bf16 a[44:47], a[244:247], v[136:139], a[44:47]
    v_exp_f32 v210, v210
    v_mfma_f32_16x16x32_bf16 a[76:79], a[240:243], v[140:143], a[76:79]
    ds_read_b64_tr_b16 a[232:233], v13 offset:17152
    v_mfma_f32_16x16x32_bf16 a[76:79], a[244:247], v[144:147], a[76:79]
    v_exp_f32 v211, v211
    v_mfma_f32_16x16x32_bf16 v[204:207], a[200:203], v[88:91], v[120:123]
    ds_read_b64_tr_b16 a[234:235], v13 offset:21248
    v_cvt_pk_bf16_f32 v183, v210, v211
    v_mfma_f32_16x16x32_bf16 v[204:207], a[204:207], v[92:95], v[204:207]
    v_exp_f32 v212, v212
    v_mfma_f32_16x16x32_bf16 v[204:207], a[208:211], v[96:99], v[204:207]
    s_waitcnt lgkmcnt(2)
    ds_read_b64_tr_b16 a[236:237], v15 offset:17152
    v_mfma_f32_16x16x32_bf16 v[204:207], a[212:215], v[100:103], v[204:207]
    v_exp_f32 v213, v213
    v_mfma_f32_16x16x32_bf16 a[108:111], a[240:243], v[148:151], a[108:111]
    ds_read_b64_tr_b16 a[238:239], v15 offset:21248
    v_cvt_pk_bf16_f32 v190, v212, v213
    v_mfma_f32_16x16x32_bf16 a[108:111], a[244:247], v[152:155], a[108:111]
    v_exp_f32 v214, v214
    v_mfma_f32_16x16x32_bf16 a[140:143], a[240:243], v[156:159], a[140:143]
    buffer_load_dwordx4 v6, s[20:23], s1 offen offset:1024 nt lds
    v_mfma_f32_16x16x32_bf16 a[164:167], a[180:183], v[136:139], a[164:167]
    v_exp_f32 v215, v215
    v_mfma_f32_16x16x32_bf16 v[208:211], a[184:187], v[24:27], v[104:107]
    ds_read_b128 a[200:203], v12 offset:4096
    v_cvt_pk_bf16_f32 v191, v214, v215
    v_mfma_f32_16x16x32_bf16 v[208:211], a[188:191], v[28:31], v[208:211]
    v_exp_f32 v204, v204
    v_mfma_f32_16x16x32_bf16 v[208:211], a[192:195], v[32:35], v[208:211]
    ds_read_b128 a[204:207], v12 offset:4352
    v_add_u32 v13, s43, v9
    v_mfma_f32_16x16x32_bf16 v[208:211], a[196:199], v[36:39], v[208:211]
    v_exp_f32 v205, v205
    v_mfma_f32_16x16x32_bf16 a[16:19], a[216:219], v[124:127], a[16:19]
    ds_read_b128 a[208:211], v12 offset:4608
    v_cvt_pk_bf16_f32 v198, v204, v205
    v_mfma_f32_16x16x32_bf16 a[16:19], a[220:223], v[128:131], a[16:19]
    v_exp_f32 v206, v206
    v_mfma_f32_16x16x32_bf16 a[48:51], a[216:219], v[132:135], a[48:51]
    ds_read_b128 a[212:215], v12 offset:4864
    v_add_u32 v15, s43, v10
    v_mfma_f32_16x16x32_bf16 a[48:51], a[220:223], v[136:139], a[48:51]
    v_exp_f32 v207, v207
    v_mfma_f32_16x16x32_bf16 v[212:215], a[184:187], v[40:43], v[108:111]
    ds_read_b64_tr_b16 a[240:241], v14 offset:17152
    v_cvt_pk_bf16_f32 v199, v206, v207
    v_mfma_f32_16x16x32_bf16 v[212:215], a[188:191], v[44:47], v[212:215]
    v_exp_f32 v208, v208
    v_mfma_f32_16x16x32_bf16 v[212:215], a[192:195], v[48:51], v[212:215]
    buffer_load_dwordx4 v5, s[20:23], s1 offen offset:2048 nt lds
    v_mfma_f32_16x16x32_bf16 v[212:215], a[196:199], v[52:55], v[212:215]
    v_exp_f32 v209, v209
    v_mfma_f32_16x16x32_bf16 a[80:83], a[216:219], v[140:143], a[80:83]
    ds_read_b64_tr_b16 a[242:243], v14 offset:21248
    v_cvt_pk_bf16_f32 v168, v208, v209
    v_mfma_f32_16x16x32_bf16 a[80:83], a[220:223], v[144:147], a[80:83]
    v_exp_f32 v210, v210
    v_mfma_f32_16x16x32_bf16 a[112:115], a[216:219], v[148:151], a[112:115]
    ds_read_b64_tr_b16 a[244:245], v16 offset:17152
    v_add_u32 v12, s43, v8
    v_mfma_f32_16x16x32_bf16 a[112:115], a[220:223], v[152:155], a[112:115]
    v_exp_f32 v211, v211
    v_mfma_f32_16x16x32_bf16 v[204:207], a[184:187], v[56:59], v[112:115]
    ds_read_b64_tr_b16 a[246:247], v16 offset:21248
    v_cvt_pk_bf16_f32 v169, v210, v211
    v_mfma_f32_16x16x32_bf16 v[204:207], a[188:191], v[60:63], v[204:207]
    v_exp_f32 v212, v212
    v_mfma_f32_16x16x32_bf16 v[204:207], a[192:195], v[64:67], v[204:207]
    v_xor_b32 v14, 32, v13
    v_xor_b32 v16, 32, v15
    v_mfma_f32_16x16x32_bf16 v[204:207], a[196:199], v[68:71], v[204:207]
    v_exp_f32 v213, v213
    v_mfma_f32_16x16x32_bf16 a[144:147], a[216:219], v[156:159], a[144:147]
    v_cvt_pk_bf16_f32 v176, v212, v213
    v_mfma_f32_16x16x32_bf16 a[168:171], a[180:183], v[140:143], a[168:171]
    v_exp_f32 v214, v214
    v_mfma_f32_16x16x32_bf16 a[20:23], a[224:227], v[124:127], a[20:23]
    buffer_load_dwordx4 v6, s[20:23], s1 offen offset:3072 nt lds
    v_mfma_f32_16x16x32_bf16 a[20:23], a[228:231], v[128:131], a[20:23]
    v_exp_f32 v215, v215
    v_mfma_f32_16x16x32_bf16 v[208:211], a[184:187], v[72:75], v[116:119]
    s_mov_b32 s1, s45
    v_cvt_pk_bf16_f32 v177, v214, v215
    v_mfma_f32_16x16x32_bf16 v[208:211], a[188:191], v[76:79], v[208:211]
    v_exp_f32 v204, v204
    v_mfma_f32_16x16x32_bf16 v[208:211], a[192:195], v[80:83], v[208:211]
    s_add_u32 s45, s45, 16384
    v_mfma_f32_16x16x32_bf16 v[208:211], a[196:199], v[84:87], v[208:211]
    v_exp_f32 v205, v205
    v_mfma_f32_16x16x32_bf16 a[52:55], a[224:227], v[132:135], a[52:55]
    s_waitcnt lgkmcnt(0)
    v_cvt_pk_bf16_f32 v184, v204, v205
    v_mfma_f32_16x16x32_bf16 a[52:55], a[228:231], v[136:139], a[52:55]
    v_exp_f32 v206, v206
    v_mfma_f32_16x16x32_bf16 a[84:87], a[224:227], v[140:143], a[84:87]
    s_waitcnt vmcnt(9)
    s_barrier
    v_mfma_f32_16x16x32_bf16 a[84:87], a[228:231], v[144:147], a[84:87]
    v_exp_f32 v207, v207
    v_mfma_f32_16x16x32_bf16 v[212:215], a[200:203], v[24:27], v[104:107]
    ds_read_b128 a[184:187], v11 offset:0
    v_cvt_pk_bf16_f32 v185, v206, v207
    v_mfma_f32_16x16x32_bf16 v[212:215], a[204:207], v[28:31], v[212:215]
    v_exp_f32 v208, v208
    v_mfma_f32_16x16x32_bf16 v[212:215], a[208:211], v[32:35], v[212:215]
    ds_read_b128 a[188:191], v11 offset:256
    v_mfma_f32_16x16x32_bf16 v[212:215], a[212:215], v[36:39], v[212:215]
    v_exp_f32 v209, v209
    v_mfma_f32_16x16x32_bf16 a[116:119], a[224:227], v[148:151], a[116:119]
    ds_read_b128 a[192:195], v11 offset:512
    v_cvt_pk_bf16_f32 v192, v208, v209
    v_mfma_f32_16x16x32_bf16 a[116:119], a[228:231], v[152:155], a[116:119]
    v_exp_f32 v210, v210
    v_mfma_f32_16x16x32_bf16 a[148:151], a[224:227], v[156:159], a[148:151]
    ds_read_b128 a[196:199], v11 offset:768
    v_mfma_f32_16x16x32_bf16 a[168:171], a[180:183], v[144:147], a[168:171]
    v_exp_f32 v211, v211
    v_mfma_f32_16x16x32_bf16 v[204:207], a[200:203], v[40:43], v[108:111]
    ds_read_b64_tr_b16 a[216:217], v13 offset:16384
    v_cvt_pk_bf16_f32 v193, v210, v211
    v_mfma_f32_16x16x32_bf16 v[204:207], a[204:207], v[44:47], v[204:207]
    v_exp_f32 v212, v212
    v_mfma_f32_16x16x32_bf16 v[204:207], a[208:211], v[48:51], v[204:207]
    ds_read_b64_tr_b16 a[218:219], v13 offset:20480
    v_mfma_f32_16x16x32_bf16 v[204:207], a[212:215], v[52:55], v[204:207]
    v_exp_f32 v213, v213
    v_mfma_f32_16x16x32_bf16 a[24:27], a[232:235], v[124:127], a[24:27]
    ds_read_b64_tr_b16 a[220:221], v15 offset:16384
    v_cvt_pk_bf16_f32 v170, v212, v213
    v_mfma_f32_16x16x32_bf16 a[24:27], a[236:239], v[128:131], a[24:27]
    v_exp_f32 v214, v214
    v_mfma_f32_16x16x32_bf16 a[56:59], a[232:235], v[132:135], a[56:59]
    buffer_load_dword v0, v22, s[28:31], s101 offen sc1
    v_mfma_f32_16x16x32_bf16 a[56:59], a[236:239], v[136:139], a[56:59]
    v_exp_f32 v215, v215
    v_mfma_f32_16x16x32_bf16 v[208:211], a[200:203], v[56:59], v[112:115]
    ds_read_b64_tr_b16 a[222:223], v15 offset:20480
    v_cvt_pk_bf16_f32 v171, v214, v215
    v_mfma_f32_16x16x32_bf16 v[208:211], a[204:207], v[60:63], v[208:211]
    v_exp_f32 v204, v204
    v_mfma_f32_16x16x32_bf16 v[208:211], a[208:211], v[64:67], v[208:211]
    ds_read_b64_tr_b16 a[224:225], v14 offset:16384
    s_add_u32 s100, s100, 131072
    v_mfma_f32_16x16x32_bf16 v[208:211], a[212:215], v[68:71], v[208:211]
    v_exp_f32 v205, v205
    v_mfma_f32_16x16x32_bf16 a[88:91], a[232:235], v[140:143], a[88:91]
    ds_read_b64_tr_b16 a[226:227], v14 offset:20480
    v_cvt_pk_bf16_f32 v178, v204, v205
    v_mfma_f32_16x16x32_bf16 a[88:91], a[236:239], v[144:147], a[88:91]
    v_exp_f32 v206, v206
    v_mfma_f32_16x16x32_bf16 a[120:123], a[232:235], v[148:151], a[120:123]
    ds_read_b64_tr_b16 a[228:229], v16 offset:16384
    s_cmp_ge_i32 s100, 0
    v_mfma_f32_16x16x32_bf16 a[120:123], a[236:239], v[152:155], a[120:123]
    v_exp_f32 v207, v207
    v_mfma_f32_16x16x32_bf16 v[212:215], a[200:203], v[72:75], v[116:119]
    ds_read_b64_tr_b16 a[230:231], v16 offset:20480
    v_cvt_pk_bf16_f32 v179, v206, v207
    v_mfma_f32_16x16x32_bf16 v[212:215], a[204:207], v[76:79], v[212:215]
    v_exp_f32 v208, v208
    v_mfma_f32_16x16x32_bf16 v[212:215], a[208:211], v[80:83], v[212:215]
    s_cselect_b32 s30, 4718592, s30
    s_cselect_b32 s101, s100, 0
    v_mfma_f32_16x16x32_bf16 v[212:215], a[212:215], v[84:87], v[212:215]
    v_exp_f32 v209, v209
    v_mfma_f32_16x16x32_bf16 a[152:155], a[232:235], v[156:159], a[152:155]
    v_cvt_pk_bf16_f32 v186, v208, v209
    v_mfma_f32_16x16x32_bf16 a[172:175], a[180:183], v[148:151], a[172:175]
    v_exp_f32 v210, v210
    v_mfma_f32_16x16x32_bf16 a[28:31], a[240:243], v[124:127], a[28:31]
    v_mfma_f32_16x16x32_bf16 a[28:31], a[244:247], v[128:131], a[28:31]
    v_exp_f32 v211, v211
    v_mfma_f32_16x16x32_bf16 a[60:63], a[240:243], v[132:135], a[60:63]
    v_cvt_pk_bf16_f32 v187, v210, v211
    v_mfma_f32_16x16x32_bf16 a[60:63], a[244:247], v[136:139], a[60:63]
    v_exp_f32 v212, v212
    v_mfma_f32_16x16x32_bf16 a[92:95], a[240:243], v[140:143], a[92:95]
    v_mfma_f32_16x16x32_bf16 a[92:95], a[244:247], v[144:147], a[92:95]
    v_exp_f32 v213, v213
    v_mfma_f32_16x16x32_bf16 a[124:127], a[240:243], v[148:151], a[124:127]
    v_cvt_pk_bf16_f32 v194, v212, v213
    v_mfma_f32_16x16x32_bf16 a[124:127], a[244:247], v[152:155], a[124:127]
    v_exp_f32 v214, v214
    v_mfma_f32_16x16x32_bf16 a[156:159], a[240:243], v[156:159], a[156:159]
    s_waitcnt lgkmcnt(0)
    s_cmp_eq_u32 s46, 15
    v_mfma_f32_16x16x32_bf16 a[172:175], a[180:183], v[152:155], a[172:175]
    v_exp_f32 v215, v215
    v_mfma_f32_16x16x32_bf16 a[176:179], a[180:183], v[156:159], a[176:179]
    v_cvt_pk_bf16_f32 v195, v214, v215
    s_cbranch_scc1 L1_last
    v_mfma_f32_16x16x32_bf16 v[204:207], a[184:187], v[24:27], v[104:107]
    ds_read_b128 a[200:203], v11 offset:4096
    v_mfma_f32_16x16x32_bf16 v[204:207], a[188:191], v[28:31], v[204:207]
    ds_read_b128 a[204:207], v11 offset:4352
    s_add_u32 s41, s43, 65536
    v_mfma_f32_16x16x32_bf16 v[204:207], a[192:195], v[32:35], v[204:207]
    ds_read_b128 a[208:211], v11 offset:4608
    s_sub_u32 s40, s41, 163840
    v_mfma_f32_16x16x32_bf16 v[204:207], a[196:199], v[36:39], v[204:207]
    ds_read_b128 a[212:215], v11 offset:4864
    s_min_u32 s41, s41, s40
    v_mfma_f32_16x16x32_bf16 a[0:3], a[216:219], v[164:167], a[0:3]
    ds_read_b64_tr_b16 a[232:233], v13 offset:16640
    s_add_u32 s41, s41, s39
    v_mfma_f32_16x16x32_bf16 a[0:3], a[220:223], v[168:171], a[0:3]
    ds_read_b64_tr_b16 a[234:235], v13 offset:20736
    s_add_u32 s43, s43, 32768
    v_mfma_f32_16x16x32_bf16 a[32:35], a[216:219], v[172:175], a[32:35]
    ds_read_b64_tr_b16 a[236:237], v15 offset:16640
    s_sub_u32 s40, s43, 163840
    v_mfma_f32_16x16x32_bf16 a[32:35], a[220:223], v[176:179], a[32:35]
    ds_read_b64_tr_b16 a[238:239], v15 offset:20736
    s_min_u32 s43, s43, s40
    v_mfma_f32_16x16x32_bf16 v[208:211], a[184:187], v[40:43], v[108:111]
    s_mov_b32 m0, s41
    v_add_u32 v11, s43, v7
    v_mfma_f32_16x16x32_bf16 v[208:211], a[188:191], v[44:47], v[208:211]
    v_exp_f32 v204, v204
    v_mfma_f32_16x16x32_bf16 v[208:211], a[192:195], v[48:51], v[208:211]
    v_mfma_f32_16x16x32_bf16 v[208:211], a[196:199], v[52:55], v[208:211]
    v_exp_f32 v205, v205
    v_mfma_f32_16x16x32_bf16 a[64:67], a[216:219], v[180:183], a[64:67]
    v_cvt_pk_bf16_f32 v124, v204, v205
    v_mfma_f32_16x16x32_bf16 a[64:67], a[220:223], v[184:187], a[64:67]
    v_exp_f32 v206, v206
    v_mfma_f32_16x16x32_bf16 a[96:99], a[216:219], v[188:191], a[96:99]
    v_mfma_f32_16x16x32_bf16 a[96:99], a[220:223], v[192:195], a[96:99]
    v_exp_f32 v207, v207
    v_mfma_f32_16x16x32_bf16 v[212:215], a[184:187], v[56:59], v[112:115]
    v_cvt_pk_bf16_f32 v125, v206, v207
    v_mfma_f32_16x16x32_bf16 v[212:215], a[188:191], v[60:63], v[212:215]
    v_exp_f32 v208, v208
    v_mfma_f32_16x16x32_bf16 v[212:215], a[192:195], v[64:67], v[212:215]
    buffer_load_dwordx4 v5, s[16:19], s45 offen nt lds
    v_mfma_f32_16x16x32_bf16 v[212:215], a[196:199], v[68:71], v[212:215]
    v_exp_f32 v209, v209
    v_mfma_f32_16x16x32_bf16 a[128:131], a[216:219], v[196:199], a[128:131]
    ds_read_b64_tr_b16 a[240:241], v14 offset:16640
    v_cvt_pk_bf16_f32 v132, v208, v209
    v_mfma_f32_16x16x32_bf16 a[160:163], a[180:183], v[164:167], a[160:163]
    v_exp_f32 v210, v210
    v_mfma_f32_16x16x32_bf16 a[4:7], a[224:227], v[164:167], a[4:7]
    ds_read_b64_tr_b16 a[242:243], v14 offset:20736
    v_mfma_f32_16x16x32_bf16 a[4:7], a[228:231], v[168:171], a[4:7]
    v_exp_f32 v211, v211
    v_mfma_f32_16x16x32_bf16 v[204:207], a[184:187], v[72:75], v[116:119]
    ds_read_b64_tr_b16 a[244:245], v16 offset:16640
    v_cvt_pk_bf16_f32 v133, v210, v211
    v_mfma_f32_16x16x32_bf16 v[204:207], a[188:191], v[76:79], v[204:207]
    v_exp_f32 v212, v212
    v_mfma_f32_16x16x32_bf16 v[204:207], a[192:195], v[80:83], v[204:207]
    ds_read_b64_tr_b16 a[246:247], v16 offset:20736
    v_mfma_f32_16x16x32_bf16 v[204:207], a[196:199], v[84:87], v[204:207]
    v_exp_f32 v213, v213
    v_mfma_f32_16x16x32_bf16 a[36:39], a[224:227], v[172:175], a[36:39]
    v_cvt_pk_bf16_f32 v140, v212, v213
    v_mfma_f32_16x16x32_bf16 a[36:39], a[228:231], v[176:179], a[36:39]
    v_exp_f32 v214, v214
    v_mfma_f32_16x16x32_bf16 a[68:71], a[224:227], v[180:183], a[68:71]
    buffer_load_dwordx4 v6, s[16:19], s45 offen offset:1024 nt lds
    v_mfma_f32_16x16x32_bf16 a[68:71], a[228:231], v[184:187], a[68:71]
    v_exp_f32 v215, v215
    v_mfma_f32_16x16x32_bf16 v[208:211], a[184:187], v[88:91], v[120:123]
    v_cvt_pk_bf16_f32 v141, v214, v215
    v_mfma_f32_16x16x32_bf16 v[208:211], a[188:191], v[92:95], v[208:211]
    v_exp_f32 v204, v204
    v_mfma_f32_16x16x32_bf16 v[208:211], a[192:195], v[96:99], v[208:211]
    v_mfma_f32_16x16x32_bf16 v[208:211], a[196:199], v[100:103], v[208:211]
    v_exp_f32 v205, v205
    v_mfma_f32_16x16x32_bf16 a[100:103], a[224:227], v[188:191], a[100:103]
    v_cvt_pk_bf16_f32 v148, v204, v205
    v_mfma_f32_16x16x32_bf16 a[100:103], a[228:231], v[192:195], a[100:103]
    v_exp_f32 v206, v206
    v_mfma_f32_16x16x32_bf16 a[132:135], a[224:227], v[196:199], a[132:135]
    s_waitcnt lgkmcnt(0)
    ds_read_b128 a[184:187], v12 offset:0
    v_mfma_f32_16x16x32_bf16 a[160:163], a[180:183], v[168:171], a[160:163]
    v_exp_f32 v207, v207
    v_mfma_f32_16x16x32_bf16 v[212:215], a[200:203], v[24:27], v[104:107]
    ds_read_b128 a[188:191], v12 offset:256
    v_cvt_pk_bf16_f32 v149, v206, v207
    v_mfma_f32_16x16x32_bf16 v[212:215], a[204:207], v[28:31], v[212:215]
    v_exp_f32 v208, v208
    v_mfma_f32_16x16x32_bf16 v[212:215], a[208:211], v[32:35], v[212:215]
    buffer_load_dwordx4 v5, s[16:19], s45 offen offset:2048 nt lds
    v_mfma_f32_16x16x32_bf16 v[212:215], a[212:215], v[36:39], v[212:215]
    v_exp_f32 v209, v209
    v_mfma_f32_16x16x32_bf16 a[8:11], a[232:235], v[164:167], a[8:11]
    ds_read_b128 a[192:195], v12 offset:512
    v_cvt_pk_bf16_f32 v156, v208, v209
    v_mfma_f32_16x16x32_bf16 a[8:11], a[236:239], v[168:171], a[8:11]
    v_exp_f32 v210, v210
    v_mfma_f32_16x16x32_bf16 a[40:43], a[232:235], v[172:175], a[40:43]
    ds_read_b128 a[196:199], v12 offset:768
    v_mfma_f32_16x16x32_bf16 a[40:43], a[236:239], v[176:179], a[40:43]
    v_exp_f32 v211, v211
    v_mfma_f32_16x16x32_bf16 v[204:207], a[200:203], v[40:43], v[108:111]
    ds_read_b64_tr_b16 a[216:217], v13 offset:16896
    v_cvt_pk_bf16_f32 v157, v210, v211
    v_mfma_f32_16x16x32_bf16 v[204:207], a[204:207], v[44:47], v[204:207]
    v_exp_f32 v212, v212
    v_mfma_f32_16x16x32_bf16 v[204:207], a[208:211], v[48:51], v[204:207]
    ds_read_b64_tr_b16 a[218:219], v13 offset:20992
    v_mfma_f32_16x16x32_bf16 v[204:207], a[212:215], v[52:55], v[204:207]
    v_exp_f32 v213, v213
    v_mfma_f32_16x16x32_bf16 a[72:75], a[232:235], v[180:183], a[72:75]
    ds_read_b64_tr_b16 a[220:221], v15 offset:16896
    v_cvt_pk_bf16_f32 v126, v212, v213
    v_mfma_f32_16x16x32_bf16 a[72:75], a[236:239], v[184:187], a[72:75]
    v_exp_f32 v214, v214
    v_mfma_f32_16x16x32_bf16 a[104:107], a[232:235], v[188:191], a[104:107]
    buffer_load_dwordx4 v6, s[16:19], s45 offen offset:3072 nt lds
    v_mfma_f32_16x16x32_bf16 a[104:107], a[236:239], v[192:195], a[104:107]
    v_exp_f32 v215, v215
    v_mfma_f32_16x16x32_bf16 v[208:211], a[200:203], v[56:59], v[112:115]
    ds_read_b64_tr_b16 a[222:223], v15 offset:20992
    v_cvt_pk_bf16_f32 v127, v214, v215
    v_mfma_f32_16x16x32_bf16 v[208:211], a[204:207], v[60:63], v[208:211]
    v_exp_f32 v204, v204
    v_mfma_f32_16x16x32_bf16 v[208:211], a[208:211], v[64:67], v[208:211]
    ds_read_b64_tr_b16 a[224:225], v14 offset:16896
    s_add_u32 m0, s41, 16384
    v_mfma_f32_16x16x32_bf16 v[208:211], a[212:215], v[68:71], v[208:211]
    v_exp_f32 v205, v205
    v_mfma_f32_16x16x32_bf16 a[136:139], a[232:235], v[196:199], a[136:139]
    ds_read_b64_tr_b16 a[226:227], v14 offset:20992
    v_cvt_pk_bf16_f32 v134, v204, v205
    v_mfma_f32_16x16x32_bf16 a[164:167], a[180:183], v[172:175], a[164:167]
    v_exp_f32 v206, v206
    v_mfma_f32_16x16x32_bf16 a[12:15], a[240:243], v[164:167], a[12:15]
    ds_read_b64_tr_b16 a[228:229], v16 offset:16896
    v_mfma_f32_16x16x32_bf16 a[12:15], a[244:247], v[168:171], a[12:15]
    v_exp_f32 v207, v207
    v_mfma_f32_16x16x32_bf16 v[212:215], a[200:203], v[72:75], v[116:119]
    ds_read_b64_tr_b16 a[230:231], v16 offset:20992
    v_cvt_pk_bf16_f32 v135, v206, v207
    v_mfma_f32_16x16x32_bf16 v[212:215], a[204:207], v[76:79], v[212:215]
    v_exp_f32 v208, v208
    v_mfma_f32_16x16x32_bf16 v[212:215], a[208:211], v[80:83], v[212:215]
    buffer_load_dwordx4 v5, s[20:23], s1 offen nt lds
    v_mfma_f32_16x16x32_bf16 v[212:215], a[212:215], v[84:87], v[212:215]
    v_exp_f32 v209, v209
    v_mfma_f32_16x16x32_bf16 a[44:47], a[240:243], v[172:175], a[44:47]
    v_cvt_pk_bf16_f32 v142, v208, v209
    v_mfma_f32_16x16x32_bf16 a[44:47], a[244:247], v[176:179], a[44:47]
    v_exp_f32 v210, v210
    v_mfma_f32_16x16x32_bf16 a[76:79], a[240:243], v[180:183], a[76:79]
    ds_read_b64_tr_b16 a[232:233], v13 offset:17152
    v_mfma_f32_16x16x32_bf16 a[76:79], a[244:247], v[184:187], a[76:79]
    v_exp_f32 v211, v211
    v_mfma_f32_16x16x32_bf16 v[204:207], a[200:203], v[88:91], v[120:123]
    ds_read_b64_tr_b16 a[234:235], v13 offset:21248
    v_cvt_pk_bf16_f32 v143, v210, v211
    v_mfma_f32_16x16x32_bf16 v[204:207], a[204:207], v[92:95], v[204:207]
    v_exp_f32 v212, v212
    v_mfma_f32_16x16x32_bf16 v[204:207], a[208:211], v[96:99], v[204:207]
    s_waitcnt lgkmcnt(2)
    ds_read_b64_tr_b16 a[236:237], v15 offset:17152
    v_mfma_f32_16x16x32_bf16 v[204:207], a[212:215], v[100:103], v[204:207]
    v_exp_f32 v213, v213
    v_mfma_f32_16x16x32_bf16 a[108:111], a[240:243], v[188:191], a[108:111]
    ds_read_b64_tr_b16 a[238:239], v15 offset:21248
    v_cvt_pk_bf16_f32 v150, v212, v213
    v_mfma_f32_16x16x32_bf16 a[108:111], a[244:247], v[192:195], a[108:111]
    v_exp_f32 v214, v214
    v_mfma_f32_16x16x32_bf16 a[140:143], a[240:243], v[196:199], a[140:143]
    buffer_load_dwordx4 v6, s[20:23], s1 offen offset:1024 nt lds
    v_mfma_f32_16x16x32_bf16 a[164:167], a[180:183], v[176:179], a[164:167]
    v_exp_f32 v215, v215
    v_mfma_f32_16x16x32_bf16 v[208:211], a[184:187], v[24:27], v[104:107]
    ds_read_b128 a[200:203], v12 offset:4096
    v_cvt_pk_bf16_f32 v151, v214, v215
    v_mfma_f32_16x16x32_bf16 v[208:211], a[188:191], v[28:31], v[208:211]
    v_exp_f32 v204, v204
    v_mfma_f32_16x16x32_bf16 v[208:211], a[192:195], v[32:35], v[208:211]
    ds_read_b128 a[204:207], v12 offset:4352
    v_add_u32 v13, s43, v9
    v_mfma_f32_16x16x32_bf16 v[208:211], a[196:199], v[36:39], v[208:211]
    v_exp_f32 v205, v205
    v_mfma_f32_16x16x32_bf16 a[16:19], a[216:219], v[164:167], a[16:19]
    ds_read_b128 a[208:211], v12 offset:4608
    v_cvt_pk_bf16_f32 v158, v204, v205
    v_mfma_f32_16x16x32_bf16 a[16:19], a[220:223], v[168:171], a[16:19]
    v_exp_f32 v206, v206
    v_mfma_f32_16x16x32_bf16 a[48:51], a[216:219], v[172:175], a[48:51]
    ds_read_b128 a[212:215], v12 offset:4864
    v_add_u32 v15, s43, v10
    v_mfma_f32_16x16x32_bf16 a[48:51], a[220:223], v[176:179], a[48:51]
    v_exp_f32 v207, v207
    v_mfma_f32_16x16x32_bf16 v[212:215], a[184:187], v[40:43], v[108:111]
    ds_read_b64_tr_b16 a[240:241], v14 offset:17152
    v_cvt_pk_bf16_f32 v159, v206, v207
    v_mfma_f32_16x16x32_bf16 v[212:215], a[188:191], v[44:47], v[212:215]
    v_exp_f32 v208, v208
    v_mfma_f32_16x16x32_bf16 v[212:215], a[192:195], v[48:51], v[212:215]
    buffer_load_dwordx4 v5, s[20:23], s1 offen offset:2048 nt lds
    v_mfma_f32_16x16x32_bf16 v[212:215], a[196:199], v[52:55], v[212:215]
    v_exp_f32 v209, v209
    v_mfma_f32_16x16x32_bf16 a[80:83], a[216:219], v[180:183], a[80:83]
    ds_read_b64_tr_b16 a[242:243], v14 offset:21248
    v_cvt_pk_bf16_f32 v128, v208, v209
    v_mfma_f32_16x16x32_bf16 a[80:83], a[220:223], v[184:187], a[80:83]
    v_exp_f32 v210, v210
    v_mfma_f32_16x16x32_bf16 a[112:115], a[216:219], v[188:191], a[112:115]
    ds_read_b64_tr_b16 a[244:245], v16 offset:17152
    v_add_u32 v12, s43, v8
    v_mfma_f32_16x16x32_bf16 a[112:115], a[220:223], v[192:195], a[112:115]
    v_exp_f32 v211, v211
    v_mfma_f32_16x16x32_bf16 v[204:207], a[184:187], v[56:59], v[112:115]
    ds_read_b64_tr_b16 a[246:247], v16 offset:21248
    v_cvt_pk_bf16_f32 v129, v210, v211
    v_mfma_f32_16x16x32_bf16 v[204:207], a[188:191], v[60:63], v[204:207]
    v_exp_f32 v212, v212
    v_mfma_f32_16x16x32_bf16 v[204:207], a[192:195], v[64:67], v[204:207]
    v_xor_b32 v14, 32, v13
    v_xor_b32 v16, 32, v15
    v_mfma_f32_16x16x32_bf16 v[204:207], a[196:199], v[68:71], v[204:207]
    v_exp_f32 v213, v213
    v_mfma_f32_16x16x32_bf16 a[144:147], a[216:219], v[196:199], a[144:147]
    v_cvt_pk_bf16_f32 v136, v212, v213
    v_mfma_f32_16x16x32_bf16 a[168:171], a[180:183], v[180:183], a[168:171]
    v_exp_f32 v214, v214
    v_mfma_f32_16x16x32_bf16 a[20:23], a[224:227], v[164:167], a[20:23]
    buffer_load_dwordx4 v6, s[20:23], s1 offen offset:3072 nt lds
    v_mfma_f32_16x16x32_bf16 a[20:23], a[228:231], v[168:171], a[20:23]
    v_exp_f32 v215, v215
    v_mfma_f32_16x16x32_bf16 v[208:211], a[184:187], v[72:75], v[116:119]
    s_mov_b32 s1, s45
    v_cvt_pk_bf16_f32 v137, v214, v215
    v_mfma_f32_16x16x32_bf16 v[208:211], a[188:191], v[76:79], v[208:211]
    v_exp_f32 v204, v204
    v_mfma_f32_16x16x32_bf16 v[208:211], a[192:195], v[80:83], v[208:211]
    s_add_u32 s45, s45, 16384
    v_mfma_f32_16x16x32_bf16 v[208:211], a[196:199], v[84:87], v[208:211]
    v_exp_f32 v205, v205
    v_mfma_f32_16x16x32_bf16 a[52:55], a[224:227], v[172:175], a[52:55]
    s_waitcnt lgkmcnt(0)
    v_cvt_pk_bf16_f32 v144, v204, v205
    v_mfma_f32_16x16x32_bf16 a[52:55], a[228:231], v[176:179], a[52:55]
    v_exp_f32 v206, v206
    v_mfma_f32_16x16x32_bf16 a[84:87], a[224:227], v[180:183], a[84:87]
    s_waitcnt vmcnt(9)
    s_barrier
    v_mfma_f32_16x16x32_bf16 a[84:87], a[228:231], v[184:187], a[84:87]
    v_exp_f32 v207, v207
    v_mfma_f32_16x16x32_bf16 v[212:215], a[200:203], v[24:27], v[104:107]
    ds_read_b128 a[184:187], v11 offset:0
    v_cvt_pk_bf16_f32 v145, v206, v207
    v_mfma_f32_16x16x32_bf16 v[212:215], a[204:207], v[28:31], v[212:215]
    v_exp_f32 v208, v208
    v_mfma_f32_16x16x32_bf16 v[212:215], a[208:211], v[32:35], v[212:215]
    ds_read_b128 a[188:191], v11 offset:256
    v_mfma_f32_16x16x32_bf16 v[212:215], a[212:215], v[36:39], v[212:215]
    v_exp_f32 v209, v209
    v_mfma_f32_16x16x32_bf16 a[116:119], a[224:227], v[188:191], a[116:119]
    ds_read_b128 a[192:195], v11 offset:512
    v_cvt_pk_bf16_f32 v152, v208, v209
    v_mfma_f32_16x16x32_bf16 a[116:119], a[228:231], v[192:195], a[116:119]
    v_exp_f32 v210, v210
    v_mfma_f32_16x16x32_bf16 a[148:151], a[224:227], v[196:199], a[148:151]
    ds_read_b128 a[196:199], v11 offset:768
    v_mfma_f32_16x16x32_bf16 a[168:171], a[180:183], v[184:187], a[168:171]
    v_exp_f32 v211, v211
    v_mfma_f32_16x16x32_bf16 v[204:207], a[200:203], v[40:43], v[108:111]
    ds_read_b64_tr_b16 a[216:217], v13 offset:16384
    v_cvt_pk_bf16_f32 v153, v210, v211
    v_mfma_f32_16x16x32_bf16 v[204:207], a[204:207], v[44:47], v[204:207]
    v_exp_f32 v212, v212
    v_mfma_f32_16x16x32_bf16 v[204:207], a[208:211], v[48:51], v[204:207]
    ds_read_b64_tr_b16 a[218:219], v13 offset:20480
    v_mfma_f32_16x16x32_bf16 v[204:207], a[212:215], v[52:55], v[204:207]
    v_exp_f32 v213, v213
    v_mfma_f32_16x16x32_bf16 a[24:27], a[232:235], v[164:167], a[24:27]
    ds_read_b64_tr_b16 a[220:221], v15 offset:16384
    v_cvt_pk_bf16_f32 v130, v212, v213
    v_mfma_f32_16x16x32_bf16 a[24:27], a[236:239], v[168:171], a[24:27]
    v_exp_f32 v214, v214
    v_mfma_f32_16x16x32_bf16 a[56:59], a[232:235], v[172:175], a[56:59]
    buffer_load_dword v0, v22, s[28:31], s101 offen sc1
    v_mfma_f32_16x16x32_bf16 a[56:59], a[236:239], v[176:179], a[56:59]
    v_exp_f32 v215, v215
    v_mfma_f32_16x16x32_bf16 v[208:211], a[200:203], v[56:59], v[112:115]
    ds_read_b64_tr_b16 a[222:223], v15 offset:20480
    v_cvt_pk_bf16_f32 v131, v214, v215
    v_mfma_f32_16x16x32_bf16 v[208:211], a[204:207], v[60:63], v[208:211]
    v_exp_f32 v204, v204
    v_mfma_f32_16x16x32_bf16 v[208:211], a[208:211], v[64:67], v[208:211]
    ds_read_b64_tr_b16 a[224:225], v14 offset:16384
    s_add_u32 s100, s100, 131072
    v_mfma_f32_16x16x32_bf16 v[208:211], a[212:215], v[68:71], v[208:211]
    v_exp_f32 v205, v205
    v_mfma_f32_16x16x32_bf16 a[88:91], a[232:235], v[180:183], a[88:91]
    ds_read_b64_tr_b16 a[226:227], v14 offset:20480
    v_cvt_pk_bf16_f32 v138, v204, v205
    v_mfma_f32_16x16x32_bf16 a[88:91], a[236:239], v[184:187], a[88:91]
    v_exp_f32 v206, v206
    v_mfma_f32_16x16x32_bf16 a[120:123], a[232:235], v[188:191], a[120:123]
    ds_read_b64_tr_b16 a[228:229], v16 offset:16384
    s_cmp_ge_i32 s100, 0
    v_mfma_f32_16x16x32_bf16 a[120:123], a[236:239], v[192:195], a[120:123]
    v_exp_f32 v207, v207
    v_mfma_f32_16x16x32_bf16 v[212:215], a[200:203], v[72:75], v[116:119]
    ds_read_b64_tr_b16 a[230:231], v16 offset:20480
    v_cvt_pk_bf16_f32 v139, v206, v207
    v_mfma_f32_16x16x32_bf16 v[212:215], a[204:207], v[76:79], v[212:215]
    v_exp_f32 v208, v208
    v_mfma_f32_16x16x32_bf16 v[212:215], a[208:211], v[80:83], v[212:215]
    s_cselect_b32 s30, 4718592, s30
    s_cselect_b32 s101, s100, 0
    v_mfma_f32_16x16x32_bf16 v[212:215], a[212:215], v[84:87], v[212:215]
    v_exp_f32 v209, v209
    v_mfma_f32_16x16x32_bf16 a[152:155], a[232:235], v[196:199], a[152:155]
    v_cvt_pk_bf16_f32 v146, v208, v209
    v_mfma_f32_16x16x32_bf16 a[172:175], a[180:183], v[188:191], a[172:175]
    v_exp_f32 v210, v210
    v_mfma_f32_16x16x32_bf16 a[28:31], a[240:243], v[164:167], a[28:31]
    v_mfma_f32_16x16x32_bf16 a[28:31], a[244:247], v[168:171], a[28:31]
    v_exp_f32 v211, v211
    v_mfma_f32_16x16x32_bf16 a[60:63], a[240:243], v[172:175], a[60:63]
    v_cvt_pk_bf16_f32 v147, v210, v211
    v_mfma_f32_16x16x32_bf16 a[60:63], a[244:247], v[176:179], a[60:63]
    v_exp_f32 v212, v212
    v_mfma_f32_16x16x32_bf16 a[92:95], a[240:243], v[180:183], a[92:95]
    v_mfma_f32_16x16x32_bf16 a[92:95], a[244:247], v[184:187], a[92:95]
    v_exp_f32 v213, v213
    v_mfma_f32_16x16x32_bf16 a[124:127], a[240:243], v[188:191], a[124:127]
    v_cvt_pk_bf16_f32 v154, v212, v213
    v_mfma_f32_16x16x32_bf16 a[124:127], a[244:247], v[192:195], a[124:127]
    v_exp_f32 v214, v214
    v_mfma_f32_16x16x32_bf16 a[156:159], a[240:243], v[196:199], a[156:159]
    s_waitcnt lgkmcnt(0)
    v_mfma_f32_16x16x32_bf16 a[172:175], a[180:183], v[192:195], a[172:175]
    v_exp_f32 v215, v215
    v_mfma_f32_16x16x32_bf16 a[176:179], a[180:183], v[196:199], a[176:179]
    v_cvt_pk_bf16_f32 v155, v214, v215
    s_branch L1_loop
L1_last:
    v_mfma_f32_16x16x32_bf16 v[204:207], a[184:187], v[24:27], v[104:107]
    ds_read_b128 a[200:203], v11 offset:4096
    ds_read_b128 a[204:207], v11 offset:4352
    v_mfma_f32_16x16x32_bf16 v[204:207], a[188:191], v[28:31], v[204:207]
    ds_read_b128 a[208:211], v11 offset:4608
    ds_read_b128 a[212:215], v11 offset:4864
    v_mfma_f32_16x16x32_bf16 v[204:207], a[192:195], v[32:35], v[204:207]
    ds_read_b64_tr_b16 a[232:233], v13 offset:16640
    ds_read_b64_tr_b16 a[234:235], v13 offset:20736
    v_mfma_f32_16x16x32_bf16 v[204:207], a[196:199], v[36:39], v[204:207]
    ds_read_b64_tr_b16 a[236:237], v15 offset:16640
    ds_read_b64_tr_b16 a[238:239], v15 offset:20736
    v_mfma_f32_16x16x32_bf16 a[0:3], a[216:219], v[164:167], a[0:3]
    s_mov_b32 s43, 32768
    v_mfma_f32_16x16x32_bf16 a[0:3], a[220:223], v[168:171], a[0:3]
    s_add_u32 m0, s39, 81920
    v_add_u32 v11, s43, v7
    v_mfma_f32_16x16x32_bf16 a[32:35], a[216:219], v[172:175], a[32:35]
    v_mfma_f32_16x16x32_bf16 a[32:35], a[220:223], v[176:179], a[32:35]
    buffer_load_dwordx4 v5, s[20:23], s1 offen nt lds
    v_mfma_f32_16x16x32_bf16 v[208:211], a[184:187], v[40:43], v[108:111]
    v_mfma_f32_16x16x32_bf16 v[208:211], a[188:191], v[44:47], v[208:211]
    v_exp_f32 v204, v204
    v_mfma_f32_16x16x32_bf16 v[208:211], a[192:195], v[48:51], v[208:211]
    v_mfma_f32_16x16x32_bf16 v[208:211], a[196:199], v[52:55], v[208:211]
    v_exp_f32 v205, v205
    v_mfma_f32_16x16x32_bf16 a[64:67], a[216:219], v[180:183], a[64:67]
    v_cvt_pk_bf16_f32 v124, v204, v205
    v_mfma_f32_16x16x32_bf16 a[64:67], a[220:223], v[184:187], a[64:67]
    v_exp_f32 v206, v206
    v_mfma_f32_16x16x32_bf16 a[96:99], a[216:219], v[188:191], a[96:99]
    buffer_load_dwordx4 v6, s[20:23], s1 offen offset:1024 nt lds
    v_mfma_f32_16x16x32_bf16 a[96:99], a[220:223], v[192:195], a[96:99]
    v_exp_f32 v207, v207
    v_mfma_f32_16x16x32_bf16 v[212:215], a[184:187], v[56:59], v[112:115]
    v_cvt_pk_bf16_f32 v125, v206, v207
    v_mfma_f32_16x16x32_bf16 v[212:215], a[188:191], v[60:63], v[212:215]
    v_exp_f32 v208, v208
    v_mfma_f32_16x16x32_bf16 v[212:215], a[192:195], v[64:67], v[212:215]
    ds_read_b64_tr_b16 a[240:241], v14 offset:16640
    v_mfma_f32_16x16x32_bf16 v[212:215], a[196:199], v[68:71], v[212:215]
    v_exp_f32 v209, v209
    v_mfma_f32_16x16x32_bf16 a[128:131], a[216:219], v[196:199], a[128:131]
    ds_read_b64_tr_b16 a[242:243], v14 offset:20736
    v_cvt_pk_bf16_f32 v132, v208, v209
    v_mfma_f32_16x16x32_bf16 a[160:163], a[180:183], v[164:167], a[160:163]
    v_exp_f32 v210, v210
    v_mfma_f32_16x16x32_bf16 a[4:7], a[224:227], v[164:167], a[4:7]
    buffer_load_dwordx4 v5, s[20:23], s1 offen offset:2048 nt lds
    ds_read_b64_tr_b16 a[244:245], v16 offset:16640
    v_mfma_f32_16x16x32_bf16 a[4:7], a[228:231], v[168:171], a[4:7]
    v_exp_f32 v211, v211
    v_mfma_f32_16x16x32_bf16 v[204:207], a[184:187], v[72:75], v[116:119]
    ds_read_b64_tr_b16 a[246:247], v16 offset:20736
    v_cvt_pk_bf16_f32 v133, v210, v211
    v_mfma_f32_16x16x32_bf16 v[204:207], a[188:191], v[76:79], v[204:207]
    v_exp_f32 v212, v212
    v_mfma_f32_16x16x32_bf16 v[204:207], a[192:195], v[80:83], v[204:207]
    v_mfma_f32_16x16x32_bf16 v[204:207], a[196:199], v[84:87], v[204:207]
    v_exp_f32 v213, v213
    v_mfma_f32_16x16x32_bf16 a[36:39], a[224:227], v[172:175], a[36:39]
    v_cvt_pk_bf16_f32 v140, v212, v213
    v_mfma_f32_16x16x32_bf16 a[36:39], a[228:231], v[176:179], a[36:39]
    v_exp_f32 v214, v214
    v_mfma_f32_16x16x32_bf16 a[68:71], a[224:227], v[180:183], a[68:71]
    s_waitcnt lgkmcnt(0)
    buffer_load_dwordx4 v6, s[20:23], s1 offen offset:3072 nt lds
    v_mfma_f32_16x16x32_bf16 a[68:71], a[228:231], v[184:187], a[68:71]
    v_exp_f32 v215, v215
    v_mfma_f32_16x16x32_bf16 v[208:211], a[184:187], v[88:91], v[120:123]
    s_add_u32 m0, s39, 98304
    v_cvt_pk_bf16_f32 v141, v214, v215
    v_mfma_f32_16x16x32_bf16 v[208:211], a[188:191], v[92:95], v[208:211]
    v_exp_f32 v204, v204
    v_mfma_f32_16x16x32_bf16 v[208:211], a[192:195], v[96:99], v[208:211]
    s_add_u32 s42, s48, 0
    buffer_load_dwordx4 v2, s[8:11], s42 offen lds
    v_mfma_f32_16x16x32_bf16 v[208:211], a[196:199], v[100:103], v[208:211]
    v_exp_f32 v205, v205
    v_mfma_f32_16x16x32_bf16 a[100:103], a[224:227], v[188:191], a[100:103]
    buffer_load_dwordx4 v3, s[8:11], s42 offen offset:1024 lds
    v_cvt_pk_bf16_f32 v148, v204, v205
    v_mfma_f32_16x16x32_bf16 a[100:103], a[228:231], v[192:195], a[100:103]
    v_exp_f32 v206, v206
    v_mfma_f32_16x16x32_bf16 a[132:135], a[224:227], v[196:199], a[132:135]
    ds_read_b128 a[184:187], v12 offset:0
    buffer_load_dwordx4 v4, s[8:11], s42 offen offset:2048 lds
    v_mfma_f32_16x16x32_bf16 a[160:163], a[180:183], v[168:171], a[160:163]
    v_exp_f32 v207, v207
    v_mfma_f32_16x16x32_bf16 v[212:215], a[200:203], v[24:27], v[104:107]
    ds_read_b128 a[188:191], v12 offset:256
    v_cvt_pk_bf16_f32 v149, v206, v207
    v_mfma_f32_16x16x32_bf16 v[212:215], a[204:207], v[28:31], v[212:215]
    v_exp_f32 v208, v208
    v_mfma_f32_16x16x32_bf16 v[212:215], a[208:211], v[32:35], v[212:215]
    ds_read_b128 a[192:195], v12 offset:512
    ds_read_b64_tr_b16 a[216:217], v13 offset:16896
    v_mfma_f32_16x16x32_bf16 v[212:215], a[212:215], v[36:39], v[212:215]
    v_exp_f32 v209, v209
    v_mfma_f32_16x16x32_bf16 a[8:11], a[232:235], v[164:167], a[8:11]
    ds_read_b128 a[196:199], v12 offset:768
    v_cvt_pk_bf16_f32 v156, v208, v209
    v_mfma_f32_16x16x32_bf16 a[8:11], a[236:239], v[168:171], a[8:11]
    v_exp_f32 v210, v210
    v_mfma_f32_16x16x32_bf16 a[40:43], a[232:235], v[172:175], a[40:43]
    ds_read_b64_tr_b16 a[218:219], v13 offset:20992
    buffer_load_dwordx4 v21, s[8:11], s42 offen offset:3072 lds
    v_mfma_f32_16x16x32_bf16 a[40:43], a[236:239], v[176:179], a[40:43]
    v_exp_f32 v211, v211
    v_mfma_f32_16x16x32_bf16 v[204:207], a[200:203], v[40:43], v[108:111]
    ds_read_b64_tr_b16 a[220:221], v15 offset:16896
    v_cvt_pk_bf16_f32 v157, v210, v211
    v_mfma_f32_16x16x32_bf16 v[204:207], a[204:207], v[44:47], v[204:207]
    v_exp_f32 v212, v212
    v_mfma_f32_16x16x32_bf16 v[204:207], a[208:211], v[48:51], v[204:207]
    ds_read_b64_tr_b16 a[222:223], v15 offset:20992
    s_add_u32 m0, s39, 114688
    v_mfma_f32_16x16x32_bf16 v[204:207], a[212:215], v[52:55], v[204:207]
    v_exp_f32 v213, v213
    v_mfma_f32_16x16x32_bf16 a[72:75], a[232:235], v[180:183], a[72:75]
    s_add_u32 s42, s49, 0
    v_cvt_pk_bf16_f32 v126, v212, v213
    v_mfma_f32_16x16x32_bf16 a[72:75], a[236:239], v[184:187], a[72:75]
    v_exp_f32 v214, v214
    v_mfma_f32_16x16x32_bf16 a[104:107], a[232:235], v[188:191], a[104:107]
    buffer_load_dwordx4 v2, s[8:11], s42 offen lds
    v_mfma_f32_16x16x32_bf16 a[104:107], a[236:239], v[192:195], a[104:107]
    v_exp_f32 v215, v215
    v_mfma_f32_16x16x32_bf16 v[208:211], a[200:203], v[56:59], v[112:115]
    ds_read_b64_tr_b16 a[224:225], v14 offset:16896
    v_cvt_pk_bf16_f32 v127, v214, v215
    v_mfma_f32_16x16x32_bf16 v[208:211], a[204:207], v[60:63], v[208:211]
    v_exp_f32 v204, v204
    v_mfma_f32_16x16x32_bf16 v[208:211], a[208:211], v[64:67], v[208:211]
    ds_read_b64_tr_b16 a[226:227], v14 offset:20992
    buffer_load_dwordx4 v3, s[8:11], s42 offen offset:1024 lds
    v_mfma_f32_16x16x32_bf16 v[208:211], a[212:215], v[68:71], v[208:211]
    v_exp_f32 v205, v205
    v_mfma_f32_16x16x32_bf16 a[136:139], a[232:235], v[196:199], a[136:139]
    ds_read_b64_tr_b16 a[228:229], v16 offset:16896
    v_cvt_pk_bf16_f32 v134, v204, v205
    v_mfma_f32_16x16x32_bf16 a[164:167], a[180:183], v[172:175], a[164:167]
    v_exp_f32 v206, v206
    v_mfma_f32_16x16x32_bf16 a[12:15], a[240:243], v[164:167], a[12:15]
    ds_read_b64_tr_b16 a[230:231], v16 offset:20992
    buffer_load_dwordx4 v4, s[8:11], s42 offen offset:2048 lds
    v_mfma_f32_16x16x32_bf16 a[12:15], a[244:247], v[168:171], a[12:15]
    v_exp_f32 v207, v207
    v_mfma_f32_16x16x32_bf16 v[212:215], a[200:203], v[72:75], v[116:119]
    buffer_load_dwordx4 v21, s[8:11], s42 offen offset:3072 lds
    v_cvt_pk_bf16_f32 v135, v206, v207
    v_mfma_f32_16x16x32_bf16 v[212:215], a[204:207], v[76:79], v[212:215]
    v_exp_f32 v208, v208
    v_mfma_f32_16x16x32_bf16 v[212:215], a[208:211], v[80:83], v[212:215]
    s_add_u32 m0, s39, 65536
    v_mfma_f32_16x16x32_bf16 v[212:215], a[212:215], v[84:87], v[212:215]
    v_exp_f32 v209, v209
    v_mfma_f32_16x16x32_bf16 a[44:47], a[240:243], v[172:175], a[44:47]
    s_add_u32 s42, s52, 0
    v_cvt_pk_bf16_f32 v142, v208, v209
    v_mfma_f32_16x16x32_bf16 a[44:47], a[244:247], v[176:179], a[44:47]
    v_exp_f32 v210, v210
    v_mfma_f32_16x16x32_bf16 a[76:79], a[240:243], v[180:183], a[76:79]
    ds_read_b64_tr_b16 a[232:233], v13 offset:17152
    buffer_load_dwordx4 v2, s[8:11], s42 offen lds
    v_mfma_f32_16x16x32_bf16 a[76:79], a[244:247], v[184:187], a[76:79]
    v_exp_f32 v211, v211
    v_mfma_f32_16x16x32_bf16 v[204:207], a[200:203], v[88:91], v[120:123]
    ds_read_b64_tr_b16 a[234:235], v13 offset:21248
    v_cvt_pk_bf16_f32 v143, v210, v211
    v_mfma_f32_16x16x32_bf16 v[204:207], a[204:207], v[92:95], v[204:207]
    v_exp_f32 v212, v212
    v_mfma_f32_16x16x32_bf16 v[204:207], a[208:211], v[96:99], v[204:207]
    ds_read_b64_tr_b16 a[236:237], v15 offset:17152
    buffer_load_dwordx4 v3, s[8:11], s42 offen offset:1024 lds
    v_mfma_f32_16x16x32_bf16 v[204:207], a[212:215], v[100:103], v[204:207]
    v_exp_f32 v213, v213
    v_mfma_f32_16x16x32_bf16 a[108:111], a[240:243], v[188:191], a[108:111]
    ds_read_b64_tr_b16 a[238:239], v15 offset:21248
    v_cvt_pk_bf16_f32 v150, v212, v213
    v_mfma_f32_16x16x32_bf16 a[108:111], a[244:247], v[192:195], a[108:111]
    v_exp_f32 v214, v214
    v_mfma_f32_16x16x32_bf16 a[140:143], a[240:243], v[196:199], a[140:143]
    ds_read_b128 a[200:203], v12 offset:4096
    v_add_u32 v13, s43, v9
    v_mfma_f32_16x16x32_bf16 a[164:167], a[180:183], v[176:179], a[164:167]
    s_waitcnt lgkmcnt(3)
    v_exp_f32 v215, v215
    v_mfma_f32_16x16x32_bf16 v[208:211], a[184:187], v[24:27], v[104:107]
    ds_read_b128 a[204:207], v12 offset:4352
    v_cvt_pk_bf16_f32 v151, v214, v215
    v_mfma_f32_16x16x32_bf16 v[208:211], a[188:191], v[28:31], v[208:211]
    v_exp_f32 v204, v204
    v_mfma_f32_16x16x32_bf16 v[208:211], a[192:195], v[32:35], v[208:211]
    ds_read_b128 a[208:211], v12 offset:4608
    v_add_u32 v15, s43, v10
    v_mfma_f32_16x16x32_bf16 v[208:211], a[196:199], v[36:39], v[208:211]
    v_exp_f32 v205, v205
    v_mfma_f32_16x16x32_bf16 a[16:19], a[216:219], v[164:167], a[16:19]
    ds_read_b128 a[212:215], v12 offset:4864
    v_cvt_pk_bf16_f32 v158, v204, v205
    v_mfma_f32_16x16x32_bf16 a[16:19], a[220:223], v[168:171], a[16:19]
    v_exp_f32 v206, v206
    v_mfma_f32_16x16x32_bf16 a[48:51], a[216:219], v[172:175], a[48:51]
    ds_read_b64_tr_b16 a[240:241], v14 offset:17152
    v_add_u32 v12, s43, v8
    v_mfma_f32_16x16x32_bf16 a[48:51], a[220:223], v[176:179], a[48:51]
    v_exp_f32 v207, v207
    v_mfma_f32_16x16x32_bf16 v[212:215], a[184:187], v[40:43], v[108:111]
    ds_read_b64_tr_b16 a[242:243], v14 offset:21248
    v_cvt_pk_bf16_f32 v159, v206, v207
    v_mfma_f32_16x16x32_bf16 v[212:215], a[188:191], v[44:47], v[212:215]
    v_exp_f32 v208, v208
    v_mfma_f32_16x16x32_bf16 v[212:215], a[192:195], v[48:51], v[212:215]
    ds_read_b64_tr_b16 a[244:245], v16 offset:17152
    buffer_load_dwordx4 v4, s[8:11], s42 offen offset:2048 lds
    v_mfma_f32_16x16x32_bf16 v[212:215], a[196:199], v[52:55], v[212:215]
    v_exp_f32 v209, v209
    v_mfma_f32_16x16x32_bf16 a[80:83], a[216:219], v[180:183], a[80:83]
    ds_read_b64_tr_b16 a[246:247], v16 offset:21248
    v_cvt_pk_bf16_f32 v128, v208, v209
    v_mfma_f32_16x16x32_bf16 a[80:83], a[220:223], v[184:187], a[80:83]
    v_exp_f32 v210, v210
    v_mfma_f32_16x16x32_bf16 a[112:115], a[216:219], v[188:191], a[112:115]
    v_xor_b32 v14, 32, v13
    v_xor_b32 v16, 32, v15
    v_mfma_f32_16x16x32_bf16 a[112:115], a[220:223], v[192:195], a[112:115]
    v_exp_f32 v211, v211
    v_mfma_f32_16x16x32_bf16 v[204:207], a[184:187], v[56:59], v[112:115]
    buffer_load_dwordx4 v21, s[8:11], s42 offen offset:3072 lds
    v_cvt_pk_bf16_f32 v129, v210, v211
    v_mfma_f32_16x16x32_bf16 v[204:207], a[188:191], v[60:63], v[204:207]
    v_exp_f32 v212, v212
    v_mfma_f32_16x16x32_bf16 v[204:207], a[192:195], v[64:67], v[204:207]
    v_mfma_f32_16x16x32_bf16 v[204:207], a[196:199], v[68:71], v[204:207]
    v_exp_f32 v213, v213
    v_mfma_f32_16x16x32_bf16 a[144:147], a[216:219], v[196:199], a[144:147]
    v_cvt_pk_bf16_f32 v136, v212, v213
    v_mfma_f32_16x16x32_bf16 a[168:171], a[180:183], v[180:183], a[168:171]
    v_exp_f32 v214, v214
    v_mfma_f32_16x16x32_bf16 a[20:23], a[224:227], v[164:167], a[20:23]
    v_mfma_f32_16x16x32_bf16 a[20:23], a[228:231], v[168:171], a[20:23]
    v_exp_f32 v215, v215
    v_mfma_f32_16x16x32_bf16 v[208:211], a[184:187], v[72:75], v[116:119]
    v_cvt_pk_bf16_f32 v137, v214, v215
    v_mfma_f32_16x16x32_bf16 v[208:211], a[188:191], v[76:79], v[208:211]
    v_exp_f32 v204, v204
    v_mfma_f32_16x16x32_bf16 v[208:211], a[192:195], v[80:83], v[208:211]
    v_mfma_f32_16x16x32_bf16 v[208:211], a[196:199], v[84:87], v[208:211]
    v_exp_f32 v205, v205
    v_mfma_f32_16x16x32_bf16 a[52:55], a[224:227], v[172:175], a[52:55]
    s_waitcnt lgkmcnt(0)
    v_cvt_pk_bf16_f32 v144, v204, v205
    v_mfma_f32_16x16x32_bf16 a[52:55], a[228:231], v[176:179], a[52:55]
    v_exp_f32 v206, v206
    v_mfma_f32_16x16x32_bf16 a[84:87], a[224:227], v[180:183], a[84:87]
    s_waitcnt vmcnt(17)
    s_barrier
    v_mfma_f32_16x16x32_bf16 a[84:87], a[228:231], v[184:187], a[84:87]
    v_exp_f32 v207, v207
    v_mfma_f32_16x16x32_bf16 v[212:215], a[200:203], v[24:27], v[104:107]
    ds_read_b128 a[184:187], v11 offset:0
    v_cvt_pk_bf16_f32 v145, v206, v207
    v_mfma_f32_16x16x32_bf16 v[212:215], a[204:207], v[28:31], v[212:215]
    v_exp_f32 v208, v208
    v_mfma_f32_16x16x32_bf16 v[212:215], a[208:211], v[32:35], v[212:215]
    ds_read_b128 a[188:191], v11 offset:256
    ds_read_b64_tr_b16 a[216:217], v13 offset:16384
    v_mfma_f32_16x16x32_bf16 v[212:215], a[212:215], v[36:39], v[212:215]
    v_exp_f32 v209, v209
    v_mfma_f32_16x16x32_bf16 a[116:119], a[224:227], v[188:191], a[116:119]
    ds_read_b128 a[192:195], v11 offset:512
    v_cvt_pk_bf16_f32 v152, v208, v209
    v_mfma_f32_16x16x32_bf16 a[116:119], a[228:231], v[192:195], a[116:119]
    v_exp_f32 v210, v210
    v_mfma_f32_16x16x32_bf16 a[148:151], a[224:227], v[196:199], a[148:151]
    ds_read_b128 a[196:199], v11 offset:768
    ds_read_b64_tr_b16 a[218:219], v13 offset:20480
    v_mfma_f32_16x16x32_bf16 a[168:171], a[180:183], v[184:187], a[168:171]
    v_exp_f32 v211, v211
    v_mfma_f32_16x16x32_bf16 v[204:207], a[200:203], v[40:43], v[108:111]
    ds_read_b64_tr_b16 a[220:221], v15 offset:16384
    v_cvt_pk_bf16_f32 v153, v210, v211
    v_mfma_f32_16x16x32_bf16 v[204:207], a[204:207], v[44:47], v[204:207]
    v_exp_f32 v212, v212
    v_mfma_f32_16x16x32_bf16 v[204:207], a[208:211], v[48:51], v[204:207]
    ds_read_b64_tr_b16 a[222:223], v15 offset:20480
    s_add_u32 m0, s39, 131072
    v_mfma_f32_16x16x32_bf16 v[204:207], a[212:215], v[52:55], v[204:207]
    v_exp_f32 v213, v213
    v_mfma_f32_16x16x32_bf16 a[24:27], a[232:235], v[164:167], a[24:27]
    s_add_u32 s42, s50, 0
    v_cvt_pk_bf16_f32 v130, v212, v213
    v_mfma_f32_16x16x32_bf16 a[24:27], a[236:239], v[168:171], a[24:27]
    v_exp_f32 v214, v214
    v_mfma_f32_16x16x32_bf16 a[56:59], a[232:235], v[172:175], a[56:59]
    buffer_load_dwordx4 v2, s[8:11], s42 offen lds
    v_mfma_f32_16x16x32_bf16 a[56:59], a[236:239], v[176:179], a[56:59]
    v_exp_f32 v215, v215
    v_mfma_f32_16x16x32_bf16 v[208:211], a[200:203], v[56:59], v[112:115]
    ds_read_b64_tr_b16 a[224:225], v14 offset:16384
    v_cvt_pk_bf16_f32 v131, v214, v215
    v_mfma_f32_16x16x32_bf16 v[208:211], a[204:207], v[60:63], v[208:211]
    v_exp_f32 v204, v204
    v_mfma_f32_16x16x32_bf16 v[208:211], a[208:211], v[64:67], v[208:211]
    ds_read_b64_tr_b16 a[226:227], v14 offset:20480
    buffer_load_dwordx4 v3, s[8:11], s42 offen offset:1024 lds
    v_mfma_f32_16x16x32_bf16 v[208:211], a[212:215], v[68:71], v[208:211]
    v_exp_f32 v205, v205
    v_mfma_f32_16x16x32_bf16 a[88:91], a[232:235], v[180:183], a[88:91]
    ds_read_b64_tr_b16 a[228:229], v16 offset:16384
    v_cvt_pk_bf16_f32 v138, v204, v205
    v_mfma_f32_16x16x32_bf16 a[88:91], a[236:239], v[184:187], a[88:91]
    v_exp_f32 v206, v206
    v_mfma_f32_16x16x32_bf16 a[120:123], a[232:235], v[188:191], a[120:123]
    ds_read_b64_tr_b16 a[230:231], v16 offset:20480
    buffer_load_dwordx4 v4, s[8:11], s42 offen offset:2048 lds
    v_mfma_f32_16x16x32_bf16 a[120:123], a[236:239], v[192:195], a[120:123]
    v_exp_f32 v207, v207
    v_mfma_f32_16x16x32_bf16 v[212:215], a[200:203], v[72:75], v[116:119]
    v_cvt_pk_bf16_f32 v139, v206, v207
    v_mfma_f32_16x16x32_bf16 v[212:215], a[204:207], v[76:79], v[212:215]
    v_exp_f32 v208, v208
    v_mfma_f32_16x16x32_bf16 v[212:215], a[208:211], v[80:83], v[212:215]
    buffer_load_dwordx4 v21, s[8:11], s42 offen offset:3072 lds
    v_mfma_f32_16x16x32_bf16 v[212:215], a[212:215], v[84:87], v[212:215]
    v_exp_f32 v209, v209
    v_mfma_f32_16x16x32_bf16 a[152:155], a[232:235], v[196:199], a[152:155]
    v_cvt_pk_bf16_f32 v146, v208, v209
    v_mfma_f32_16x16x32_bf16 a[172:175], a[180:183], v[188:191], a[172:175]
    v_exp_f32 v210, v210
    v_mfma_f32_16x16x32_bf16 a[28:31], a[240:243], v[164:167], a[28:31]
    v_mfma_f32_16x16x32_bf16 a[28:31], a[244:247], v[168:171], a[28:31]
    v_exp_f32 v211, v211
    v_mfma_f32_16x16x32_bf16 a[60:63], a[240:243], v[172:175], a[60:63]
    v_cvt_pk_bf16_f32 v147, v210, v211
    v_mfma_f32_16x16x32_bf16 a[60:63], a[244:247], v[176:179], a[60:63]
    v_exp_f32 v212, v212
    v_mfma_f32_16x16x32_bf16 a[92:95], a[240:243], v[180:183], a[92:95]
    buffer_load_dword v0, v22, s[28:31], s101 offen sc1
    v_mfma_f32_16x16x32_bf16 a[92:95], a[244:247], v[184:187], a[92:95]
    v_exp_f32 v213, v213
    v_mfma_f32_16x16x32_bf16 a[124:127], a[240:243], v[188:191], a[124:127]
    v_cvt_pk_bf16_f32 v154, v212, v213
    v_mfma_f32_16x16x32_bf16 a[124:127], a[244:247], v[192:195], a[124:127]
    v_exp_f32 v214, v214
    v_mfma_f32_16x16x32_bf16 a[156:159], a[240:243], v[196:199], a[156:159]
    s_waitcnt lgkmcnt(0)
    v_mfma_f32_16x16x32_bf16 a[172:175], a[180:183], v[192:195], a[172:175]
    v_exp_f32 v215, v215
    v_mfma_f32_16x16x32_bf16 a[176:179], a[180:183], v[196:199], a[176:179]
    v_cvt_pk_bf16_f32 v155, v214, v215
    v_mfma_f32_16x16x32_bf16 v[204:207], a[184:187], v[24:27], v[104:107]
    ds_read_b128 a[200:203], v11 offset:4096
    ds_read_b128 a[204:207], v11 offset:4352
    v_mfma_f32_16x16x32_bf16 v[204:207], a[188:191], v[28:31], v[204:207]
    ds_read_b128 a[208:211], v11 offset:4608
    ds_read_b128 a[212:215], v11 offset:4864
    v_mfma_f32_16x16x32_bf16 v[204:207], a[192:195], v[32:35], v[204:207]
    ds_read_b64_tr_b16 a[232:233], v13 offset:16640
    ds_read_b64_tr_b16 a[234:235], v13 offset:20736
    v_mfma_f32_16x16x32_bf16 v[204:207], a[196:199], v[36:39], v[204:207]
    ds_read_b64_tr_b16 a[236:237], v15 offset:16640
    ds_read_b64_tr_b16 a[238:239], v15 offset:20736
    v_mfma_f32_16x16x32_bf16 a[0:3], a[216:219], v[124:127], a[0:3]
    s_mov_b32 s43, 65536
    v_add_u32 v18, 65536, v17
    v_mfma_f32_16x16x32_bf16 a[0:3], a[220:223], v[128:131], a[0:3]
    s_add_u32 m0, s39, 147456
    v_xor_b32 v19, 32, v18
    v_mfma_f32_16x16x32_bf16 a[32:35], a[216:219], v[132:135], a[32:35]
    s_add_u32 s42, s51, 0
    buffer_load_dwordx4 v2, s[8:11], s42 offen lds
    v_mfma_f32_16x16x32_bf16 a[32:35], a[220:223], v[136:139], a[32:35]
    v_mfma_f32_16x16x32_bf16 v[208:211], a[184:187], v[40:43], v[108:111]
    buffer_load_dwordx4 v3, s[8:11], s42 offen offset:1024 lds
    v_mfma_f32_16x16x32_bf16 v[208:211], a[188:191], v[44:47], v[208:211]
    v_exp_f32 v204, v204
    v_mfma_f32_16x16x32_bf16 v[208:211], a[192:195], v[48:51], v[208:211]
    buffer_load_dwordx4 v4, s[8:11], s42 offen offset:2048 lds
    v_mfma_f32_16x16x32_bf16 v[208:211], a[196:199], v[52:55], v[208:211]
    v_exp_f32 v205, v205
    v_mfma_f32_16x16x32_bf16 a[64:67], a[216:219], v[140:143], a[64:67]
    buffer_load_dwordx4 v21, s[8:11], s42 offen offset:3072 lds
    v_cvt_pk_bf16_f32 v164, v204, v205
    v_mfma_f32_16x16x32_bf16 a[64:67], a[220:223], v[144:147], a[64:67]
    v_exp_f32 v206, v206
    v_mfma_f32_16x16x32_bf16 a[96:99], a[216:219], v[148:151], a[96:99]
    s_waitcnt vmcnt(13)
    v_mfma_f32_16x16x32_bf16 a[96:99], a[220:223], v[152:155], a[96:99]
    v_exp_f32 v207, v207
    v_mfma_f32_16x16x32_bf16 v[212:215], a[184:187], v[56:59], v[112:115]
    ds_read_b64_tr_b16 v[224:225], v18 offset:32768
    v_cvt_pk_bf16_f32 v165, v206, v207
    v_mfma_f32_16x16x32_bf16 v[212:215], a[188:191], v[60:63], v[212:215]
    v_exp_f32 v208, v208
    v_mfma_f32_16x16x32_bf16 v[212:215], a[192:195], v[64:67], v[212:215]
    ds_read_b64_tr_b16 a[240:241], v14 offset:16640
    ds_read_b64_tr_b16 v[226:227], v18 offset:34816
    v_mfma_f32_16x16x32_bf16 v[212:215], a[196:199], v[68:71], v[212:215]
    v_exp_f32 v209, v209
    v_mfma_f32_16x16x32_bf16 a[128:131], a[216:219], v[156:159], a[128:131]
    ds_read_b64_tr_b16 a[242:243], v14 offset:20736
    v_cvt_pk_bf16_f32 v172, v208, v209
    v_mfma_f32_16x16x32_bf16 a[160:163], a[180:183], v[124:127], a[160:163]
    v_exp_f32 v210, v210
    v_mfma_f32_16x16x32_bf16 a[4:7], a[224:227], v[124:127], a[4:7]
    ds_read_b64_tr_b16 a[244:245], v16 offset:16640
    ds_read_b64_tr_b16 v[228:229], v19 offset:32768
    v_mfma_f32_16x16x32_bf16 a[4:7], a[228:231], v[128:131], a[4:7]
    v_exp_f32 v211, v211
    v_mfma_f32_16x16x32_bf16 v[204:207], a[184:187], v[72:75], v[116:119]
    ds_read_b64_tr_b16 a[246:247], v16 offset:20736
    v_cvt_pk_bf16_f32 v173, v210, v211
    v_mfma_f32_16x16x32_bf16 v[204:207], a[188:191], v[76:79], v[204:207]
    v_exp_f32 v212, v212
    v_mfma_f32_16x16x32_bf16 v[204:207], a[192:195], v[80:83], v[204:207]
    ds_read_b64_tr_b16 v[230:231], v19 offset:34816
    ds_read_b64_tr_b16 v[232:233], v18 offset:33280
    v_mfma_f32_16x16x32_bf16 v[204:207], a[196:199], v[84:87], v[204:207]
    v_exp_f32 v213, v213
    v_mfma_f32_16x16x32_bf16 a[36:39], a[224:227], v[132:135], a[36:39]
    ds_read_b64_tr_b16 v[234:235], v18 offset:35328
    v_cvt_pk_bf16_f32 v180, v212, v213
    v_mfma_f32_16x16x32_bf16 a[36:39], a[228:231], v[136:139], a[36:39]
    v_exp_f32 v214, v214
    v_mfma_f32_16x16x32_bf16 a[68:71], a[224:227], v[140:143], a[68:71]
    ds_read_b64_tr_b16 v[236:237], v19 offset:33280
    ds_read_b64_tr_b16 v[238:239], v19 offset:35328
    v_mfma_f32_16x16x32_bf16 a[68:71], a[228:231], v[144:147], a[68:71]
    v_exp_f32 v215, v215
    v_mfma_f32_16x16x32_bf16 v[208:211], a[184:187], v[88:91], v[120:123]
    ds_read_b64_tr_b16 v[240:241], v18 offset:49152
    v_cvt_pk_bf16_f32 v181, v214, v215
    v_mfma_f32_16x16x32_bf16 v[208:211], a[188:191], v[92:95], v[208:211]
    v_exp_f32 v204, v204
    v_mfma_f32_16x16x32_bf16 v[208:211], a[192:195], v[96:99], v[208:211]
    ds_read_b64_tr_b16 v[242:243], v18 offset:51200
    ds_read_b64_tr_b16 v[244:245], v19 offset:49152
    v_mfma_f32_16x16x32_bf16 v[208:211], a[196:199], v[100:103], v[208:211]
    v_exp_f32 v205, v205
    v_mfma_f32_16x16x32_bf16 a[100:103], a[224:227], v[148:151], a[100:103]
    ds_read_b64_tr_b16 v[246:247], v19 offset:51200
    v_cvt_pk_bf16_f32 v188, v204, v205
    v_mfma_f32_16x16x32_bf16 a[100:103], a[228:231], v[152:155], a[100:103]
    v_exp_f32 v206, v206
    v_mfma_f32_16x16x32_bf16 a[132:135], a[224:227], v[156:159], a[132:135]
    ds_read_b128 a[184:187], v12 offset:0
    ds_read_b64_tr_b16 v[248:249], v18 offset:49664
    v_mfma_f32_16x16x32_bf16 a[160:163], a[180:183], v[128:131], a[160:163]
    s_waitcnt lgkmcnt(5)
    v_exp_f32 v207, v207
    v_mfma_f32_16x16x32_bf16 v[212:215], a[200:203], v[24:27], v[104:107]
    ds_read_b128 a[188:191], v12 offset:256
    v_cvt_pk_bf16_f32 v189, v206, v207
    v_mfma_f32_16x16x32_bf16 v[212:215], a[204:207], v[28:31], v[212:215]
    v_exp_f32 v208, v208
    v_mfma_f32_16x16x32_bf16 v[212:215], a[208:211], v[32:35], v[212:215]
    ds_read_b128 a[192:195], v12 offset:512
    ds_read_b64_tr_b16 a[216:217], v13 offset:16896
    v_mfma_f32_16x16x32_bf16 v[212:215], a[212:215], v[36:39], v[212:215]
    v_exp_f32 v209, v209
    v_mfma_f32_16x16x32_bf16 a[8:11], a[232:235], v[124:127], a[8:11]
    ds_read_b128 a[196:199], v12 offset:768
    v_cvt_pk_bf16_f32 v196, v208, v209
    v_mfma_f32_16x16x32_bf16 a[8:11], a[236:239], v[128:131], a[8:11]
    v_exp_f32 v210, v210
    v_mfma_f32_16x16x32_bf16 a[40:43], a[232:235], v[132:135], a[40:43]
    ds_read_b64_tr_b16 a[218:219], v13 offset:20992
    ds_read_b64_tr_b16 v[250:251], v18 offset:51712
    v_mfma_f32_16x16x32_bf16 a[40:43], a[236:239], v[136:139], a[40:43]
    v_exp_f32 v211, v211
    v_mfma_f32_16x16x32_bf16 v[204:207], a[200:203], v[40:43], v[108:111]
    ds_read_b64_tr_b16 a[220:221], v15 offset:16896
    v_cvt_pk_bf16_f32 v197, v210, v211
    v_mfma_f32_16x16x32_bf16 v[204:207], a[204:207], v[44:47], v[204:207]
    v_exp_f32 v212, v212
    v_mfma_f32_16x16x32_bf16 v[204:207], a[208:211], v[48:51], v[204:207]
    ds_read_b64_tr_b16 a[222:223], v15 offset:20992
    ds_read_b64_tr_b16 v[252:253], v19 offset:49664
    v_mfma_f32_16x16x32_bf16 v[204:207], a[212:215], v[52:55], v[204:207]
    v_exp_f32 v213, v213
    v_mfma_f32_16x16x32_bf16 a[72:75], a[232:235], v[140:143], a[72:75]
    ds_read_b64_tr_b16 v[254:255], v19 offset:51712
    v_cvt_pk_bf16_f32 v166, v212, v213
    v_mfma_f32_16x16x32_bf16 a[72:75], a[236:239], v[144:147], a[72:75]
    v_exp_f32 v214, v214
    v_mfma_f32_16x16x32_bf16 a[104:107], a[232:235], v[148:151], a[104:107]
    v_mfma_f32_16x16x32_bf16 a[104:107], a[236:239], v[152:155], a[104:107]
    v_exp_f32 v215, v215
    v_mfma_f32_16x16x32_bf16 v[208:211], a[200:203], v[56:59], v[112:115]
    ds_read_b64_tr_b16 a[224:225], v14 offset:16896
    v_cvt_pk_bf16_f32 v167, v214, v215
    v_mfma_f32_16x16x32_bf16 v[208:211], a[204:207], v[60:63], v[208:211]
    v_exp_f32 v204, v204
    v_mfma_f32_16x16x32_bf16 v[208:211], a[208:211], v[64:67], v[208:211]
    ds_read_b64_tr_b16 a[226:227], v14 offset:20992
    v_mfma_f32_16x16x32_bf16 v[208:211], a[212:215], v[68:71], v[208:211]
    v_exp_f32 v205, v205
    v_mfma_f32_16x16x32_bf16 a[136:139], a[232:235], v[156:159], a[136:139]
    ds_read_b64_tr_b16 a[228:229], v16 offset:16896
    v_cvt_pk_bf16_f32 v174, v204, v205
    v_mfma_f32_16x16x32_bf16 a[164:167], a[180:183], v[132:135], a[164:167]
    v_exp_f32 v206, v206
    v_mfma_f32_16x16x32_bf16 a[12:15], a[240:243], v[124:127], a[12:15]
    ds_read_b64_tr_b16 a[230:231], v16 offset:20992
    v_mfma_f32_16x16x32_bf16 a[12:15], a[244:247], v[128:131], a[12:15]
    v_exp_f32 v207, v207
    v_mfma_f32_16x16x32_bf16 v[212:215], a[200:203], v[72:75], v[116:119]
    s_waitcnt lgkmcnt(0)
    v_cvt_pk_bf16_f32 v175, v206, v207
    v_mfma_f32_16x16x32_bf16 v[212:215], a[204:207], v[76:79], v[212:215]
    v_exp_f32 v208, v208
    v_mfma_f32_16x16x32_bf16 v[212:215], a[208:211], v[80:83], v[212:215]
    s_add_u32 m0, s39, 98304
    v_mfma_f32_16x16x32_bf16 v[212:215], a[212:215], v[84:87], v[212:215]
    v_exp_f32 v209, v209
    v_mfma_f32_16x16x32_bf16 a[44:47], a[240:243], v[132:135], a[44:47]
    s_add_u32 s42, s50, 294912
    v_cvt_pk_bf16_f32 v182, v208, v209
    v_mfma_f32_16x16x32_bf16 a[44:47], a[244:247], v[136:139], a[44:47]
    v_exp_f32 v210, v210
    v_mfma_f32_16x16x32_bf16 a[76:79], a[240:243], v[140:143], a[76:79]
    ds_read_b64_tr_b16 a[232:233], v13 offset:17152
    buffer_load_dwordx4 v2, s[8:11], s42 offen lds
    v_mfma_f32_16x16x32_bf16 a[76:79], a[244:247], v[144:147], a[76:79]
    v_exp_f32 v211, v211
    v_mfma_f32_16x16x32_bf16 v[204:207], a[200:203], v[88:91], v[120:123]
    ds_read_b64_tr_b16 a[234:235], v13 offset:21248
    v_cvt_pk_bf16_f32 v183, v210, v211
    v_mfma_f32_16x16x32_bf16 v[204:207], a[204:207], v[92:95], v[204:207]
    v_exp_f32 v212, v212
    v_mfma_f32_16x16x32_bf16 v[204:207], a[208:211], v[96:99], v[204:207]
    ds_read_b64_tr_b16 a[236:237], v15 offset:17152
    buffer_load_dwordx4 v3, s[8:11], s42 offen offset:1024 lds
    v_mfma_f32_16x16x32_bf16 v[204:207], a[212:215], v[100:103], v[204:207]
    v_exp_f32 v213, v213
    v_mfma_f32_16x16x32_bf16 a[108:111], a[240:243], v[148:151], a[108:111]
    ds_read_b64_tr_b16 a[238:239], v15 offset:21248
    v_cvt_pk_bf16_f32 v190, v212, v213
    v_mfma_f32_16x16x32_bf16 a[108:111], a[244:247], v[152:155], a[108:111]
    v_exp_f32 v214, v214
    v_mfma_f32_16x16x32_bf16 a[140:143], a[240:243], v[156:159], a[140:143]
    ds_read_b128 a[200:203], v12 offset:4096
    v_add_u32 v13, s43, v9
    v_mfma_f32_16x16x32_bf16 a[164:167], a[180:183], v[136:139], a[164:167]
    v_exp_f32 v215, v215
    v_mfma_f32_16x16x32_bf16 v[208:211], a[184:187], v[24:27], v[104:107]
    ds_read_b128 a[204:207], v12 offset:4352
    v_cvt_pk_bf16_f32 v191, v214, v215
    v_mfma_f32_16x16x32_bf16 v[208:211], a[188:191], v[28:31], v[208:211]
    v_exp_f32 v204, v204
    v_mfma_f32_16x16x32_bf16 v[208:211], a[192:195], v[32:35], v[208:211]
    ds_read_b128 a[208:211], v12 offset:4608
    v_add_u32 v15, s43, v10
    v_mfma_f32_16x16x32_bf16 v[208:211], a[196:199], v[36:39], v[208:211]
    v_exp_f32 v205, v205
    v_mfma_f32_16x16x32_bf16 a[16:19], a[216:219], v[124:127], a[16:19]
    ds_read_b128 a[212:215], v12 offset:4864
    v_cvt_pk_bf16_f32 v198, v204, v205
    v_mfma_f32_16x16x32_bf16 a[16:19], a[220:223], v[128:131], a[16:19]
    v_exp_f32 v206, v206
    v_mfma_f32_16x16x32_bf16 a[48:51], a[216:219], v[132:135], a[48:51]
    ds_read_b64_tr_b16 a[240:241], v14 offset:17152
    buffer_load_dwordx4 v4, s[8:11], s42 offen offset:2048 lds
    v_mfma_f32_16x16x32_bf16 a[48:51], a[220:223], v[136:139], a[48:51]
    v_exp_f32 v207, v207
    v_mfma_f32_16x16x32_bf16 v[212:215], a[184:187], v[40:43], v[108:111]
    ds_read_b64_tr_b16 a[242:243], v14 offset:21248
    v_cvt_pk_bf16_f32 v199, v206, v207
    v_mfma_f32_16x16x32_bf16 v[212:215], a[188:191], v[44:47], v[212:215]
    v_exp_f32 v208, v208
    v_mfma_f32_16x16x32_bf16 v[212:215], a[192:195], v[48:51], v[212:215]
    ds_read_b64_tr_b16 a[244:245], v16 offset:17152
    buffer_load_dwordx4 v21, s[8:11], s42 offen offset:3072 lds
    v_mfma_f32_16x16x32_bf16 v[212:215], a[196:199], v[52:55], v[212:215]
    v_exp_f32 v209, v209
    v_mfma_f32_16x16x32_bf16 a[80:83], a[216:219], v[140:143], a[80:83]
    ds_read_b64_tr_b16 a[246:247], v16 offset:21248
    v_cvt_pk_bf16_f32 v168, v208, v209
    v_mfma_f32_16x16x32_bf16 a[80:83], a[220:223], v[144:147], a[80:83]
    v_exp_f32 v210, v210
    v_mfma_f32_16x16x32_bf16 a[112:115], a[216:219], v[148:151], a[112:115]
    v_xor_b32 v14, 32, v13
    v_xor_b32 v16, 32, v15
    v_mfma_f32_16x16x32_bf16 a[112:115], a[220:223], v[152:155], a[112:115]
    v_exp_f32 v211, v211
    v_mfma_f32_16x16x32_bf16 v[204:207], a[184:187], v[56:59], v[112:115]
    s_add_u32 m0, s39, 114688
    v_cvt_pk_bf16_f32 v169, v210, v211
    v_mfma_f32_16x16x32_bf16 v[204:207], a[188:191], v[60:63], v[204:207]
    v_exp_f32 v212, v212
    v_mfma_f32_16x16x32_bf16 v[204:207], a[192:195], v[64:67], v[204:207]
    s_add_u32 s42, s51, 294912
    buffer_load_dwordx4 v2, s[8:11], s42 offen lds
    v_mfma_f32_16x16x32_bf16 v[204:207], a[196:199], v[68:71], v[204:207]
    v_exp_f32 v213, v213
    v_mfma_f32_16x16x32_bf16 a[144:147], a[216:219], v[156:159], a[144:147]
    buffer_load_dwordx4 v3, s[8:11], s42 offen offset:1024 lds
    v_cvt_pk_bf16_f32 v176, v212, v213
    v_mfma_f32_16x16x32_bf16 a[168:171], a[180:183], v[140:143], a[168:171]
    v_exp_f32 v214, v214
    v_mfma_f32_16x16x32_bf16 a[20:23], a[224:227], v[124:127], a[20:23]
    buffer_load_dwordx4 v4, s[8:11], s42 offen offset:2048 lds
    v_mfma_f32_16x16x32_bf16 a[20:23], a[228:231], v[128:131], a[20:23]
    v_exp_f32 v215, v215
    v_mfma_f32_16x16x32_bf16 v[208:211], a[184:187], v[72:75], v[116:119]
    buffer_load_dwordx4 v21, s[8:11], s42 offen offset:3072 lds
    v_cvt_pk_bf16_f32 v177, v214, v215
    v_mfma_f32_16x16x32_bf16 v[208:211], a[188:191], v[76:79], v[208:211]
    v_exp_f32 v204, v204
    v_mfma_f32_16x16x32_bf16 v[208:211], a[192:195], v[80:83], v[208:211]
    v_mfma_f32_16x16x32_bf16 v[208:211], a[196:199], v[84:87], v[208:211]
    v_exp_f32 v205, v205
    v_mfma_f32_16x16x32_bf16 a[52:55], a[224:227], v[132:135], a[52:55]
    v_cvt_pk_bf16_f32 v184, v204, v205
    v_mfma_f32_16x16x32_bf16 a[52:55], a[228:231], v[136:139], a[52:55]
    v_exp_f32 v206, v206
    v_mfma_f32_16x16x32_bf16 a[84:87], a[224:227], v[140:143], a[84:87]
    s_waitcnt vmcnt(29) lgkmcnt(0)
    s_barrier
    v_mfma_f32_16x16x32_bf16 a[84:87], a[228:231], v[144:147], a[84:87]
    v_exp_f32 v207, v207
    v_mfma_f32_16x16x32_bf16 v[212:215], a[200:203], v[24:27], v[104:107]
    s_add_u32 m0, s39, 16384
    v_cvt_pk_bf16_f32 v185, v206, v207
    v_mfma_f32_16x16x32_bf16 v[212:215], a[204:207], v[28:31], v[212:215]
    v_exp_f32 v208, v208
    v_mfma_f32_16x16x32_bf16 v[212:215], a[208:211], v[32:35], v[212:215]
    s_add_u32 s42, s53, 0
    buffer_load_dwordx4 v2, s[8:11], s42 offen lds
    v_mfma_f32_16x16x32_bf16 v[212:215], a[212:215], v[36:39], v[212:215]
    v_exp_f32 v209, v209
    v_mfma_f32_16x16x32_bf16 a[116:119], a[224:227], v[148:151], a[116:119]
    buffer_load_dwordx4 v3, s[8:11], s42 offen offset:1024 lds
    v_cvt_pk_bf16_f32 v192, v208, v209
    v_mfma_f32_16x16x32_bf16 a[116:119], a[228:231], v[152:155], a[116:119]
    v_exp_f32 v210, v210
    v_mfma_f32_16x16x32_bf16 a[148:151], a[224:227], v[156:159], a[148:151]
    buffer_load_dwordx4 v4, s[8:11], s42 offen offset:2048 lds
    ds_read_b64_tr_b16 a[216:217], v13 offset:16384
    v_mfma_f32_16x16x32_bf16 a[168:171], a[180:183], v[144:147], a[168:171]
    v_exp_f32 v211, v211
    v_mfma_f32_16x16x32_bf16 v[204:207], a[200:203], v[40:43], v[108:111]
    buffer_load_dwordx4 v21, s[8:11], s42 offen offset:3072 lds
    v_cvt_pk_bf16_f32 v193, v210, v211
    v_mfma_f32_16x16x32_bf16 v[204:207], a[204:207], v[44:47], v[204:207]
    v_exp_f32 v212, v212
    v_mfma_f32_16x16x32_bf16 v[204:207], a[208:211], v[48:51], v[204:207]
    s_add_u32 m0, s39, 49152
    ds_read_b64_tr_b16 a[218:219], v13 offset:20480
    v_mfma_f32_16x16x32_bf16 v[204:207], a[212:215], v[52:55], v[204:207]
    v_exp_f32 v213, v213
    v_mfma_f32_16x16x32_bf16 a[24:27], a[232:235], v[124:127], a[24:27]
    s_add_u32 s42, s86, 0
    v_cvt_pk_bf16_f32 v170, v212, v213
    v_mfma_f32_16x16x32_bf16 a[24:27], a[236:239], v[128:131], a[24:27]
    v_exp_f32 v214, v214
    v_mfma_f32_16x16x32_bf16 a[56:59], a[232:235], v[132:135], a[56:59]
    buffer_load_dwordx4 v2, s[8:11], s42 offen lds
    ds_read_b64_tr_b16 a[220:221], v15 offset:16384
    v_mfma_f32_16x16x32_bf16 a[56:59], a[236:239], v[136:139], a[56:59]
    v_exp_f32 v215, v215
    v_mfma_f32_16x16x32_bf16 v[208:211], a[200:203], v[56:59], v[112:115]
    buffer_load_dwordx4 v3, s[8:11], s42 offen offset:1024 lds
    v_cvt_pk_bf16_f32 v171, v214, v215
    v_mfma_f32_16x16x32_bf16 v[208:211], a[204:207], v[60:63], v[208:211]
    v_exp_f32 v204, v204
    v_mfma_f32_16x16x32_bf16 v[208:211], a[208:211], v[64:67], v[208:211]
    buffer_load_dwordx4 v4, s[8:11], s42 offen offset:2048 lds
    ds_read_b64_tr_b16 a[222:223], v15 offset:20480
    v_mfma_f32_16x16x32_bf16 v[208:211], a[212:215], v[68:71], v[208:211]
    v_exp_f32 v205, v205
    v_mfma_f32_16x16x32_bf16 a[88:91], a[232:235], v[140:143], a[88:91]
    buffer_load_dwordx4 v21, s[8:11], s42 offen offset:3072 lds
    v_cvt_pk_bf16_f32 v178, v204, v205
    v_mfma_f32_16x16x32_bf16 a[88:91], a[236:239], v[144:147], a[88:91]
    v_exp_f32 v206, v206
    v_mfma_f32_16x16x32_bf16 a[120:123], a[232:235], v[148:151], a[120:123]
    ds_read_b64_tr_b16 a[224:225], v14 offset:16384
    ds_read_b64_tr_b16 a[226:227], v14 offset:20480
    v_mfma_f32_16x16x32_bf16 a[120:123], a[236:239], v[152:155], a[120:123]
    v_exp_f32 v207, v207
    v_mfma_f32_16x16x32_bf16 v[212:215], a[200:203], v[72:75], v[116:119]
    ds_read_b64_tr_b16 a[228:229], v16 offset:16384
    v_cvt_pk_bf16_f32 v179, v206, v207
    v_mfma_f32_16x16x32_bf16 v[212:215], a[204:207], v[76:79], v[212:215]
    v_exp_f32 v208, v208
    v_mfma_f32_16x16x32_bf16 v[212:215], a[208:211], v[80:83], v[212:215]
    ds_read_b64_tr_b16 a[230:231], v16 offset:20480
    ds_read_b64_tr_b16 a[184:185], v13 offset:16896
    v_mfma_f32_16x16x32_bf16 v[212:215], a[212:215], v[84:87], v[212:215]
    v_exp_f32 v209, v209
    v_mfma_f32_16x16x32_bf16 a[152:155], a[232:235], v[156:159], a[152:155]
    ds_read_b64_tr_b16 a[186:187], v13 offset:20992
    v_cvt_pk_bf16_f32 v186, v208, v209
    v_mfma_f32_16x16x32_bf16 a[172:175], a[180:183], v[148:151], a[172:175]
    v_exp_f32 v210, v210
    v_mfma_f32_16x16x32_bf16 a[28:31], a[240:243], v[124:127], a[28:31]
    ds_read_b64_tr_b16 a[188:189], v15 offset:16896
    ds_read_b64_tr_b16 a[190:191], v15 offset:20992
    v_mfma_f32_16x16x32_bf16 a[28:31], a[244:247], v[128:131], a[28:31]
    v_exp_f32 v211, v211
    v_mfma_f32_16x16x32_bf16 a[60:63], a[240:243], v[132:135], a[60:63]
    ds_read_b64_tr_b16 a[232:233], v13 offset:16640
    v_cvt_pk_bf16_f32 v187, v210, v211
    v_mfma_f32_16x16x32_bf16 a[60:63], a[244:247], v[136:139], a[60:63]
    v_exp_f32 v212, v212
    v_mfma_f32_16x16x32_bf16 a[92:95], a[240:243], v[140:143], a[92:95]
    ds_read_b64_tr_b16 a[234:235], v13 offset:20736
    ds_read_b64_tr_b16 a[236:237], v15 offset:16640
    v_mfma_f32_16x16x32_bf16 a[92:95], a[244:247], v[144:147], a[92:95]
    v_exp_f32 v213, v213
    v_mfma_f32_16x16x32_bf16 a[124:127], a[240:243], v[148:151], a[124:127]
    ds_read_b64_tr_b16 a[238:239], v15 offset:20736
    v_cvt_pk_bf16_f32 v194, v212, v213
    v_mfma_f32_16x16x32_bf16 a[124:127], a[244:247], v[152:155], a[124:127]
    v_exp_f32 v214, v214
    v_mfma_f32_16x16x32_bf16 a[156:159], a[240:243], v[156:159], a[156:159]
    ds_read_b64_tr_b16 a[192:193], v14 offset:16896
    ds_read_b64_tr_b16 a[194:195], v14 offset:20992
    v_mfma_f32_16x16x32_bf16 a[172:175], a[180:183], v[152:155], a[172:175]
    v_exp_f32 v215, v215
    v_mfma_f32_16x16x32_bf16 a[176:179], a[180:183], v[156:159], a[176:179]
    ds_read_b64_tr_b16 a[196:197], v16 offset:16896
    v_cvt_pk_bf16_f32 v195, v214, v215
    s_nop 0
    v_mfma_f32_16x16x32_bf16 a[160:163], a[180:183], v[164:167], a[160:163]
    ds_read_b64_tr_b16 a[198:199], v16 offset:20992
    ds_read_b64_tr_b16 a[240:241], v14 offset:16640
    ds_read_b64_tr_b16 a[242:243], v14 offset:20736
    v_mfma_f32_16x16x32_bf16 a[160:163], a[180:183], v[168:171], a[160:163]
    s_waitcnt lgkmcnt(6)
    ds_read_b64_tr_b16 a[244:245], v16 offset:16640
    ds_read_b64_tr_b16 a[246:247], v16 offset:20736
    ds_read_b64_tr_b16 a[200:201], v13 offset:17152
    s_mul_i32 s4, s38, 524288
    s_add_u32 s5, s4, 131072
    v_mfma_f32_16x16x32_bf16 a[0:3], a[216:219], v[164:167], a[0:3]
    ds_read_b64_tr_b16 a[202:203], v13 offset:21248
    ds_read_b64_tr_b16 a[204:205], v15 offset:17152
    ds_read_b64_tr_b16 a[206:207], v15 offset:21248
    s_add_u32 s6, s4, 262144
    s_add_u32 s7, s4, 393216
    v_mfma_f32_16x16x32_bf16 a[0:3], a[220:223], v[168:171], a[0:3]
    ds_read_b64_tr_b16 a[208:209], v14 offset:17152
    ds_read_b64_tr_b16 a[210:211], v14 offset:21248
    ds_read_b64_tr_b16 a[212:213], v16 offset:17152
    v_mfma_f32_16x16x32_bf16 a[4:7], a[224:227], v[164:167], a[4:7]
    ds_read_b64_tr_b16 a[214:215], v16 offset:21248
    v_mfma_f32_16x16x32_bf16 a[4:7], a[228:231], v[168:171], a[4:7]
    v_accvgpr_read_b32 v216, a160
    v_cmp_nle_f32_e64 vcc, v216, s58
    v_rcp_f32 v216, v216
    v_mov_b32 v11, v17
    v_xor_b32 v12, 32, v17
    v_mfma_f32_16x16x32_bf16 a[164:167], a[180:183], v[172:175], a[164:167]
    v_add_u32 v13, 65536, v11
    v_add_u32 v14, 65536, v12
    v_add_u32 v15, 131072, v11
    v_add_u32 v16, 131072, v12
    v_mfma_f32_16x16x32_bf16 a[164:167], a[180:183], v[176:179], a[164:167]
    v_mfma_f32_16x16x32_bf16 a[168:171], a[180:183], v[180:183], a[168:171]
    v_mfma_f32_16x16x32_bf16 a[168:171], a[180:183], v[184:187], a[168:171]
    v_accvgpr_read_b32 v124, a0
    v_accvgpr_read_b32 v125, a1
    v_accvgpr_read_b32 v126, a2
    v_accvgpr_read_b32 v127, a3
    v_accvgpr_read_b32 v128, a4
    v_mfma_f32_16x16x32_bf16 a[172:175], a[180:183], v[188:191], a[172:175]
    v_accvgpr_read_b32 v129, a5
    v_accvgpr_read_b32 v130, a6
    v_accvgpr_read_b32 v131, a7
    v_mul_f32 v124, v124, v216
    v_mul_f32 v125, v125, v216
    v_mfma_f32_16x16x32_bf16 a[172:175], a[180:183], v[192:195], a[172:175]
    v_mul_f32 v126, v126, v216
    v_mul_f32 v127, v127, v216
    v_mul_f32 v128, v128, v216
    v_mul_f32 v129, v129, v216
    v_mul_f32 v130, v130, v216
    v_mfma_f32_16x16x32_bf16 a[176:179], a[180:183], v[196:199], a[176:179]
    v_mul_f32 v131, v131, v216
    v_cvt_pk_bf16_f32 v140, v124, v125
    v_cvt_pk_bf16_f32 v141, v126, v127
    v_cvt_pk_bf16_f32 v142, v128, v129
    v_cvt_pk_bf16_f32 v143, v130, v131
    v_mfma_f32_16x16x32_bf16 a[8:11], a[232:235], v[164:167], a[8:11]
    buffer_store_dwordx4 v[140:143], v1, s[24:27], s4 offen offset:0 sc1
    v_accvgpr_read_b32 v217, a164
    v_accvgpr_read_b32 v218, a168
    v_mfma_f32_16x16x32_bf16 a[8:11], a[236:239], v[168:171], a[8:11]
    s_waitcnt lgkmcnt(0)
    v_mfma_f32_16x16x32_bf16 a[12:15], a[240:243], v[164:167], a[12:15]
    v_accvgpr_read_b32 v219, a172
    v_mfma_f32_16x16x32_bf16 a[12:15], a[244:247], v[168:171], a[12:15]
    v_accvgpr_read_b32 v220, a176
    v_cmp_nle_f32_e64 s[40:41], v217, s58
    v_cmp_nle_f32_e64 s[100:101], v218, s58
    v_cmp_nle_f32_e64 s[28:29], v219, s58
    v_cmp_nle_f32_e64 s[30:31], v220, s58
    v_mfma_f32_16x16x32_bf16 a[16:19], a[184:187], v[164:167], a[16:19]
    v_rcp_f32 v217, v217
    v_rcp_f32 v218, v218
    v_rcp_f32 v219, v219
    v_mfma_f32_16x16x32_bf16 a[16:19], a[188:191], v[168:171], a[16:19]
    s_or_b64 s[40:41], s[40:41], vcc
    s_or_b64 s[40:41], s[40:41], s[100:101]
    s_or_b64 s[28:29], s[28:29], s[30:31]
    v_mfma_f32_16x16x32_bf16 a[20:23], a[192:195], v[164:167], a[20:23]
    s_or_b64 s[40:41], s[40:41], s[28:29]
    s_cselect_b32 s28, 1, 0
    v_mov_b32 v18, s28
    v_mfma_f32_16x16x32_bf16 a[20:23], a[196:199], v[168:171], a[20:23]
    v_accvgpr_read_b32 v132, a8
    v_accvgpr_read_b32 v133, a9
    v_accvgpr_read_b32 v134, a10
    v_accvgpr_read_b32 v135, a11
    v_accvgpr_read_b32 v136, a12
    v_mfma_f32_16x16x32_bf16 a[24:27], a[200:203], v[164:167], a[24:27]
    v_accvgpr_read_b32 v137, a13
    v_accvgpr_read_b32 v138, a14
    v_accvgpr_read_b32 v139, a15
    v_mul_f32 v132, v132, v216
    v_mul_f32 v133, v133, v216
    v_mfma_f32_16x16x32_bf16 a[24:27], a[204:207], v[168:171], a[24:27]
    v_mul_f32 v134, v134, v216
    v_mul_f32 v135, v135, v216
    v_mul_f32 v136, v136, v216
    v_mul_f32 v137, v137, v216
    v_mul_f32 v138, v138, v216
    v_mfma_f32_16x16x32_bf16 a[28:31], a[208:211], v[164:167], a[28:31]
    v_mul_f32 v139, v139, v216
    v_cvt_pk_bf16_f32 v144, v132, v133
    v_cvt_pk_bf16_f32 v145, v134, v135
    v_cvt_pk_bf16_f32 v146, v136, v137
    v_cvt_pk_bf16_f32 v147, v138, v139
    v_mfma_f32_16x16x32_bf16 a[28:31], a[212:215], v[168:171], a[28:31]
    buffer_store_dwordx4 v[144:147], v1, s[24:27], s4 offen offset:1024 sc1
    v_add_u32 v19, s39, v1
    v_add_u32 v19, 32768, v19
    v_lshrrev_b32 v20, 2, v1
    v_add_u32 v22, s39, v20
    v_mfma_f32_16x16x32_bf16 a[128:131], a[216:219], v[196:199], a[128:131]
    ds_write_b32 v22, v220
    ds_write_b32 v22, v120 offset:256
    ds_write_b32 v22, v18 offset:512
    v_accvgpr_read_b32 v124, a16
    v_accvgpr_read_b32 v125, a17
    v_mfma_f32_16x16x32_bf16 a[132:135], a[224:227], v[196:199], a[132:135]
    v_accvgpr_read_b32 v126, a18
    v_accvgpr_read_b32 v127, a19
    v_accvgpr_read_b32 v128, a20
    v_accvgpr_read_b32 v129, a21
    v_accvgpr_read_b32 v130, a22
    v_mfma_f32_16x16x32_bf16 a[136:139], a[232:235], v[196:199], a[136:139]
    v_accvgpr_read_b32 v131, a23
    v_mul_f32 v124, v124, v216
    v_mul_f32 v125, v125, v216
    v_mul_f32 v126, v126, v216
    v_mul_f32 v127, v127, v216
    v_mfma_f32_16x16x32_bf16 a[140:143], a[240:243], v[196:199], a[140:143]
    v_mul_f32 v128, v128, v216
    v_mul_f32 v129, v129, v216
    v_mul_f32 v130, v130, v216
    v_mul_f32 v131, v131, v216
    v_cvt_pk_bf16_f32 v148, v124, v125
    v_mfma_f32_16x16x32_bf16 a[144:147], a[184:187], v[196:199], a[144:147]
    v_cvt_pk_bf16_f32 v149, v126, v127
    v_cvt_pk_bf16_f32 v150, v128, v129
    v_cvt_pk_bf16_f32 v151, v130, v131
    v_mfma_f32_16x16x32_bf16 a[148:151], a[192:195], v[196:199], a[148:151]
    buffer_store_dwordx4 v[148:151], v1, s[24:27], s4 offen offset:2048 sc1
    v_accvgpr_read_b32 v132, a24
    v_accvgpr_read_b32 v133, a25
    v_accvgpr_read_b32 v134, a26
    v_accvgpr_read_b32 v135, a27
    v_mfma_f32_16x16x32_bf16 a[152:155], a[200:203], v[196:199], a[152:155]
    v_accvgpr_read_b32 v136, a28
    v_accvgpr_read_b32 v137, a29
    v_accvgpr_read_b32 v138, a30
    v_accvgpr_read_b32 v139, a31
    v_mul_f32 v132, v132, v216
    v_mfma_f32_16x16x32_bf16 a[156:159], a[208:211], v[196:199], a[156:159]
    v_mul_f32 v133, v133, v216
    v_mul_f32 v134, v134, v216
    v_mul_f32 v135, v135, v216
    v_mul_f32 v136, v136, v216
    v_mul_f32 v137, v137, v216
    v_mfma_f32_16x16x32_bf16 a[32:35], a[216:219], v[172:175], a[32:35]
    v_mul_f32 v138, v138, v216
    v_mul_f32 v139, v139, v216
    v_cvt_pk_bf16_f32 v152, v132, v133
    v_cvt_pk_bf16_f32 v153, v134, v135
    v_cvt_pk_bf16_f32 v154, v136, v137
    v_mfma_f32_16x16x32_bf16 a[32:35], a[220:223], v[176:179], a[32:35]
    v_cvt_pk_bf16_f32 v155, v138, v139
    v_mfma_f32_16x16x32_bf16 a[36:39], a[224:227], v[172:175], a[36:39]
    buffer_store_dwordx4 v[152:155], v1, s[24:27], s4 offen offset:3072 sc1
    v_mfma_f32_16x16x32_bf16 a[36:39], a[228:231], v[176:179], a[36:39]
    v_xor_b32 v22, 4096, v22
    v_mfma_f32_16x16x32_bf16 a[40:43], a[232:235], v[172:175], a[40:43]
    s_bitcmp1_b32 s38, 0
    s_cbranch_scc1 L1_wr_odd
    ds_write_b128 v19, a[144:147] offset:0
    ds_write_b128 v19, a[148:151] offset:1024
    ds_write_b128 v19, a[152:155] offset:2048
    ds_write_b128 v19, a[156:159] offset:3072
    s_branch L1_wr_done
    L1_wr_odd:
    ds_write_b128 v19, a[128:131] offset:0
    ds_write_b128 v19, a[132:135] offset:1024
    ds_write_b128 v19, a[136:139] offset:2048
    ds_write_b128 v19, a[140:143] offset:3072
    L1_wr_done:
    v_mfma_f32_16x16x32_bf16 a[40:43], a[236:239], v[176:179], a[40:43]
    v_xor_b32 v19, 4096, v19
    v_mfma_f32_16x16x32_bf16 a[44:47], a[240:243], v[172:175], a[44:47]
    v_mfma_f32_16x16x32_bf16 a[44:47], a[244:247], v[176:179], a[44:47]
    v_accvgpr_read_b32 v124, a32
    v_accvgpr_read_b32 v125, a33
    v_accvgpr_read_b32 v126, a34
    v_accvgpr_read_b32 v127, a35
    v_accvgpr_read_b32 v128, a36
    v_mfma_f32_16x16x32_bf16 a[48:51], a[184:187], v[172:175], a[48:51]
    v_accvgpr_read_b32 v129, a37
    v_accvgpr_read_b32 v130, a38
    v_accvgpr_read_b32 v131, a39
    v_mul_f32 v124, v124, v217
    v_mul_f32 v125, v125, v217
    v_mfma_f32_16x16x32_bf16 a[48:51], a[188:191], v[176:179], a[48:51]
    v_mul_f32 v126, v126, v217
    v_mul_f32 v127, v127, v217
    v_mul_f32 v128, v128, v217
    v_mul_f32 v129, v129, v217
    v_mul_f32 v130, v130, v217
    v_mfma_f32_16x16x32_bf16 a[52:55], a[192:195], v[172:175], a[52:55]
    v_mul_f32 v131, v131, v217
    v_cvt_pk_bf16_f32 v156, v124, v125
    v_cvt_pk_bf16_f32 v157, v126, v127
    v_cvt_pk_bf16_f32 v158, v128, v129
    v_cvt_pk_bf16_f32 v159, v130, v131
    v_mfma_f32_16x16x32_bf16 a[52:55], a[196:199], v[176:179], a[52:55]
    buffer_store_dwordx4 v[156:159], v1, s[24:27], s5 offen offset:0 sc1
    v_accvgpr_read_b32 v132, a40
    v_accvgpr_read_b32 v133, a41
    v_accvgpr_read_b32 v134, a42
    v_accvgpr_read_b32 v135, a43
    v_mfma_f32_16x16x32_bf16 a[56:59], a[200:203], v[172:175], a[56:59]
    v_accvgpr_read_b32 v136, a44
    v_accvgpr_read_b32 v137, a45
    v_accvgpr_read_b32 v138, a46
    v_accvgpr_read_b32 v139, a47
    v_mul_f32 v132, v132, v217
    v_mfma_f32_16x16x32_bf16 a[56:59], a[204:207], v[176:179], a[56:59]
    v_mul_f32 v133, v133, v217
    v_mul_f32 v134, v134, v217
    v_mul_f32 v135, v135, v217
    v_mul_f32 v136, v136, v217
    v_mul_f32 v137, v137, v217
    v_mfma_f32_16x16x32_bf16 a[60:63], a[208:211], v[172:175], a[60:63]
    v_mul_f32 v138, v138, v217
    v_mul_f32 v139, v139, v217
    v_cvt_pk_bf16_f32 v160, v132, v133
    v_cvt_pk_bf16_f32 v161, v134, v135
    v_cvt_pk_bf16_f32 v162, v136, v137
    v_mfma_f32_16x16x32_bf16 a[60:63], a[212:215], v[176:179], a[60:63]
    v_cvt_pk_bf16_f32 v163, v138, v139
    v_mfma_f32_16x16x32_bf16 a[64:67], a[216:219], v[180:183], a[64:67]
    buffer_store_dwordx4 v[160:163], v1, s[24:27], s5 offen offset:1024 sc1
    v_accvgpr_read_b32 v124, a48
    v_accvgpr_read_b32 v125, a49
    v_accvgpr_read_b32 v126, a50
    v_accvgpr_read_b32 v127, a51
    v_mfma_f32_16x16x32_bf16 a[64:67], a[220:223], v[184:187], a[64:67]
    v_accvgpr_read_b32 v128, a52
    v_accvgpr_read_b32 v129, a53
    v_accvgpr_read_b32 v130, a54
    v_accvgpr_read_b32 v131, a55
    v_mul_f32 v124, v124, v217
    v_mfma_f32_16x16x32_bf16 a[68:71], a[224:227], v[180:183], a[68:71]
    v_mul_f32 v125, v125, v217
    v_mul_f32 v126, v126, v217
    v_mul_f32 v127, v127, v217
    v_mul_f32 v128, v128, v217
    v_mul_f32 v129, v129, v217
    v_mfma_f32_16x16x32_bf16 a[68:71], a[228:231], v[184:187], a[68:71]
    v_mul_f32 v130, v130, v217
    v_mul_f32 v131, v131, v217
    v_cvt_pk_bf16_f32 v140, v124, v125
    v_cvt_pk_bf16_f32 v141, v126, v127
    v_cvt_pk_bf16_f32 v142, v128, v129
    v_mfma_f32_16x16x32_bf16 a[72:75], a[232:235], v[180:183], a[72:75]
    v_cvt_pk_bf16_f32 v143, v130, v131
    v_mfma_f32_16x16x32_bf16 a[72:75], a[236:239], v[184:187], a[72:75]
    buffer_store_dwordx4 v[140:143], v1, s[24:27], s5 offen offset:2048 sc1
    v_mfma_f32_16x16x32_bf16 a[76:79], a[240:243], v[180:183], a[76:79]
    s_waitcnt lgkmcnt(0)
    s_barrier
    v_mfma_f32_16x16x32_bf16 a[76:79], a[244:247], v[184:187], a[76:79]
    ds_read_b32 v204, v20 offset:512
    ds_read_b32 v205, v20 offset:4608
    ds_read_b32 v206, v20 offset:8704
    ds_read_b32 v207, v20 offset:12800
    v_mfma_f32_16x16x32_bf16 a[80:83], a[184:187], v[180:183], a[80:83]
    ds_read_b32 v208, v22
    ds_read_b32 v209, v22 offset:256
    v_accvgpr_read_b32 v132, a56
    v_accvgpr_read_b32 v133, a57
    v_accvgpr_read_b32 v134, a58
    v_mfma_f32_16x16x32_bf16 a[80:83], a[188:191], v[184:187], a[80:83]
    v_accvgpr_read_b32 v135, a59
    v_accvgpr_read_b32 v136, a60
    v_accvgpr_read_b32 v137, a61
    v_accvgpr_read_b32 v138, a62
    v_accvgpr_read_b32 v139, a63
    v_mfma_f32_16x16x32_bf16 a[84:87], a[192:195], v[180:183], a[84:87]
    v_mul_f32 v132, v132, v217
    v_mul_f32 v133, v133, v217
    v_mul_f32 v134, v134, v217
    v_mul_f32 v135, v135, v217
    v_mul_f32 v136, v136, v217
    v_mfma_f32_16x16x32_bf16 a[84:87], a[196:199], v[184:187], a[84:87]
    v_mul_f32 v137, v137, v217
    v_mul_f32 v138, v138, v217
    v_mul_f32 v139, v139, v217
    v_cvt_pk_bf16_f32 v144, v132, v133
    v_cvt_pk_bf16_f32 v145, v134, v135
    v_mfma_f32_16x16x32_bf16 a[88:91], a[200:203], v[180:183], a[88:91]
    v_cvt_pk_bf16_f32 v146, v136, v137
    v_cvt_pk_bf16_f32 v147, v138, v139
    v_mfma_f32_16x16x32_bf16 a[88:91], a[204:207], v[184:187], a[88:91]
    buffer_store_dwordx4 v[144:147], v1, s[24:27], s5 offen offset:3072 sc1
    v_accvgpr_read_b32 v124, a64
    v_accvgpr_read_b32 v125, a65
    v_accvgpr_read_b32 v126, a66
    v_accvgpr_read_b32 v127, a67
    v_mfma_f32_16x16x32_bf16 a[92:95], a[208:211], v[180:183], a[92:95]
    v_accvgpr_read_b32 v128, a68
    v_accvgpr_read_b32 v129, a69
    v_accvgpr_read_b32 v130, a70
    v_accvgpr_read_b32 v131, a71
    v_mul_f32 v124, v124, v218
    v_mfma_f32_16x16x32_bf16 a[92:95], a[212:215], v[184:187], a[92:95]
    v_mul_f32 v125, v125, v218
    v_mul_f32 v126, v126, v218
    v_mul_f32 v127, v127, v218
    v_mul_f32 v128, v128, v218
    v_mul_f32 v129, v129, v218
    v_mfma_f32_16x16x32_bf16 a[96:99], a[216:219], v[188:191], a[96:99]
    v_mul_f32 v130, v130, v218
    v_mul_f32 v131, v131, v218
    v_cvt_pk_bf16_f32 v148, v124, v125
    v_cvt_pk_bf16_f32 v149, v126, v127
    v_cvt_pk_bf16_f32 v150, v128, v129
    v_mfma_f32_16x16x32_bf16 a[96:99], a[220:223], v[192:195], a[96:99]
    v_cvt_pk_bf16_f32 v151, v130, v131
    v_mfma_f32_16x16x32_bf16 a[100:103], a[224:227], v[188:191], a[100:103]
    buffer_store_dwordx4 v[148:151], v1, s[24:27], s6 offen offset:0 sc1
    v_mfma_f32_16x16x32_bf16 a[100:103], a[228:231], v[192:195], a[100:103]
    s_waitcnt lgkmcnt(0)
    v_or_b32 v204, v204, v205
    v_or3_b32 v204, v204, v206, v207
    v_min_f32 v210, v209, v120
    v_readfirstlane_b32 s40, v204
    v_mfma_f32_16x16x32_bf16 a[104:107], a[232:235], v[188:191], a[104:107]
    v_sub_f32 v212, v210, v120
    v_sub_f32 v214, v210, v209
    v_mfma_f32_16x16x32_bf16 a[104:107], a[236:239], v[192:195], a[104:107]
    s_andn2_b32 s40, s40, s47
    s_cbranch_scc1 L1_fallback
    v_exp_f32 v212, v212
    v_mfma_f32_16x16x32_bf16 a[108:111], a[240:243], v[188:191], a[108:111]
    v_exp_f32 v214, v214
    v_mfma_f32_16x16x32_bf16 a[108:111], a[244:247], v[192:195], a[108:111]
    ds_read_b128 v[40:43], v19 offset:0
    ds_read_b128 v[44:47], v19 offset:1024
    ds_read_b128 v[48:51], v19 offset:2048
    ds_read_b128 v[52:55], v19 offset:3072
    v_accvgpr_read_b32 v132, a72
    v_mfma_f32_16x16x32_bf16 a[112:115], a[184:187], v[188:191], a[112:115]
    v_accvgpr_read_b32 v133, a73
    v_accvgpr_read_b32 v134, a74
    v_accvgpr_read_b32 v135, a75
    v_accvgpr_read_b32 v136, a76
    v_accvgpr_read_b32 v137, a77
    v_mfma_f32_16x16x32_bf16 a[112:115], a[188:191], v[192:195], a[112:115]
    v_accvgpr_read_b32 v138, a78
    v_accvgpr_read_b32 v139, a79
    v_mul_f32 v132, v132, v218
    v_mul_f32 v133, v133, v218
    v_mul_f32 v134, v134, v218
    v_mfma_f32_16x16x32_bf16 a[116:119], a[192:195], v[188:191], a[116:119]
    v_mul_f32 v135, v135, v218
    v_mul_f32 v136, v136, v218
    v_mul_f32 v137, v137, v218
    v_mul_f32 v138, v138, v218
    v_mul_f32 v139, v139, v218
    v_mfma_f32_16x16x32_bf16 a[116:119], a[196:199], v[192:195], a[116:119]
    v_cvt_pk_bf16_f32 v152, v132, v133
    v_cvt_pk_bf16_f32 v153, v134, v135
    v_cvt_pk_bf16_f32 v154, v136, v137
    v_cvt_pk_bf16_f32 v155, v138, v139
    v_mfma_f32_16x16x32_bf16 a[120:123], a[200:203], v[188:191], a[120:123]
    buffer_store_dwordx4 v[152:155], v1, s[24:27], s6 offen offset:1024 sc1
    v_mul_f32 v210, v212, v220
    v_fmac_f32 v210, v214, v208
    v_rcp_f32 v210, v210
    v_accvgpr_read_b32 v124, a80
    v_mfma_f32_16x16x32_bf16 a[120:123], a[204:207], v[192:195], a[120:123]
    v_accvgpr_read_b32 v125, a81
    v_accvgpr_read_b32 v126, a82
    v_accvgpr_read_b32 v127, a83
    v_accvgpr_read_b32 v128, a84
    v_accvgpr_read_b32 v129, a85
    v_mfma_f32_16x16x32_bf16 a[124:127], a[208:211], v[188:191], a[124:127]
    v_accvgpr_read_b32 v130, a86
    v_accvgpr_read_b32 v131, a87
    v_mul_f32 v124, v124, v218
    v_mul_f32 v125, v125, v218
    v_mul_f32 v126, v126, v218
    v_mfma_f32_16x16x32_bf16 a[124:127], a[212:215], v[192:195], a[124:127]
    v_mul_f32 v127, v127, v218
    v_mul_f32 v128, v128, v218
    v_mul_f32 v129, v129, v218
    v_mul_f32 v130, v130, v218
    v_mul_f32 v131, v131, v218
    v_cvt_pk_bf16_f32 v156, v124, v125
    v_cvt_pk_bf16_f32 v157, v126, v127
    v_cvt_pk_bf16_f32 v158, v128, v129
    v_cvt_pk_bf16_f32 v159, v130, v131
    buffer_store_dwordx4 v[156:159], v1, s[24:27], s6 offen offset:2048 sc1
    v_mul_f32 v212, v212, v210
    v_mul_f32 v214, v214, v210
    s_lshr_b32 s28, s38, 1
    s_mul_i32 s28, s28, 131072
    s_and_b32 s29, s38, 1
    s_lshl_b32 s29, s29, 11
    s_add_u32 s28, s28, s29
    s_add_u32 s28, s28, 2097152
    v_accvgpr_read_b32 v132, a88
    v_accvgpr_read_b32 v133, a89
    v_accvgpr_read_b32 v134, a90
    v_accvgpr_read_b32 v135, a91
    v_accvgpr_read_b32 v136, a92
    v_accvgpr_read_b32 v137, a93
    v_accvgpr_read_b32 v138, a94
    v_accvgpr_read_b32 v139, a95
    v_pk_mul_f32 v[132:133], v[132:133], v[218:219] op_sel_hi:[1,0]
    v_pk_mul_f32 v[134:135], v[134:135], v[218:219] op_sel_hi:[1,0]
    v_pk_mul_f32 v[136:137], v[136:137], v[218:219] op_sel_hi:[1,0]
    v_pk_mul_f32 v[138:139], v[138:139], v[218:219] op_sel_hi:[1,0]
    v_cvt_pk_bf16_f32 v160, v132, v133
    v_cvt_pk_bf16_f32 v161, v134, v135
    v_cvt_pk_bf16_f32 v162, v136, v137
    v_cvt_pk_bf16_f32 v163, v138, v139
    buffer_store_dwordx4 v[160:163], v1, s[24:27], s6 offen offset:3072 sc1
    v_accvgpr_read_b32 v124, a96
    v_accvgpr_read_b32 v125, a97
    v_accvgpr_read_b32 v126, a98
    v_accvgpr_read_b32 v127, a99
    v_accvgpr_read_b32 v128, a100
    v_accvgpr_read_b32 v129, a101
    v_accvgpr_read_b32 v130, a102
    v_accvgpr_read_b32 v131, a103
    v_pk_mul_f32 v[124:125], v[124:125], v[218:219] op_sel:[0,1]
    v_pk_mul_f32 v[126:127], v[126:127], v[218:219] op_sel:[0,1]
    v_pk_mul_f32 v[128:129], v[128:129], v[218:219] op_sel:[0,1]
    v_pk_mul_f32 v[130:131], v[130:131], v[218:219] op_sel:[0,1]
    v_cvt_pk_bf16_f32 v140, v124, v125
    v_cvt_pk_bf16_f32 v141, v126, v127
    v_cvt_pk_bf16_f32 v142, v128, v129
    v_cvt_pk_bf16_f32 v143, v130, v131
    buffer_store_dwordx4 v[140:143], v1, s[24:27], s7 offen offset:0 sc1
    v_accvgpr_read_b32 v132, a104
    v_accvgpr_read_b32 v133, a105
    v_accvgpr_read_b32 v134, a106
    v_accvgpr_read_b32 v135, a107
    v_accvgpr_read_b32 v136, a108
    v_accvgpr_read_b32 v137, a109
    v_accvgpr_read_b32 v138, a110
    v_accvgpr_read_b32 v139, a111
    v_pk_mul_f32 v[132:133], v[132:133], v[218:219] op_sel:[0,1]
    v_pk_mul_f32 v[134:135], v[134:135], v[218:219] op_sel:[0,1]
    v_pk_mul_f32 v[136:137], v[136:137], v[218:219] op_sel:[0,1]
    v_pk_mul_f32 v[138:139], v[138:139], v[218:219] op_sel:[0,1]
    v_cvt_pk_bf16_f32 v144, v132, v133
    v_cvt_pk_bf16_f32 v145, v134, v135
    v_cvt_pk_bf16_f32 v146, v136, v137
    v_cvt_pk_bf16_f32 v147, v138, v139
    buffer_store_dwordx4 v[144:147], v1, s[24:27], s7 offen offset:1024 sc1
    v_accvgpr_read_b32 v124, a112
    v_accvgpr_read_b32 v125, a113
    v_accvgpr_read_b32 v126, a114
    v_accvgpr_read_b32 v127, a115
    v_accvgpr_read_b32 v128, a116
    v_accvgpr_read_b32 v129, a117
    v_accvgpr_read_b32 v130, a118
    v_accvgpr_read_b32 v131, a119
    v_pk_mul_f32 v[124:125], v[124:125], v[218:219] op_sel:[0,1]
    v_pk_mul_f32 v[126:127], v[126:127], v[218:219] op_sel:[0,1]
    v_pk_mul_f32 v[128:129], v[128:129], v[218:219] op_sel:[0,1]
    v_pk_mul_f32 v[130:131], v[130:131], v[218:219] op_sel:[0,1]
    v_cvt_pk_bf16_f32 v148, v124, v125
    v_cvt_pk_bf16_f32 v149, v126, v127
    v_cvt_pk_bf16_f32 v150, v128, v129
    v_cvt_pk_bf16_f32 v151, v130, v131
    buffer_store_dwordx4 v[148:151], v1, s[24:27], s7 offen offset:2048 sc1
    v_accvgpr_read_b32 v132, a120
    v_accvgpr_read_b32 v133, a121
    v_accvgpr_read_b32 v134, a122
    v_accvgpr_read_b32 v135, a123
    v_accvgpr_read_b32 v136, a124
    v_accvgpr_read_b32 v137, a125
    v_accvgpr_read_b32 v138, a126
    v_accvgpr_read_b32 v139, a127
    v_pk_mul_f32 v[132:133], v[132:133], v[218:219] op_sel:[0,1]
    v_pk_mul_f32 v[134:135], v[134:135], v[218:219] op_sel:[0,1]
    v_pk_mul_f32 v[136:137], v[136:137], v[218:219] op_sel:[0,1]
    v_pk_mul_f32 v[138:139], v[138:139], v[218:219] op_sel:[0,1]
    v_cvt_pk_bf16_f32 v152, v132, v133
    v_cvt_pk_bf16_f32 v153, v134, v135
    v_cvt_pk_bf16_f32 v154, v136, v137
    v_cvt_pk_bf16_f32 v155, v138, v139
    buffer_store_dwordx4 v[152:155], v1, s[24:27], s7 offen offset:3072 sc1
    s_bitcmp1_b32 s38, 0
    s_cbranch_scc1 L1_rd_odd
    v_accvgpr_read_b32 v24, a128
    v_accvgpr_read_b32 v25, a129
    v_accvgpr_read_b32 v26, a130
    v_accvgpr_read_b32 v27, a131
    v_accvgpr_read_b32 v28, a132
    v_accvgpr_read_b32 v29, a133
    v_accvgpr_read_b32 v30, a134
    v_accvgpr_read_b32 v31, a135
    v_accvgpr_read_b32 v32, a136
    v_accvgpr_read_b32 v33, a137
    v_accvgpr_read_b32 v34, a138
    v_accvgpr_read_b32 v35, a139
    v_accvgpr_read_b32 v36, a140
    v_accvgpr_read_b32 v37, a141
    v_accvgpr_read_b32 v38, a142
    v_accvgpr_read_b32 v39, a143
    s_branch L1_rd_done
L1_rd_odd:
    v_accvgpr_read_b32 v24, a144
    v_accvgpr_read_b32 v25, a145
    v_accvgpr_read_b32 v26, a146
    v_accvgpr_read_b32 v27, a147
    v_accvgpr_read_b32 v28, a148
    v_accvgpr_read_b32 v29, a149
    v_accvgpr_read_b32 v30, a150
    v_accvgpr_read_b32 v31, a151
    v_accvgpr_read_b32 v32, a152
    v_accvgpr_read_b32 v33, a153
    v_accvgpr_read_b32 v34, a154
    v_accvgpr_read_b32 v35, a155
    v_accvgpr_read_b32 v36, a156
    v_accvgpr_read_b32 v37, a157
    v_accvgpr_read_b32 v38, a158
    v_accvgpr_read_b32 v39, a159
L1_rd_done:
    s_waitcnt lgkmcnt(0)
    v_pk_mul_f32 v[24:25], v[24:25], v[212:213] op_sel_hi:[1,0]
    v_pk_mul_f32 v[26:27], v[26:27], v[212:213] op_sel_hi:[1,0]
    v_pk_mul_f32 v[28:29], v[28:29], v[212:213] op_sel_hi:[1,0]
    v_pk_mul_f32 v[30:31], v[30:31], v[212:213] op_sel_hi:[1,0]
    v_pk_mul_f32 v[32:33], v[32:33], v[212:213] op_sel_hi:[1,0]
    v_pk_mul_f32 v[34:35], v[34:35], v[212:213] op_sel_hi:[1,0]
    v_pk_mul_f32 v[36:37], v[36:37], v[212:213] op_sel_hi:[1,0]
    v_pk_mul_f32 v[38:39], v[38:39], v[212:213] op_sel_hi:[1,0]
    v_pk_fma_f32 v[24:25], v[40:41], v[214:215], v[24:25] op_sel_hi:[1,0,1]
    v_pk_fma_f32 v[26:27], v[42:43], v[214:215], v[26:27] op_sel_hi:[1,0,1]
    v_pk_fma_f32 v[28:29], v[44:45], v[214:215], v[28:29] op_sel_hi:[1,0,1]
    v_pk_fma_f32 v[30:31], v[46:47], v[214:215], v[30:31] op_sel_hi:[1,0,1]
    v_pk_fma_f32 v[32:33], v[48:49], v[214:215], v[32:33] op_sel_hi:[1,0,1]
    v_pk_fma_f32 v[34:35], v[50:51], v[214:215], v[34:35] op_sel_hi:[1,0,1]
    v_pk_fma_f32 v[36:37], v[52:53], v[214:215], v[36:37] op_sel_hi:[1,0,1]
    v_pk_fma_f32 v[38:39], v[54:55], v[214:215], v[38:39] op_sel_hi:[1,0,1]
    v_cvt_pk_bf16_f32 v56, v24, v25
    v_cvt_pk_bf16_f32 v57, v26, v27
    v_cvt_pk_bf16_f32 v58, v28, v29
    v_cvt_pk_bf16_f32 v59, v30, v31
    v_cvt_pk_bf16_f32 v60, v32, v33
    v_cvt_pk_bf16_f32 v61, v34, v35
    v_cvt_pk_bf16_f32 v62, v36, v37
    v_cvt_pk_bf16_f32 v63, v38, v39
    buffer_store_dwordx4 v[56:59], v1, s[24:27], s28 offen sc1
    buffer_store_dwordx4 v[60:63], v1, s[24:27], s28 offen offset:1024 sc1
    s_waitcnt vmcnt(18)
    ds_read_b64_tr_b16 a[32:33], v15 offset:0
    ds_read_b64_tr_b16 a[34:35], v15 offset:2048
    ds_read_b64_tr_b16 a[36:37], v16 offset:0
    ds_read_b64_tr_b16 a[38:39], v16 offset:2048
    ds_read_b64_tr_b16 a[40:41], v15 offset:512
    ds_read_b64_tr_b16 a[42:43], v15 offset:2560
    ds_read_b64_tr_b16 a[44:45], v16 offset:512
    ds_read_b64_tr_b16 a[46:47], v16 offset:2560
    ds_read_b64_tr_b16 a[48:49], v15 offset:16384
    ds_read_b64_tr_b16 a[50:51], v15 offset:18432
    ds_read_b64_tr_b16 a[52:53], v16 offset:16384
    ds_read_b64_tr_b16 a[54:55], v16 offset:18432
    ds_read_b64_tr_b16 a[56:57], v15 offset:16896
    ds_read_b64_tr_b16 a[58:59], v15 offset:18944
    ds_read_b64_tr_b16 a[60:61], v16 offset:16896
    ds_read_b64_tr_b16 a[62:63], v16 offset:18944
    s_waitcnt lgkmcnt(8)
    s_add_u32 m0, s39, 131072
    s_add_u32 s42, s52, 294912
    buffer_load_dwordx4 v2, s[8:11], s42 offen lds
    buffer_load_dwordx4 v3, s[8:11], s42 offen offset:1024 lds
    buffer_load_dwordx4 v4, s[8:11], s42 offen offset:2048 lds
    buffer_load_dwordx4 v21, s[8:11], s42 offen offset:3072 lds
    ds_read_b64_tr_b16 a[64:65], v13 offset:0
    ds_read_b64_tr_b16 a[66:67], v13 offset:2048
    ds_read_b64_tr_b16 a[68:69], v14 offset:0
    ds_read_b64_tr_b16 a[70:71], v14 offset:2048
    ds_read_b64_tr_b16 a[72:73], v13 offset:512
    ds_read_b64_tr_b16 a[74:75], v13 offset:2560
    ds_read_b64_tr_b16 a[76:77], v14 offset:512
    ds_read_b64_tr_b16 a[78:79], v14 offset:2560
    s_waitcnt lgkmcnt(8)
    s_add_u32 m0, s39, 147456
    s_add_u32 s42, s53, 294912
    buffer_load_dwordx4 v2, s[8:11], s42 offen lds
    buffer_load_dwordx4 v3, s[8:11], s42 offen offset:1024 lds
    buffer_load_dwordx4 v4, s[8:11], s42 offen offset:2048 lds
    buffer_load_dwordx4 v21, s[8:11], s42 offen offset:3072 lds
    ds_read_b64_tr_b16 a[80:81], v11 offset:16384
    ds_read_b64_tr_b16 a[82:83], v11 offset:18432
    ds_read_b64_tr_b16 a[84:85], v12 offset:16384
    ds_read_b64_tr_b16 a[86:87], v12 offset:18432
    ds_read_b64_tr_b16 a[88:89], v11 offset:16896
    ds_read_b64_tr_b16 a[90:91], v11 offset:18944
    ds_read_b64_tr_b16 a[92:93], v12 offset:16896
    ds_read_b64_tr_b16 a[94:95], v12 offset:18944
    s_waitcnt lgkmcnt(8)
    s_add_u32 m0, s39, 65536
    s_add_u32 s42, s86, 294912
    buffer_load_dwordx4 v2, s[8:11], s42 offen lds
    buffer_load_dwordx4 v3, s[8:11], s42 offen offset:1024 lds
    buffer_load_dwordx4 v4, s[8:11], s42 offen offset:2048 lds
    buffer_load_dwordx4 v21, s[8:11], s42 offen offset:3072 lds
    v_mov_b32 v19, 1
    s_waitcnt vmcnt(12)
    s_barrier
    s_cmp_lg_u32 s38, 0
    s_cbranch_scc1 L1_nosig
    s_mov_b32 s100, 1
    s_atomic_add s100, s[32:33], s57 glc
L1_nosig:
    s_cmp_lt_u32 s88, 3
    s_cbranch_scc1 L1_work
    s_cmp_lg_u32 s38, 0
    s_cbranch_scc1 L1_pubA
    s_waitcnt lgkmcnt(0)
    s_cmp_lg_u32 s100, 31
    s_cbranch_scc1 L1_pubA
    s_add_u32 s101, s57, 128
    s_mov_b32 s100, 32
    s_atomic_add s100, s[32:33], s101
L1_pubA:
    s_branch L1_done
L1_work:
    s_add_u32 m0, s39, 32768
    s_add_u32 s42, s87, 0
    buffer_load_dwordx4 v2, s[8:11], s42 offen lds
    buffer_load_dwordx4 v3, s[8:11], s42 offen offset:1024 lds
    buffer_load_dwordx4 v4, s[8:11], s42 offen offset:2048 lds
    buffer_load_dwordx4 v21, s[8:11], s42 offen offset:3072 lds
    s_add_u32 m0, s39, 0
    s_add_u32 s42, s48, 294912
    buffer_load_dwordx4 v2, s[8:11], s42 offen lds
    buffer_load_dwordx4 v3, s[8:11], s42 offen offset:1024 lds
    buffer_load_dwordx4 v4, s[8:11], s42 offen offset:2048 lds
    buffer_load_dwordx4 v21, s[8:11], s42 offen offset:3072 lds
    s_add_u32 m0, s39, 81920
    s_add_u32 s42, s49, 294912
    buffer_load_dwordx4 v2, s[8:11], s42 offen lds
    buffer_load_dwordx4 v3, s[8:11], s42 offen offset:1024 lds
    buffer_load_dwordx4 v4, s[8:11], s42 offen offset:2048 lds
    buffer_load_dwordx4 v21, s[8:11], s42 offen offset:3072 lds
    s_add_u32 s16, s98, s44
    s_addc_u32 s17, s99, 0
    s_sub_u32 s18, 2654208, s44
    s_bitcmp1_b32 s2, 0
    s_cselect_b32 s18, 91136, s18
    ds_read_b64_tr_b16 a[96:97], v11 offset:49152
    ds_read_b64_tr_b16 a[98:99], v11 offset:51200
    ds_read_b64_tr_b16 a[100:101], v12 offset:49152
    ds_read_b64_tr_b16 a[102:103], v12 offset:51200
    ds_read_b64_tr_b16 a[104:105], v11 offset:49664
    ds_read_b64_tr_b16 a[106:107], v11 offset:51712
    ds_read_b64_tr_b16 a[108:109], v12 offset:49664
    ds_read_b64_tr_b16 a[110:111], v12 offset:51712
    s_waitcnt lgkmcnt(8)
    s_add_u32 m0, s39, 16384
    s_add_u32 s42, s87, 294912
    buffer_load_dwordx4 v2, s[8:11], s42 offen lds
    ds_read_b64_tr_b16 v[96:97], v13 offset:32768
    ds_read_b64_tr_b16 v[98:99], v13 offset:34816
    ds_read_b64_tr_b16 v[100:101], v14 offset:32768
    s_mul_i32 s4, s38, 32768
    v_add_u32 v5, s4, v1
    buffer_load_dwordx4 v3, s[8:11], s42 offen offset:1024 lds
    ds_read_b64_tr_b16 v[102:103], v14 offset:34816
    ds_read_b64_tr_b16 v[104:105], v13 offset:33280
    ds_read_b64_tr_b16 v[106:107], v13 offset:35328
    v_add_u32 v6, 131072, v5
    v_add_u32 v7, 262144, v5
    buffer_load_dwordx4 v4, s[8:11], s42 offen offset:2048 lds
    ds_read_b64_tr_b16 v[108:109], v14 offset:33280
    ds_read_b64_tr_b16 v[110:111], v14 offset:35328
    v_add_u32 v8, 393216, v5
    v_add_u32 v9, 524288, v5
    buffer_load_dwordx4 v21, s[8:11], s42 offen offset:3072 lds
    s_waitcnt lgkmcnt(8)
    s_add_u32 m0, s39, 49152
    s_add_u32 s42, s48, 589824
    buffer_load_dwordx4 v2, s[8:11], s42 offen lds
    ds_read_b64_tr_b16 v[112:113], v13 offset:49152
    ds_read_b64_tr_b16 v[114:115], v13 offset:51200
    ds_read_b64_tr_b16 v[116:117], v14 offset:49152
    v_add_u32 v10, 655360, v5
    s_add_u32 s4, s59, 0
    buffer_load_dwordx4 v3, s[8:11], s42 offen offset:1024 lds
    ds_read_b64_tr_b16 v[118:119], v14 offset:51200
    ds_read_b64_tr_b16 v[120:121], v13 offset:49664
    ds_read_b64_tr_b16 v[122:123], v13 offset:51712
    s_bfe_u32 s5, s4, 0x10002
    s_and_b32 s4, s4, 3
    buffer_load_dwordx4 v4, s[8:11], s42 offen offset:2048 lds
    ds_read_b64_tr_b16 v[124:125], v14 offset:49664
    ds_read_b64_tr_b16 v[126:127], v14 offset:51712
    s_mul_i32 s5, s5, 4096
    s_lshl_b32 s4, s4, 10
    buffer_load_dwordx4 v21, s[8:11], s42 offen offset:3072 lds
    s_waitcnt lgkmcnt(8)
    s_cmp_lg_u32 s38, 0
    s_cbranch_scc1 L1_pubB
    s_waitcnt lgkmcnt(0)
    s_cmp_lg_u32 s100, 31
    s_cbranch_scc1 L1_pubB
    s_add_u32 s101, s57, 128
    s_mov_b32 s100, 32
    s_atomic_add s100, s[32:33], s101
L1_pubB:
    s_add_u32 m0, s39, 98304
    s_add_u32 s42, s52, 589824
    buffer_load_dwordx4 v2, s[8:11], s42 offen lds
    s_waitcnt vmcnt(29)
    ds_read_b64_tr_b16 v[128:129], v15 offset:0
    ds_read_b64_tr_b16 v[130:131], v15 offset:2048
    ds_read_b64_tr_b16 v[132:133], v16 offset:0
    s_add_u32 s24, s4, s5
    s_add_u32 s4, s59, 1
    buffer_load_dwordx4 v3, s[8:11], s42 offen offset:1024 lds
    ds_read_b64_tr_b16 v[134:135], v16 offset:2048
    ds_read_b64_tr_b16 v[136:137], v15 offset:512
    ds_read_b64_tr_b16 v[138:139], v15 offset:2560
    s_bfe_u32 s5, s4, 0x10002
    s_and_b32 s4, s4, 3
    buffer_load_dwordx4 v4, s[8:11], s42 offen offset:2048 lds
    ds_read_b64_tr_b16 v[140:141], v16 offset:512
    ds_read_b64_tr_b16 v[142:143], v16 offset:2560
    s_mul_i32 s5, s5, 4096
    s_lshl_b32 s4, s4, 10
    buffer_load_dwordx4 v21, s[8:11], s42 offen offset:3072 lds
    s_waitcnt lgkmcnt(8)
    s_add_u32 m0, s39, 114688
    s_add_u32 s42, s53, 589824
    buffer_load_dwordx4 v2, s[8:11], s42 offen lds
    s_waitcnt vmcnt(29)
    ds_read_b64_tr_b16 v[144:145], v15 offset:16384
    ds_read_b64_tr_b16 v[146:147], v15 offset:18432
    ds_read_b64_tr_b16 v[148:149], v16 offset:16384
    s_add_u32 s25, s4, s5
    s_add_u32 s4, s59, 2
    buffer_load_dwordx4 v3, s[8:11], s42 offen offset:1024 lds
    ds_read_b64_tr_b16 v[150:151], v16 offset:18432
    ds_read_b64_tr_b16 v[152:153], v15 offset:16896
    ds_read_b64_tr_b16 v[154:155], v15 offset:18944
    s_bfe_u32 s5, s4, 0x10002
    s_and_b32 s4, s4, 3
    buffer_load_dwordx4 v4, s[8:11], s42 offen offset:2048 lds
    ds_read_b64_tr_b16 v[156:157], v16 offset:16896
    ds_read_b64_tr_b16 v[158:159], v16 offset:18944
    s_mul_i32 s5, s5, 4096
    s_lshl_b32 s4, s4, 10
    buffer_load_dwordx4 v21, s[8:11], s42 offen offset:3072 lds
    s_waitcnt lgkmcnt(8)
    s_add_u32 m0, s39, 131072
    s_add_u32 s42, s86, 589824
    buffer_load_dwordx4 v2, s[8:11], s42 offen lds
    s_waitcnt vmcnt(29)
    ds_read_b64_tr_b16 v[160:161], v13 offset:0
    ds_read_b64_tr_b16 v[162:163], v13 offset:2048
    ds_read_b64_tr_b16 v[164:165], v14 offset:0
    s_add_u32 s26, s4, s5
    s_add_u32 s4, s59, 3
    buffer_load_dwordx4 v3, s[8:11], s42 offen offset:1024 lds
    ds_read_b64_tr_b16 v[166:167], v14 offset:2048
    ds_read_b64_tr_b16 v[168:169], v13 offset:512
    ds_read_b64_tr_b16 v[170:171], v13 offset:2560
    s_bfe_u32 s5, s4, 0x10002
    s_and_b32 s4, s4, 3
    buffer_load_dwordx4 v4, s[8:11], s42 offen offset:2048 lds
    ds_read_b64_tr_b16 v[172:173], v14 offset:512
    ds_read_b64_tr_b16 v[174:175], v14 offset:2560
    s_mul_i32 s5, s5, 4096
    s_lshl_b32 s4, s4, 10
    buffer_load_dwordx4 v21, s[8:11], s42 offen offset:3072 lds
    s_waitcnt lgkmcnt(8)
    s_add_u32 m0, s39, 147456
    s_add_u32 s42, s87, 589824
    buffer_load_dwordx4 v2, s[8:11], s42 offen lds
    s_waitcnt vmcnt(29)
    ds_read_b64_tr_b16 a[112:113], v11 offset:32768
    ds_read_b64_tr_b16 a[114:115], v11 offset:34816
    ds_read_b64_tr_b16 a[116:117], v12 offset:32768
    s_add_u32 s27, s4, s5
    s_add_u32 s4, s59, 4
    buffer_load_dwordx4 v3, s[8:11], s42 offen offset:1024 lds
    ds_read_b64_tr_b16 a[118:119], v12 offset:34816
    ds_read_b64_tr_b16 a[120:121], v11 offset:33280
    ds_read_b64_tr_b16 a[122:123], v11 offset:35328
    s_bfe_u32 s5, s4, 0x10002
    s_and_b32 s4, s4, 3
    buffer_load_dwordx4 v4, s[8:11], s42 offen offset:2048 lds
    ds_read_b64_tr_b16 a[124:125], v12 offset:33280
    ds_read_b64_tr_b16 a[126:127], v12 offset:35328
    s_mul_i32 s5, s5, 4096
    s_lshl_b32 s4, s4, 10
    buffer_load_dwordx4 v21, s[8:11], s42 offen offset:3072 lds
    s_waitcnt lgkmcnt(8)
    s_add_u32 m0, s39, 65536
    s_add_u32 s42, s48, 884736
    buffer_load_dwordx4 v2, s[8:11], s42 offen lds
    s_waitcnt vmcnt(29)
    ds_read_b64_tr_b16 a[128:129], v11 offset:0
    ds_read_b64_tr_b16 a[130:131], v11 offset:2048
    ds_read_b64_tr_b16 a[132:133], v12 offset:0
    s_add_u32 s28, s4, s5
    s_add_u32 s4, s59, 5
    buffer_load_dwordx4 v3, s[8:11], s42 offen offset:1024 lds
    ds_read_b64_tr_b16 a[134:135], v12 offset:2048
    ds_read_b64_tr_b16 a[136:137], v11 offset:512
    ds_read_b64_tr_b16 a[138:139], v11 offset:2560
    s_bfe_u32 s5, s4, 0x10002
    s_and_b32 s4, s4, 3
    buffer_load_dwordx4 v4, s[8:11], s42 offen offset:2048 lds
    ds_read_b64_tr_b16 a[140:141], v12 offset:512
    ds_read_b64_tr_b16 a[142:143], v12 offset:2560
    s_mul_i32 s5, s5, 4096
    s_lshl_b32 s4, s4, 10
    buffer_load_dwordx4 v21, s[8:11], s42 offen offset:3072 lds
    s_waitcnt lgkmcnt(8)
    s_add_u32 m0, s39, 32768
    s_add_u32 s42, s49, 589824
    buffer_load_dwordx4 v2, s[8:11], s42 offen lds
    s_waitcnt vmcnt(29)
    ds_read_b64_tr_b16 a[144:145], v13 offset:16384
    ds_read_b64_tr_b16 a[146:147], v13 offset:18432
    ds_read_b64_tr_b16 a[148:149], v14 offset:16384
    s_add_u32 s29, s4, s5
    s_add_u32 s4, s59, 6
    buffer_load_dwordx4 v3, s[8:11], s42 offen offset:1024 lds
    ds_read_b64_tr_b16 a[150:151], v14 offset:18432
    ds_read_b64_tr_b16 a[152:153], v13 offset:16896
    ds_read_b64_tr_b16 a[154:155], v13 offset:18944
    s_bfe_u32 s5, s4, 0x10002
    s_and_b32 s4, s4, 3
    buffer_load_dwordx4 v4, s[8:11], s42 offen offset:2048 lds
    ds_read_b64_tr_b16 a[156:157], v14 offset:16896
    ds_read_b64_tr_b16 a[158:159], v14 offset:18944
    s_mul_i32 s5, s5, 4096
    s_lshl_b32 s4, s4, 10
    buffer_load_dwordx4 v21, s[8:11], s42 offen offset:3072 lds
    s_waitcnt lgkmcnt(8)
    buffer_load_dwordx2 v[18:19], off, s[32:35], s3 offset:128 sc1
    s_add_u32 m0, s39, 0
    s_add_u32 s42, s50, 589824
    buffer_load_dwordx4 v2, s[8:11], s42 offen lds
    s_waitcnt vmcnt(30)
    ds_read_b64_tr_b16 v[176:177], v11 offset:16384
    ds_read_b64_tr_b16 v[178:179], v11 offset:18432
    ds_read_b64_tr_b16 v[180:181], v12 offset:16384
    s_add_u32 s30, s4, s5
    s_add_u32 s4, s59, 7
    buffer_load_dwordx4 v3, s[8:11], s42 offen offset:1024 lds
    ds_read_b64_tr_b16 v[182:183], v12 offset:18432
    ds_read_b64_tr_b16 v[184:185], v11 offset:16896
    ds_read_b64_tr_b16 v[186:187], v11 offset:18944
    s_bfe_u32 s5, s4, 0x10002
    s_and_b32 s4, s4, 3
    buffer_load_dwordx4 v4, s[8:11], s42 offen offset:2048 lds
    ds_read_b64_tr_b16 v[188:189], v12 offset:16896
    ds_read_b64_tr_b16 v[190:191], v12 offset:18944
    s_mul_i32 s5, s5, 4096
    s_lshl_b32 s4, s4, 10
    buffer_load_dwordx4 v21, s[8:11], s42 offen offset:3072 lds
    s_waitcnt lgkmcnt(8)
    s_add_u32 m0, s39, 81920
    s_add_u32 s42, s51, 589824
    buffer_load_dwordx4 v2, s[8:11], s42 offen lds
    s_waitcnt vmcnt(30)
    ds_read_b64_tr_b16 v[192:193], v11 offset:49152
    ds_read_b64_tr_b16 v[194:195], v11 offset:51200
    ds_read_b64_tr_b16 v[196:197], v12 offset:49152
    s_add_u32 s31, s4, s5
    buffer_load_dwordx4 v3, s[8:11], s42 offen offset:1024 lds
    ds_read_b64_tr_b16 v[198:199], v12 offset:51200
    ds_read_b64_tr_b16 v[200:201], v11 offset:49664
    ds_read_b64_tr_b16 v[202:203], v11 offset:51712
    buffer_load_dwordx4 v4, s[8:11], s42 offen offset:2048 lds
    ds_read_b64_tr_b16 v[204:205], v12 offset:49664
    ds_read_b64_tr_b16 v[206:207], v12 offset:51712
    buffer_load_dwordx4 v21, s[8:11], s42 offen offset:3072 lds
    s_waitcnt lgkmcnt(8)
    s_add_u32 m0, s39, 16384
    s_add_u32 s42, s49, 884736
    buffer_load_dwordx4 v2, s[8:11], s42 offen lds
    s_waitcnt vmcnt(10)
    ds_read_b64_tr_b16 v[208:209], v11 offset:32768
    ds_read_b64_tr_b16 v[210:211], v11 offset:34816
    ds_read_b64_tr_b16 v[212:213], v12 offset:32768
    buffer_load_dwordx4 v3, s[8:11], s42 offen offset:1024 lds
    ds_read_b64_tr_b16 v[214:215], v12 offset:34816
    ds_read_b64_tr_b16 v[216:217], v11 offset:33280
    ds_read_b64_tr_b16 v[218:219], v11 offset:35328
    buffer_load_dwordx4 v4, s[8:11], s42 offen offset:2048 lds
    ds_read_b64_tr_b16 v[220:221], v12 offset:33280
    ds_read_b64_tr_b16 v[222:223], v12 offset:35328
    buffer_load_dwordx4 v21, s[8:11], s42 offen offset:3072 lds
    s_waitcnt lgkmcnt(8)
    s_add_u32 m0, s39, 49152
    s_add_u32 s42, s50, 884736
    buffer_load_dwordx4 v2, s[8:11], s42 offen lds
    s_waitcnt vmcnt(9)
    ds_read_b64_tr_b16 a[0:1], v11 offset:0
    ds_read_b64_tr_b16 a[2:3], v11 offset:2048
    ds_read_b64_tr_b16 a[4:5], v12 offset:0
    buffer_load_dwordx4 v3, s[8:11], s42 offen offset:1024 lds
    ds_read_b64_tr_b16 a[6:7], v12 offset:2048
    ds_read_b64_tr_b16 a[8:9], v11 offset:512
    ds_read_b64_tr_b16 a[10:11], v11 offset:2560
    buffer_load_dwordx4 v4, s[8:11], s42 offen offset:2048 lds
    ds_read_b64_tr_b16 a[12:13], v12 offset:512
    ds_read_b64_tr_b16 a[14:15], v12 offset:2560
    buffer_load_dwordx4 v21, s[8:11], s42 offen offset:3072 lds
    s_waitcnt lgkmcnt(8)
    s_add_u32 m0, s39, 32768
    s_add_u32 s42, s51, 884736
    buffer_load_dwordx4 v2, s[8:11], s42 offen lds
    s_waitcnt vmcnt(9)
    ds_read_b64_tr_b16 a[16:17], v13 offset:16384
    ds_read_b64_tr_b16 a[18:19], v13 offset:18432
    ds_read_b64_tr_b16 a[20:21], v14 offset:16384
    buffer_load_dwordx4 v3, s[8:11], s42 offen offset:1024 lds
    ds_read_b64_tr_b16 a[22:23], v14 offset:18432
    ds_read_b64_tr_b16 a[24:25], v13 offset:16896
    ds_read_b64_tr_b16 a[26:27], v13 offset:18944
    buffer_load_dwordx4 v4, s[8:11], s42 offen offset:2048 lds
    ds_read_b64_tr_b16 a[28:29], v14 offset:16896
    ds_read_b64_tr_b16 a[30:31], v14 offset:18944
    buffer_load_dwordx4 v21, s[8:11], s42 offen offset:3072 lds
    s_waitcnt lgkmcnt(8)
    s_add_u32 m0, s39, 0
    s_add_u32 s42, s52, 884736
    buffer_load_dwordx4 v2, s[8:11], s42 offen lds
    buffer_load_dwordx4 v3, s[8:11], s42 offen offset:1024 lds
    buffer_load_dwordx4 v4, s[8:11], s42 offen offset:2048 lds
    buffer_load_dwordx4 v21, s[8:11], s42 offen offset:3072 lds
    s_waitcnt lgkmcnt(0)
    s_add_u32 m0, s39, 81920
    s_add_u32 s42, s53, 884736
    buffer_load_dwordx4 v2, s[8:11], s42 offen lds
    buffer_load_dwordx4 v3, s[8:11], s42 offen offset:1024 lds
    buffer_load_dwordx4 v4, s[8:11], s42 offen offset:2048 lds
    buffer_load_dwordx4 v21, s[8:11], s42 offen offset:3072 lds
    s_cmp_lg_u32 s38, 0
    s_cbranch_scc1 L1_go
    s_mov_b32 s46, 0
    s_waitcnt vmcnt(28)
L1_poll:
    v_readfirstlane_b32 s4, v18
    v_readfirstlane_b32 s5, v19
    s_add_u32 s46, s46, 1
    s_cmp_gt_u32 s46, 400000
    s_cbranch_scc1 L1_go
    s_cmp_ge_u32 s5, s55
    s_cselect_b32 s4, s4, 0
    s_cmp_ge_u32 s4, 32
    s_cbranch_scc1 L1_go
    buffer_load_dwordx2 v[18:19], off, s[32:35], s3 offset:128 sc1
    s_waitcnt vmcnt(0)
    s_branch L1_poll
L1_go:
    s_barrier
    s_bitcmp1_b32 s2, 0
    s_cbranch_scc1 L1_small
    s_add_u32 s4, s24, 0
    buffer_load_dwordx4 v[24:27], v5, s[12:15], s4 offen sc1
    s_add_u32 s5, s25, 0
    buffer_load_dwordx4 v[28:31], v5, s[12:15], s5 offen sc1
    buffer_load_dwordx4 v[32:35], v6, s[12:15], s4 offen sc1
    buffer_load_dwordx4 v[36:39], v6, s[12:15], s5 offen sc1
    buffer_load_dwordx4 v[40:43], v7, s[12:15], s4 offen sc1
    buffer_load_dwordx4 v[44:47], v7, s[12:15], s5 offen sc1
    buffer_load_dwordx4 v[48:51], v8, s[12:15], s4 offen sc1
    buffer_load_dwordx4 v[52:55], v8, s[12:15], s5 offen sc1
    buffer_load_dwordx4 v[56:59], v9, s[12:15], s4 offen sc1
    buffer_load_dwordx4 v[60:63], v9, s[12:15], s5 offen sc1
    buffer_load_dwordx4 v[64:67], v10, s[12:15], s4 offen sc1
    buffer_load_dwordx4 v[68:71], v10, s[12:15], s5 offen sc1
    s_add_u32 s6, s26, 0
    buffer_load_dwordx4 v[72:75], v5, s[12:15], s6 offen sc1
    s_add_u32 s7, s27, 0
    buffer_load_dwordx4 v[76:79], v5, s[12:15], s7 offen sc1
    buffer_load_dwordx4 v[80:83], v6, s[12:15], s6 offen sc1
    buffer_load_dwordx4 v[84:87], v6, s[12:15], s7 offen sc1
    buffer_load_dwordx4 v[88:91], v7, s[12:15], s6 offen sc1
    buffer_load_dwordx4 v[92:95], v7, s[12:15], s7 offen sc1
    s_waitcnt vmcnt(46)
    v_add_u32 v20, s39, v1
    v_add_u32 v22, 65536, v20
    v_bfe_u32 v23, v1, 4, 4
    v_mul_u32_u24 v23, 1152, v23
    v_lshrrev_b32 v0, 9, v1
    v_lshl_add_u32 v23, v0, 4, v23
    v_bfe_u32 v0, v1, 8, 1
    v_lshl_add_u32 v23, v0, 5, v23
    s_mul_i32 s54, s38, 3
    s_add_u32 s54, s54, 0
    s_lshr_b32 s57, s54, 1
    s_and_b32 s54, s54, 1
    s_lshl_b32 s56, s57, 14
    s_lshl_b32 s58, s54, 11
    s_add_u32 s56, s56, s58
    v_add_u32 v0, s56, v1
    s_mul_i32 s57, s57, 18432
    s_lshl_b32 s54, s54, 6
    s_add_u32 s45, s54, s57
    s_mul_i32 s54, s38, 3
    s_add_u32 s54, s54, 1
    s_lshr_b32 s57, s54, 1
    s_and_b32 s54, s54, 1
    s_lshl_b32 s56, s57, 14
    s_lshl_b32 s58, s54, 11
    s_add_u32 s56, s56, s58
    v_add_u32 v17, s56, v1
    s_mul_i32 s57, s57, 18432
    s_lshl_b32 s54, s54, 6
    s_add_u32 s46, s54, s57
    s_mul_i32 s54, s38, 3
    s_add_u32 s54, s54, 2
    s_lshr_b32 s57, s54, 1
    s_and_b32 s54, s54, 1
    s_lshl_b32 s56, s57, 14
    s_lshl_b32 s58, s54, 11
    s_add_u32 s56, s56, s58
    v_add_u32 v18, s56, v1
    s_mul_i32 s57, s57, 18432
    s_lshl_b32 s54, s54, 6
    s_add_u32 s47, s54, s57
    s_waitcnt vmcnt(16) lgkmcnt(0)
    v_mfma_f32_16x16x32_bf16 a[160:163], v[224:227], v[24:27], 0
    v_mfma_f32_16x16x32_bf16 a[160:163], v[240:243], v[28:31], a[160:163]
    v_mfma_f32_16x16x32_bf16 a[164:167], v[228:231], v[24:27], 0
    v_mfma_f32_16x16x32_bf16 a[164:167], v[244:247], v[28:31], a[164:167]
    v_mfma_f32_16x16x32_bf16 a[168:171], v[232:235], v[24:27], 0
    v_mfma_f32_16x16x32_bf16 a[168:171], v[248:251], v[28:31], a[168:171]
    v_mfma_f32_16x16x32_bf16 a[172:175], v[236:239], v[24:27], 0
    v_mfma_f32_16x16x32_bf16 a[172:175], v[252:255], v[28:31], a[172:175]
    s_waitcnt vmcnt(14)
    v_mfma_f32_16x16x32_bf16 a[176:179], v[224:227], v[32:35], 0
    v_mfma_f32_16x16x32_bf16 a[176:179], v[240:243], v[36:39], a[176:179]
    buffer_load_dwordx4 v[24:27], v8, s[12:15], s6 offen sc1
    v_mfma_f32_16x16x32_bf16 a[180:183], v[228:231], v[32:35], 0
    v_mfma_f32_16x16x32_bf16 a[180:183], v[244:247], v[36:39], a[180:183]
    v_mfma_f32_16x16x32_bf16 a[184:187], v[232:235], v[32:35], 0
    v_mfma_f32_16x16x32_bf16 a[184:187], v[248:251], v[36:39], a[184:187]
    buffer_load_dwordx4 v[28:31], v8, s[12:15], s7 offen sc1
    v_mfma_f32_16x16x32_bf16 a[188:191], v[236:239], v[32:35], 0
    v_mfma_f32_16x16x32_bf16 a[188:191], v[252:255], v[36:39], a[188:191]
    s_waitcnt vmcnt(14)
    v_mfma_f32_16x16x32_bf16 a[192:195], v[224:227], v[40:43], 0
    v_mfma_f32_16x16x32_bf16 a[192:195], v[240:243], v[44:47], a[192:195]
    buffer_load_dwordx4 v[32:35], v9, s[12:15], s6 offen sc1
    v_mfma_f32_16x16x32_bf16 a[196:199], v[228:231], v[40:43], 0
    v_mfma_f32_16x16x32_bf16 a[196:199], v[244:247], v[44:47], a[196:199]
    v_mfma_f32_16x16x32_bf16 a[200:203], v[232:235], v[40:43], 0
    v_mfma_f32_16x16x32_bf16 a[200:203], v[248:251], v[44:47], a[200:203]
    buffer_load_dwordx4 v[36:39], v9, s[12:15], s7 offen sc1
    v_mfma_f32_16x16x32_bf16 a[204:207], v[236:239], v[40:43], 0
    v_mfma_f32_16x16x32_bf16 a[204:207], v[252:255], v[44:47], a[204:207]
    s_waitcnt vmcnt(14)
    v_mfma_f32_16x16x32_bf16 a[208:211], v[224:227], v[48:51], 0
    v_mfma_f32_16x16x32_bf16 a[208:211], v[240:243], v[52:55], a[208:211]
    buffer_load_dwordx4 v[40:43], v10, s[12:15], s6 offen sc1
    v_mfma_f32_16x16x32_bf16 a[212:215], v[228:231], v[48:51], 0
    v_mfma_f32_16x16x32_bf16 a[212:215], v[244:247], v[52:55], a[212:215]
    v_mfma_f32_16x16x32_bf16 a[216:219], v[232:235], v[48:51], 0
    v_mfma_f32_16x16x32_bf16 a[216:219], v[248:251], v[52:55], a[216:219]
    buffer_load_dwordx4 v[44:47], v10, s[12:15], s7 offen sc1
    v_mfma_f32_16x16x32_bf16 a[220:223], v[236:239], v[48:51], 0
    v_mfma_f32_16x16x32_bf16 a[220:223], v[252:255], v[52:55], a[220:223]
    s_waitcnt vmcnt(14)
    v_mfma_f32_16x16x32_bf16 a[224:227], v[224:227], v[56:59], 0
    v_mfma_f32_16x16x32_bf16 a[224:227], v[240:243], v[60:63], a[224:227]
    s_add_u32 s40, s28, 0
    buffer_load_dwordx4 v[48:51], v5, s[12:15], s40 offen sc1
    v_mfma_f32_16x16x32_bf16 a[228:231], v[228:231], v[56:59], 0
    v_mfma_f32_16x16x32_bf16 a[228:231], v[244:247], v[60:63], a[228:231]
    v_mfma_f32_16x16x32_bf16 a[232:235], v[232:235], v[56:59], 0
    v_mfma_f32_16x16x32_bf16 a[232:235], v[248:251], v[60:63], a[232:235]
    s_add_u32 s41, s29, 0
    buffer_load_dwordx4 v[52:55], v5, s[12:15], s41 offen sc1
    v_mfma_f32_16x16x32_bf16 a[236:239], v[236:239], v[56:59], 0
    v_mfma_f32_16x16x32_bf16 a[236:239], v[252:255], v[60:63], a[236:239]
    s_waitcnt vmcnt(14)
    v_mfma_f32_16x16x32_bf16 a[240:243], v[224:227], v[64:67], 0
    v_mfma_f32_16x16x32_bf16 a[240:243], v[240:243], v[68:71], a[240:243]
    buffer_load_dwordx4 v[56:59], v6, s[12:15], s40 offen sc1
    v_mfma_f32_16x16x32_bf16 a[244:247], v[228:231], v[64:67], 0
    v_mfma_f32_16x16x32_bf16 a[244:247], v[244:247], v[68:71], a[244:247]
    v_mfma_f32_16x16x32_bf16 a[248:251], v[232:235], v[64:67], 0
    v_mfma_f32_16x16x32_bf16 a[248:251], v[248:251], v[68:71], a[248:251]
    buffer_load_dwordx4 v[60:63], v6, s[12:15], s41 offen sc1
    v_mfma_f32_16x16x32_bf16 a[252:255], v[236:239], v[64:67], 0
    v_mfma_f32_16x16x32_bf16 a[252:255], v[252:255], v[68:71], a[252:255]
    s_waitcnt vmcnt(14) lgkmcnt(0)
    v_mfma_f32_16x16x32_bf16 a[160:163], a[32:35], v[72:75], a[160:163]
    ds_read_b64_tr_b16 v[224:225], v13 offset:32768
    ds_read_b64_tr_b16 v[226:227], v13 offset:34816
    v_mfma_f32_16x16x32_bf16 a[160:163], a[48:51], v[76:79], a[160:163]
    buffer_load_dwordx4 v[64:67], v7, s[12:15], s40 offen sc1
    v_mfma_f32_16x16x32_bf16 a[164:167], a[36:39], v[72:75], a[164:167]
    ds_read_b64_tr_b16 v[228:229], v14 offset:32768
    ds_read_b64_tr_b16 v[230:231], v14 offset:34816
    v_mfma_f32_16x16x32_bf16 a[164:167], a[52:55], v[76:79], a[164:167]
    ds_read_b64_tr_b16 v[232:233], v13 offset:33280
    ds_read_b64_tr_b16 v[234:235], v13 offset:35328
    v_mfma_f32_16x16x32_bf16 a[168:171], a[40:43], v[72:75], a[168:171]
    ds_read_b64_tr_b16 v[236:237], v14 offset:33280
    ds_read_b64_tr_b16 v[238:239], v14 offset:35328
    v_mfma_f32_16x16x32_bf16 a[168:171], a[56:59], v[76:79], a[168:171]
    buffer_load_dwordx4 v[68:71], v7, s[12:15], s41 offen sc1
    v_mfma_f32_16x16x32_bf16 a[172:175], a[44:47], v[72:75], a[172:175]
    ds_read_b64_tr_b16 v[240:241], v13 offset:49152
    ds_read_b64_tr_b16 v[242:243], v13 offset:51200
    v_mfma_f32_16x16x32_bf16 a[172:175], a[60:63], v[76:79], a[172:175]
    s_waitcnt vmcnt(14)
    v_mfma_f32_16x16x32_bf16 a[176:179], a[32:35], v[80:83], a[176:179]
    ds_read_b64_tr_b16 v[244:245], v14 offset:49152
    ds_read_b64_tr_b16 v[246:247], v14 offset:51200
    v_mfma_f32_16x16x32_bf16 a[176:179], a[48:51], v[84:87], a[176:179]
    buffer_load_dwordx4 v[72:75], v8, s[12:15], s40 offen sc1
    v_mfma_f32_16x16x32_bf16 a[180:183], a[36:39], v[80:83], a[180:183]
    ds_read_b64_tr_b16 v[248:249], v13 offset:49664
    ds_read_b64_tr_b16 v[250:251], v13 offset:51712
    v_mfma_f32_16x16x32_bf16 a[180:183], a[52:55], v[84:87], a[180:183]
    ds_read_b64_tr_b16 v[252:253], v14 offset:49664
    ds_read_b64_tr_b16 v[254:255], v14 offset:51712
    v_mfma_f32_16x16x32_bf16 a[184:187], a[40:43], v[80:83], a[184:187]
    v_mfma_f32_16x16x32_bf16 a[184:187], a[56:59], v[84:87], a[184:187]
    buffer_load_dwordx4 v[76:79], v8, s[12:15], s41 offen sc1
    v_mfma_f32_16x16x32_bf16 a[188:191], a[44:47], v[80:83], a[188:191]
    v_mfma_f32_16x16x32_bf16 a[188:191], a[60:63], v[84:87], a[188:191]
    s_waitcnt vmcnt(14)
    v_mfma_f32_16x16x32_bf16 a[192:195], a[32:35], v[88:91], a[192:195]
    v_mfma_f32_16x16x32_bf16 a[192:195], a[48:51], v[92:95], a[192:195]
    buffer_load_dwordx4 v[80:83], v9, s[12:15], s40 offen sc1
    v_mfma_f32_16x16x32_bf16 a[196:199], a[36:39], v[88:91], a[196:199]
    v_mfma_f32_16x16x32_bf16 a[196:199], a[52:55], v[92:95], a[196:199]
    v_mfma_f32_16x16x32_bf16 a[200:203], a[40:43], v[88:91], a[200:203]
    v_mfma_f32_16x16x32_bf16 a[200:203], a[56:59], v[92:95], a[200:203]
    buffer_load_dwordx4 v[84:87], v9, s[12:15], s41 offen sc1
    v_mfma_f32_16x16x32_bf16 a[204:207], a[44:47], v[88:91], a[204:207]
    v_mfma_f32_16x16x32_bf16 a[204:207], a[60:63], v[92:95], a[204:207]
    s_waitcnt vmcnt(14)
    v_mfma_f32_16x16x32_bf16 a[208:211], a[32:35], v[24:27], a[208:211]
    v_mfma_f32_16x16x32_bf16 a[208:211], a[48:51], v[28:31], a[208:211]
    buffer_load_dwordx4 v[88:91], v10, s[12:15], s40 offen sc1
    v_mfma_f32_16x16x32_bf16 a[212:215], a[36:39], v[24:27], a[212:215]
    v_mfma_f32_16x16x32_bf16 a[212:215], a[52:55], v[28:31], a[212:215]
    v_mfma_f32_16x16x32_bf16 a[216:219], a[40:43], v[24:27], a[216:219]
    v_mfma_f32_16x16x32_bf16 a[216:219], a[56:59], v[28:31], a[216:219]
    buffer_load_dwordx4 v[92:95], v10, s[12:15], s41 offen sc1
    v_mfma_f32_16x16x32_bf16 a[220:223], a[44:47], v[24:27], a[220:223]
    v_mfma_f32_16x16x32_bf16 a[220:223], a[60:63], v[28:31], a[220:223]
    s_waitcnt vmcnt(14)
    v_mfma_f32_16x16x32_bf16 a[224:227], a[32:35], v[32:35], a[224:227]
    v_mfma_f32_16x16x32_bf16 a[224:227], a[48:51], v[36:39], a[224:227]
    s_add_u32 s43, s30, 0
    buffer_load_dwordx4 v[24:27], v5, s[12:15], s43 offen sc1
    v_mfma_f32_16x16x32_bf16 a[228:231], a[36:39], v[32:35], a[228:231]
    v_mfma_f32_16x16x32_bf16 a[228:231], a[52:55], v[36:39], a[228:231]
    v_mfma_f32_16x16x32_bf16 a[232:235], a[40:43], v[32:35], a[232:235]
    v_mfma_f32_16x16x32_bf16 a[232:235], a[56:59], v[36:39], a[232:235]
    s_add_u32 s100, s31, 0
    buffer_load_dwordx4 v[28:31], v5, s[12:15], s100 offen sc1
    v_mfma_f32_16x16x32_bf16 a[236:239], a[44:47], v[32:35], a[236:239]
    v_mfma_f32_16x16x32_bf16 a[236:239], a[60:63], v[36:39], a[236:239]
    s_waitcnt vmcnt(14)
    v_mfma_f32_16x16x32_bf16 a[240:243], a[32:35], v[40:43], a[240:243]
    v_mfma_f32_16x16x32_bf16 a[240:243], a[48:51], v[44:47], a[240:243]
    buffer_load_dwordx4 v[32:35], v6, s[12:15], s43 offen sc1
    v_mfma_f32_16x16x32_bf16 a[244:247], a[36:39], v[40:43], a[244:247]
    v_mfma_f32_16x16x32_bf16 a[244:247], a[52:55], v[44:47], a[244:247]
    v_mfma_f32_16x16x32_bf16 a[248:251], a[40:43], v[40:43], a[248:251]
    v_mfma_f32_16x16x32_bf16 a[248:251], a[56:59], v[44:47], a[248:251]
    buffer_load_dwordx4 v[36:39], v6, s[12:15], s100 offen sc1
    v_mfma_f32_16x16x32_bf16 a[252:255], a[44:47], v[40:43], a[252:255]
    v_mfma_f32_16x16x32_bf16 a[252:255], a[60:63], v[44:47], a[252:255]
    s_waitcnt vmcnt(14) lgkmcnt(0)
    v_mfma_f32_16x16x32_bf16 a[160:163], a[64:67], v[48:51], a[160:163]
    ds_read_b64_tr_b16 a[32:33], v15 offset:0
    ds_read_b64_tr_b16 a[34:35], v15 offset:2048
    v_mfma_f32_16x16x32_bf16 a[160:163], a[80:83], v[52:55], a[160:163]
    buffer_load_dwordx4 v[40:43], v7, s[12:15], s43 offen sc1
    v_mfma_f32_16x16x32_bf16 a[164:167], a[68:71], v[48:51], a[164:167]
    ds_read_b64_tr_b16 a[36:37], v16 offset:0
    ds_read_b64_tr_b16 a[38:39], v16 offset:2048
    v_mfma_f32_16x16x32_bf16 a[164:167], a[84:87], v[52:55], a[164:167]
    ds_read_b64_tr_b16 a[40:41], v15 offset:512
    ds_read_b64_tr_b16 a[42:43], v15 offset:2560
    v_mfma_f32_16x16x32_bf16 a[168:171], a[72:75], v[48:51], a[168:171]
    ds_read_b64_tr_b16 a[44:45], v16 offset:512
    ds_read_b64_tr_b16 a[46:47], v16 offset:2560
    v_mfma_f32_16x16x32_bf16 a[168:171], a[88:91], v[52:55], a[168:171]
    buffer_load_dwordx4 v[44:47], v7, s[12:15], s100 offen sc1
    v_mfma_f32_16x16x32_bf16 a[172:175], a[76:79], v[48:51], a[172:175]
    ds_read_b64_tr_b16 a[48:49], v15 offset:16384
    ds_read_b64_tr_b16 a[50:51], v15 offset:18432
    v_mfma_f32_16x16x32_bf16 a[172:175], a[92:95], v[52:55], a[172:175]
    s_waitcnt vmcnt(14)
    v_mfma_f32_16x16x32_bf16 a[176:179], a[64:67], v[56:59], a[176:179]
    ds_read_b64_tr_b16 a[52:53], v16 offset:16384
    ds_read_b64_tr_b16 a[54:55], v16 offset:18432
    v_mfma_f32_16x16x32_bf16 a[176:179], a[80:83], v[60:63], a[176:179]
    buffer_load_dwordx4 v[48:51], v8, s[12:15], s43 offen sc1
    v_mfma_f32_16x16x32_bf16 a[180:183], a[68:71], v[56:59], a[180:183]
    ds_read_b64_tr_b16 a[56:57], v15 offset:16896
    ds_read_b64_tr_b16 a[58:59], v15 offset:18944
    v_mfma_f32_16x16x32_bf16 a[180:183], a[84:87], v[60:63], a[180:183]
    ds_read_b64_tr_b16 a[60:61], v16 offset:16896
    ds_read_b64_tr_b16 a[62:63], v16 offset:18944
    v_mfma_f32_16x16x32_bf16 a[184:187], a[72:75], v[56:59], a[184:187]
    s_add_u32 m0, s39, 98304
    s_add_u32 s42, s86, 884736
    v_mfma_f32_16x16x32_bf16 a[184:187], a[88:91], v[60:63], a[184:187]
    buffer_load_dwordx4 v[52:55], v8, s[12:15], s100 offen sc1
    v_mfma_f32_16x16x32_bf16 a[188:191], a[76:79], v[56:59], a[188:191]
    buffer_load_dwordx4 v2, s[8:11], s42 offen lds
    v_mfma_f32_16x16x32_bf16 a[188:191], a[92:95], v[60:63], a[188:191]
    s_waitcnt vmcnt(15)
    v_mfma_f32_16x16x32_bf16 a[192:195], a[64:67], v[64:67], a[192:195]
    buffer_load_dwordx4 v3, s[8:11], s42 offen offset:1024 lds
    v_mfma_f32_16x16x32_bf16 a[192:195], a[80:83], v[68:71], a[192:195]
    buffer_load_dwordx4 v[56:59], v9, s[12:15], s43 offen sc1
    v_mfma_f32_16x16x32_bf16 a[196:199], a[68:71], v[64:67], a[196:199]
    buffer_load_dwordx4 v4, s[8:11], s42 offen offset:2048 lds
    v_mfma_f32_16x16x32_bf16 a[196:199], a[84:87], v[68:71], a[196:199]
    buffer_load_dwordx4 v21, s[8:11], s42 offen offset:3072 lds
    v_mfma_f32_16x16x32_bf16 a[200:203], a[72:75], v[64:67], a[200:203]
    s_add_u32 m0, s39, 114688
    s_add_u32 s42, s87, 884736
    v_mfma_f32_16x16x32_bf16 a[200:203], a[88:91], v[68:71], a[200:203]
    buffer_load_dwordx4 v[60:63], v9, s[12:15], s100 offen sc1
    v_mfma_f32_16x16x32_bf16 a[204:207], a[76:79], v[64:67], a[204:207]
    buffer_load_dwordx4 v2, s[8:11], s42 offen lds
    v_mfma_f32_16x16x32_bf16 a[204:207], a[92:95], v[68:71], a[204:207]
    s_waitcnt vmcnt(19)
    v_mfma_f32_16x16x32_bf16 a[208:211], a[64:67], v[72:75], a[208:211]
    buffer_load_dwordx4 v3, s[8:11], s42 offen offset:1024 lds
    v_mfma_f32_16x16x32_bf16 a[208:211], a[80:83], v[76:79], a[208:211]
    buffer_load_dwordx4 v[64:67], v10, s[12:15], s43 offen sc1
    v_mfma_f32_16x16x32_bf16 a[212:215], a[68:71], v[72:75], a[212:215]
    buffer_load_dwordx4 v4, s[8:11], s42 offen offset:2048 lds
    v_mfma_f32_16x16x32_bf16 a[212:215], a[84:87], v[76:79], a[212:215]
    buffer_load_dwordx4 v21, s[8:11], s42 offen offset:3072 lds
    v_mfma_f32_16x16x32_bf16 a[216:219], a[72:75], v[72:75], a[216:219]
    v_mfma_f32_16x16x32_bf16 a[216:219], a[88:91], v[76:79], a[216:219]
    buffer_load_dwordx4 v[68:71], v10, s[12:15], s100 offen sc1
    v_mfma_f32_16x16x32_bf16 a[220:223], a[76:79], v[72:75], a[220:223]
    v_mfma_f32_16x16x32_bf16 a[220:223], a[92:95], v[76:79], a[220:223]
    s_waitcnt vmcnt(22)
    v_mfma_f32_16x16x32_bf16 a[224:227], a[64:67], v[80:83], a[224:227]
    v_mfma_f32_16x16x32_bf16 a[224:227], a[80:83], v[84:87], a[224:227]
    s_add_u32 s4, s24, 8192
    buffer_load_dwordx4 v[72:75], v5, s[12:15], s4 offen sc1
    v_mfma_f32_16x16x32_bf16 a[228:231], a[68:71], v[80:83], a[228:231]
    v_mfma_f32_16x16x32_bf16 a[228:231], a[84:87], v[84:87], a[228:231]
    v_mfma_f32_16x16x32_bf16 a[232:235], a[72:75], v[80:83], a[232:235]
    v_mfma_f32_16x16x32_bf16 a[232:235], a[88:91], v[84:87], a[232:235]
    s_add_u32 s5, s25, 8192
    buffer_load_dwordx4 v[76:79], v5, s[12:15], s5 offen sc1
    v_mfma_f32_16x16x32_bf16 a[236:239], a[76:79], v[80:83], a[236:239]
    v_mfma_f32_16x16x32_bf16 a[236:239], a[92:95], v[84:87], a[236:239]
    s_waitcnt vmcnt(22)
    v_mfma_f32_16x16x32_bf16 a[240:243], a[64:67], v[88:91], a[240:243]
    v_mfma_f32_16x16x32_bf16 a[240:243], a[80:83], v[92:95], a[240:243]
    buffer_load_dwordx4 v[80:83], v6, s[12:15], s4 offen sc1
    v_mfma_f32_16x16x32_bf16 a[244:247], a[68:71], v[88:91], a[244:247]
    v_mfma_f32_16x16x32_bf16 a[244:247], a[84:87], v[92:95], a[244:247]
    v_mfma_f32_16x16x32_bf16 a[248:251], a[72:75], v[88:91], a[248:251]
    v_mfma_f32_16x16x32_bf16 a[248:251], a[88:91], v[92:95], a[248:251]
    buffer_load_dwordx4 v[84:87], v6, s[12:15], s5 offen sc1
    v_mfma_f32_16x16x32_bf16 a[252:255], a[76:79], v[88:91], a[252:255]
    v_mfma_f32_16x16x32_bf16 a[252:255], a[92:95], v[92:95], a[252:255]
    s_waitcnt vmcnt(22) lgkmcnt(0)
    v_mfma_f32_16x16x32_bf16 a[160:163], a[96:99], v[24:27], a[160:163]
    ds_read_b64_tr_b16 a[64:65], v13 offset:0
    ds_read_b64_tr_b16 a[66:67], v13 offset:2048
    v_mfma_f32_16x16x32_bf16 a[160:163], a[112:115], v[28:31], a[160:163]
    buffer_load_dwordx4 v[88:91], v7, s[12:15], s4 offen sc1
    v_mfma_f32_16x16x32_bf16 a[164:167], a[100:103], v[24:27], a[164:167]
    ds_read_b64_tr_b16 a[68:69], v14 offset:0
    ds_read_b64_tr_b16 a[70:71], v14 offset:2048
    v_mfma_f32_16x16x32_bf16 a[164:167], a[116:119], v[28:31], a[164:167]
    ds_read_b64_tr_b16 a[72:73], v13 offset:512
    ds_read_b64_tr_b16 a[74:75], v13 offset:2560
    v_mfma_f32_16x16x32_bf16 a[168:171], a[104:107], v[24:27], a[168:171]
    ds_read_b64_tr_b16 a[76:77], v14 offset:512
    ds_read_b64_tr_b16 a[78:79], v14 offset:2560
    v_mfma_f32_16x16x32_bf16 a[168:171], a[120:123], v[28:31], a[168:171]
    buffer_load_dwordx4 v[92:95], v7, s[12:15], s5 offen sc1
    v_mfma_f32_16x16x32_bf16 a[172:175], a[108:111], v[24:27], a[172:175]
    ds_read_b64_tr_b16 a[80:81], v11 offset:16384
    ds_read_b64_tr_b16 a[82:83], v11 offset:18432
    v_mfma_f32_16x16x32_bf16 a[172:175], a[124:127], v[28:31], a[172:175]
    s_waitcnt vmcnt(22)
    v_mfma_f32_16x16x32_bf16 a[176:179], a[96:99], v[32:35], a[176:179]
    ds_read_b64_tr_b16 a[84:85], v12 offset:16384
    ds_read_b64_tr_b16 a[86:87], v12 offset:18432
    v_mfma_f32_16x16x32_bf16 a[176:179], a[112:115], v[36:39], a[176:179]
    buffer_load_dwordx4 v[24:27], v8, s[12:15], s4 offen sc1
    v_mfma_f32_16x16x32_bf16 a[180:183], a[100:103], v[32:35], a[180:183]
    ds_read_b64_tr_b16 a[88:89], v11 offset:16896
    ds_read_b64_tr_b16 a[90:91], v11 offset:18944
    v_mfma_f32_16x16x32_bf16 a[180:183], a[116:119], v[36:39], a[180:183]
    ds_read_b64_tr_b16 a[92:93], v12 offset:16896
    ds_read_b64_tr_b16 a[94:95], v12 offset:18944
    v_mfma_f32_16x16x32_bf16 a[184:187], a[104:107], v[32:35], a[184:187]
    v_mfma_f32_16x16x32_bf16 a[184:187], a[120:123], v[36:39], a[184:187]
    buffer_load_dwordx4 v[28:31], v8, s[12:15], s5 offen sc1
    v_mfma_f32_16x16x32_bf16 a[188:191], a[108:111], v[32:35], a[188:191]
    v_mfma_f32_16x16x32_bf16 a[188:191], a[124:127], v[36:39], a[188:191]
    s_waitcnt vmcnt(22)
    v_mfma_f32_16x16x32_bf16 a[192:195], a[96:99], v[40:43], a[192:195]
    v_mfma_f32_16x16x32_bf16 a[192:195], a[112:115], v[44:47], a[192:195]
    buffer_load_dwordx4 v[32:35], v9, s[12:15], s4 offen sc1
    v_mfma_f32_16x16x32_bf16 a[196:199], a[100:103], v[40:43], a[196:199]
    v_mfma_f32_16x16x32_bf16 a[196:199], a[116:119], v[44:47], a[196:199]
    v_mfma_f32_16x16x32_bf16 a[200:203], a[104:107], v[40:43], a[200:203]
    v_mfma_f32_16x16x32_bf16 a[200:203], a[120:123], v[44:47], a[200:203]
    buffer_load_dwordx4 v[36:39], v9, s[12:15], s5 offen sc1
    v_mfma_f32_16x16x32_bf16 a[204:207], a[108:111], v[40:43], a[204:207]
    v_mfma_f32_16x16x32_bf16 a[204:207], a[124:127], v[44:47], a[204:207]
    s_waitcnt vmcnt(22)
    v_mfma_f32_16x16x32_bf16 a[208:211], a[96:99], v[48:51], a[208:211]
    v_mfma_f32_16x16x32_bf16 a[208:211], a[112:115], v[52:55], a[208:211]
    buffer_load_dwordx4 v[40:43], v10, s[12:15], s4 offen sc1
    v_mfma_f32_16x16x32_bf16 a[212:215], a[100:103], v[48:51], a[212:215]
    v_mfma_f32_16x16x32_bf16 a[212:215], a[116:119], v[52:55], a[212:215]
    v_mfma_f32_16x16x32_bf16 a[216:219], a[104:107], v[48:51], a[216:219]
    v_mfma_f32_16x16x32_bf16 a[216:219], a[120:123], v[52:55], a[216:219]
    buffer_load_dwordx4 v[44:47], v10, s[12:15], s5 offen sc1
    v_mfma_f32_16x16x32_bf16 a[220:223], a[108:111], v[48:51], a[220:223]
    v_mfma_f32_16x16x32_bf16 a[220:223], a[124:127], v[52:55], a[220:223]
    s_waitcnt vmcnt(18)
    v_mfma_f32_16x16x32_bf16 a[224:227], a[96:99], v[56:59], a[224:227]
    v_mfma_f32_16x16x32_bf16 a[224:227], a[112:115], v[60:63], a[224:227]
    s_add_u32 s6, s26, 8192
    buffer_load_dwordx4 v[48:51], v5, s[12:15], s6 offen sc1
    v_mfma_f32_16x16x32_bf16 a[228:231], a[100:103], v[56:59], a[228:231]
    v_mfma_f32_16x16x32_bf16 a[228:231], a[116:119], v[60:63], a[228:231]
    v_mfma_f32_16x16x32_bf16 a[232:235], a[104:107], v[56:59], a[232:235]
    v_mfma_f32_16x16x32_bf16 a[232:235], a[120:123], v[60:63], a[232:235]
    s_add_u32 s7, s27, 8192
    buffer_load_dwordx4 v[52:55], v5, s[12:15], s7 offen sc1
    v_mfma_f32_16x16x32_bf16 a[236:239], a[108:111], v[56:59], a[236:239]
    v_mfma_f32_16x16x32_bf16 a[236:239], a[124:127], v[60:63], a[236:239]
    s_waitcnt vmcnt(14)
    v_mfma_f32_16x16x32_bf16 a[240:243], a[96:99], v[64:67], a[240:243]
    v_mfma_f32_16x16x32_bf16 a[240:243], a[112:115], v[68:71], a[240:243]
    buffer_load_dwordx4 v[56:59], v6, s[12:15], s6 offen sc1
    v_mfma_f32_16x16x32_bf16 a[244:247], a[100:103], v[64:67], a[244:247]
    v_mfma_f32_16x16x32_bf16 a[244:247], a[116:119], v[68:71], a[244:247]
    v_mfma_f32_16x16x32_bf16 a[248:251], a[104:107], v[64:67], a[248:251]
    v_mfma_f32_16x16x32_bf16 a[248:251], a[120:123], v[68:71], a[248:251]
    buffer_load_dwordx4 v[60:63], v6, s[12:15], s7 offen sc1
    v_mfma_f32_16x16x32_bf16 a[252:255], a[108:111], v[64:67], a[252:255]
    v_mfma_f32_16x16x32_bf16 a[252:255], a[124:127], v[68:71], a[252:255]
    s_waitcnt vmcnt(14) lgkmcnt(0)
    v_mfma_f32_16x16x32_bf16 a[160:163], a[128:131], v[72:75], a[160:163]
    ds_read_b64_tr_b16 a[96:97], v11 offset:49152
    ds_read_b64_tr_b16 a[98:99], v11 offset:51200
    v_mfma_f32_16x16x32_bf16 a[160:163], a[144:147], v[76:79], a[160:163]
    buffer_load_dwordx4 v[64:67], v7, s[12:15], s6 offen sc1
    v_mfma_f32_16x16x32_bf16 a[164:167], a[132:135], v[72:75], a[164:167]
    ds_read_b64_tr_b16 a[100:101], v12 offset:49152
    ds_read_b64_tr_b16 a[102:103], v12 offset:51200
    v_mfma_f32_16x16x32_bf16 a[164:167], a[148:151], v[76:79], a[164:167]
    ds_read_b64_tr_b16 a[104:105], v11 offset:49664
    ds_read_b64_tr_b16 a[106:107], v11 offset:51712
    v_mfma_f32_16x16x32_bf16 a[168:171], a[136:139], v[72:75], a[168:171]
    ds_read_b64_tr_b16 a[108:109], v12 offset:49664
    ds_read_b64_tr_b16 a[110:111], v12 offset:51712
    v_mfma_f32_16x16x32_bf16 a[168:171], a[152:155], v[76:79], a[168:171]
    buffer_load_dwordx4 v[68:71], v7, s[12:15], s7 offen sc1
    v_mfma_f32_16x16x32_bf16 a[172:175], a[140:143], v[72:75], a[172:175]
    ds_read_b64_tr_b16 a[112:113], v11 offset:32768
    ds_read_b64_tr_b16 a[114:115], v11 offset:34816
    v_mfma_f32_16x16x32_bf16 a[172:175], a[156:159], v[76:79], a[172:175]
    s_waitcnt vmcnt(14)
    v_mfma_f32_16x16x32_bf16 a[176:179], a[128:131], v[80:83], a[176:179]
    ds_read_b64_tr_b16 a[116:117], v12 offset:32768
    ds_read_b64_tr_b16 a[118:119], v12 offset:34816
    v_mfma_f32_16x16x32_bf16 a[176:179], a[144:147], v[84:87], a[176:179]
    buffer_load_dwordx4 v[72:75], v8, s[12:15], s6 offen sc1
    v_mfma_f32_16x16x32_bf16 a[180:183], a[132:135], v[80:83], a[180:183]
    ds_read_b64_tr_b16 a[120:121], v11 offset:33280
    ds_read_b64_tr_b16 a[122:123], v11 offset:35328
    v_mfma_f32_16x16x32_bf16 a[180:183], a[148:151], v[84:87], a[180:183]
    ds_read_b64_tr_b16 a[124:125], v12 offset:33280
    ds_read_b64_tr_b16 a[126:127], v12 offset:35328
    v_mfma_f32_16x16x32_bf16 a[184:187], a[136:139], v[80:83], a[184:187]
    v_mfma_f32_16x16x32_bf16 a[184:187], a[152:155], v[84:87], a[184:187]
    buffer_load_dwordx4 v[76:79], v8, s[12:15], s7 offen sc1
    v_mfma_f32_16x16x32_bf16 a[188:191], a[140:143], v[80:83], a[188:191]
    v_mfma_f32_16x16x32_bf16 a[188:191], a[156:159], v[84:87], a[188:191]
    s_waitcnt vmcnt(14)
    v_mfma_f32_16x16x32_bf16 a[192:195], a[128:131], v[88:91], a[192:195]
    v_mfma_f32_16x16x32_bf16 a[192:195], a[144:147], v[92:95], a[192:195]
    buffer_load_dwordx4 v[80:83], v9, s[12:15], s6 offen sc1
    v_mfma_f32_16x16x32_bf16 a[196:199], a[132:135], v[88:91], a[196:199]
    v_mfma_f32_16x16x32_bf16 a[196:199], a[148:151], v[92:95], a[196:199]
    v_mfma_f32_16x16x32_bf16 a[200:203], a[136:139], v[88:91], a[200:203]
    v_mfma_f32_16x16x32_bf16 a[200:203], a[152:155], v[92:95], a[200:203]
    buffer_load_dwordx4 v[84:87], v9, s[12:15], s7 offen sc1
    v_mfma_f32_16x16x32_bf16 a[204:207], a[140:143], v[88:91], a[204:207]
    v_mfma_f32_16x16x32_bf16 a[204:207], a[156:159], v[92:95], a[204:207]
    s_waitcnt vmcnt(14)
    v_mfma_f32_16x16x32_bf16 a[208:211], a[128:131], v[24:27], a[208:211]
    v_mfma_f32_16x16x32_bf16 a[208:211], a[144:147], v[28:31], a[208:211]
    buffer_load_dwordx4 v[88:91], v10, s[12:15], s6 offen sc1
    v_mfma_f32_16x16x32_bf16 a[212:215], a[132:135], v[24:27], a[212:215]
    v_mfma_f32_16x16x32_bf16 a[212:215], a[148:151], v[28:31], a[212:215]
    v_mfma_f32_16x16x32_bf16 a[216:219], a[136:139], v[24:27], a[216:219]
    v_mfma_f32_16x16x32_bf16 a[216:219], a[152:155], v[28:31], a[216:219]
    buffer_load_dwordx4 v[92:95], v10, s[12:15], s7 offen sc1
    v_mfma_f32_16x16x32_bf16 a[220:223], a[140:143], v[24:27], a[220:223]
    v_mfma_f32_16x16x32_bf16 a[220:223], a[156:159], v[28:31], a[220:223]
    s_waitcnt vmcnt(14)
    v_mfma_f32_16x16x32_bf16 a[224:227], a[128:131], v[32:35], a[224:227]
    v_mfma_f32_16x16x32_bf16 a[224:227], a[144:147], v[36:39], a[224:227]
    s_add_u32 s40, s28, 8192
    buffer_load_dwordx4 v[24:27], v5, s[12:15], s40 offen sc1
    v_mfma_f32_16x16x32_bf16 a[228:231], a[132:135], v[32:35], a[228:231]
    v_mfma_f32_16x16x32_bf16 a[228:231], a[148:151], v[36:39], a[228:231]
    v_mfma_f32_16x16x32_bf16 a[232:235], a[136:139], v[32:35], a[232:235]
    v_mfma_f32_16x16x32_bf16 a[232:235], a[152:155], v[36:39], a[232:235]
    s_add_u32 s41, s29, 8192
    buffer_load_dwordx4 v[28:31], v5, s[12:15], s41 offen sc1
    v_mfma_f32_16x16x32_bf16 a[236:239], a[140:143], v[32:35], a[236:239]
    v_mfma_f32_16x16x32_bf16 a[236:239], a[156:159], v[36:39], a[236:239]
    s_waitcnt vmcnt(14)
    v_mfma_f32_16x16x32_bf16 a[240:243], a[128:131], v[40:43], a[240:243]
    v_mfma_f32_16x16x32_bf16 a[240:243], a[144:147], v[44:47], a[240:243]
    buffer_load_dwordx4 v[32:35], v6, s[12:15], s40 offen sc1
    v_mfma_f32_16x16x32_bf16 a[244:247], a[132:135], v[40:43], a[244:247]
    v_mfma_f32_16x16x32_bf16 a[244:247], a[148:151], v[44:47], a[244:247]
    v_mfma_f32_16x16x32_bf16 a[248:251], a[136:139], v[40:43], a[248:251]
    v_mfma_f32_16x16x32_bf16 a[248:251], a[152:155], v[44:47], a[248:251]
    buffer_load_dwordx4 v[36:39], v6, s[12:15], s41 offen sc1
    v_mfma_f32_16x16x32_bf16 a[252:255], a[140:143], v[40:43], a[252:255]
    v_mfma_f32_16x16x32_bf16 a[252:255], a[156:159], v[44:47], a[252:255]
    s_waitcnt vmcnt(14) lgkmcnt(0)
    v_mfma_f32_16x16x32_bf16 a[160:163], v[96:99], v[48:51], a[160:163]
    ds_read_b64_tr_b16 a[128:129], v11 offset:0
    ds_read_b64_tr_b16 a[130:131], v11 offset:2048
    v_mfma_f32_16x16x32_bf16 a[160:163], v[112:115], v[52:55], a[160:163]
    buffer_load_dwordx4 v[40:43], v7, s[12:15], s40 offen sc1
    v_mfma_f32_16x16x32_bf16 a[164:167], v[100:103], v[48:51], a[164:167]
    ds_read_b64_tr_b16 a[132:133], v12 offset:0
    ds_read_b64_tr_b16 a[134:135], v12 offset:2048
    v_mfma_f32_16x16x32_bf16 a[164:167], v[116:119], v[52:55], a[164:167]
    ds_read_b64_tr_b16 a[136:137], v11 offset:512
    ds_read_b64_tr_b16 a[138:139], v11 offset:2560
    v_mfma_f32_16x16x32_bf16 a[168:171], v[104:107], v[48:51], a[168:171]
    ds_read_b64_tr_b16 a[140:141], v12 offset:512
    ds_read_b64_tr_b16 a[142:143], v12 offset:2560
    v_mfma_f32_16x16x32_bf16 a[168:171], v[120:123], v[52:55], a[168:171]
    buffer_load_dwordx4 v[44:47], v7, s[12:15], s41 offen sc1
    v_mfma_f32_16x16x32_bf16 a[172:175], v[108:111], v[48:51], a[172:175]
    ds_read_b64_tr_b16 a[144:145], v13 offset:16384
    ds_read_b64_tr_b16 a[146:147], v13 offset:18432
    v_mfma_f32_16x16x32_bf16 a[172:175], v[124:127], v[52:55], a[172:175]
    s_waitcnt vmcnt(14)
    v_mfma_f32_16x16x32_bf16 a[176:179], v[96:99], v[56:59], a[176:179]
    ds_read_b64_tr_b16 a[148:149], v14 offset:16384
    ds_read_b64_tr_b16 a[150:151], v14 offset:18432
    v_mfma_f32_16x16x32_bf16 a[176:179], v[112:115], v[60:63], a[176:179]
    buffer_load_dwordx4 v[48:51], v8, s[12:15], s40 offen sc1
    v_mfma_f32_16x16x32_bf16 a[180:183], v[100:103], v[56:59], a[180:183]
    ds_read_b64_tr_b16 a[152:153], v13 offset:16896
    ds_read_b64_tr_b16 a[154:155], v13 offset:18944
    v_mfma_f32_16x16x32_bf16 a[180:183], v[116:119], v[60:63], a[180:183]
    ds_read_b64_tr_b16 a[156:157], v14 offset:16896
    ds_read_b64_tr_b16 a[158:159], v14 offset:18944
    v_mfma_f32_16x16x32_bf16 a[184:187], v[104:107], v[56:59], a[184:187]
    v_mfma_f32_16x16x32_bf16 a[184:187], v[120:123], v[60:63], a[184:187]
    buffer_load_dwordx4 v[52:55], v8, s[12:15], s41 offen sc1
    v_mfma_f32_16x16x32_bf16 a[188:191], v[108:111], v[56:59], a[188:191]
    v_mfma_f32_16x16x32_bf16 a[188:191], v[124:127], v[60:63], a[188:191]
    s_waitcnt vmcnt(14)
    v_mfma_f32_16x16x32_bf16 a[192:195], v[96:99], v[64:67], a[192:195]
    v_mfma_f32_16x16x32_bf16 a[192:195], v[112:115], v[68:71], a[192:195]
    buffer_load_dwordx4 v[56:59], v9, s[12:15], s40 offen sc1
    v_mfma_f32_16x16x32_bf16 a[196:199], v[100:103], v[64:67], a[196:199]
    v_mfma_f32_16x16x32_bf16 a[196:199], v[116:119], v[68:71], a[196:199]
    v_mfma_f32_16x16x32_bf16 a[200:203], v[104:107], v[64:67], a[200:203]
    v_mfma_f32_16x16x32_bf16 a[200:203], v[120:123], v[68:71], a[200:203]
    buffer_load_dwordx4 v[60:63], v9, s[12:15], s41 offen sc1
    v_mfma_f32_16x16x32_bf16 a[204:207], v[108:111], v[64:67], a[204:207]
    v_mfma_f32_16x16x32_bf16 a[204:207], v[124:127], v[68:71], a[204:207]
    s_waitcnt vmcnt(14)
    v_mfma_f32_16x16x32_bf16 a[208:211], v[96:99], v[72:75], a[208:211]
    v_mfma_f32_16x16x32_bf16 a[208:211], v[112:115], v[76:79], a[208:211]
    buffer_load_dwordx4 v[64:67], v10, s[12:15], s40 offen sc1
    v_mfma_f32_16x16x32_bf16 a[212:215], v[100:103], v[72:75], a[212:215]
    v_mfma_f32_16x16x32_bf16 a[212:215], v[116:119], v[76:79], a[212:215]
    v_mfma_f32_16x16x32_bf16 a[216:219], v[104:107], v[72:75], a[216:219]
    v_mfma_f32_16x16x32_bf16 a[216:219], v[120:123], v[76:79], a[216:219]
    buffer_load_dwordx4 v[68:71], v10, s[12:15], s41 offen sc1
    v_mfma_f32_16x16x32_bf16 a[220:223], v[108:111], v[72:75], a[220:223]
    v_mfma_f32_16x16x32_bf16 a[220:223], v[124:127], v[76:79], a[220:223]
    s_waitcnt vmcnt(14)
    v_mfma_f32_16x16x32_bf16 a[224:227], v[96:99], v[80:83], a[224:227]
    v_mfma_f32_16x16x32_bf16 a[224:227], v[112:115], v[84:87], a[224:227]
    s_add_u32 s43, s30, 8192
    buffer_load_dwordx4 v[72:75], v5, s[12:15], s43 offen sc1
    v_mfma_f32_16x16x32_bf16 a[228:231], v[100:103], v[80:83], a[228:231]
    v_mfma_f32_16x16x32_bf16 a[228:231], v[116:119], v[84:87], a[228:231]
    v_mfma_f32_16x16x32_bf16 a[232:235], v[104:107], v[80:83], a[232:235]
    v_mfma_f32_16x16x32_bf16 a[232:235], v[120:123], v[84:87], a[232:235]
    s_add_u32 s100, s31, 8192
    buffer_load_dwordx4 v[76:79], v5, s[12:15], s100 offen sc1
    v_mfma_f32_16x16x32_bf16 a[236:239], v[108:111], v[80:83], a[236:239]
    v_mfma_f32_16x16x32_bf16 a[236:239], v[124:127], v[84:87], a[236:239]
    s_waitcnt vmcnt(14)
    v_mfma_f32_16x16x32_bf16 a[240:243], v[96:99], v[88:91], a[240:243]
    v_mfma_f32_16x16x32_bf16 a[240:243], v[112:115], v[92:95], a[240:243]
    buffer_load_dwordx4 v[80:83], v6, s[12:15], s43 offen sc1
    v_mfma_f32_16x16x32_bf16 a[244:247], v[100:103], v[88:91], a[244:247]
    v_mfma_f32_16x16x32_bf16 a[244:247], v[116:119], v[92:95], a[244:247]
    v_mfma_f32_16x16x32_bf16 a[248:251], v[104:107], v[88:91], a[248:251]
    v_mfma_f32_16x16x32_bf16 a[248:251], v[120:123], v[92:95], a[248:251]
    buffer_load_dwordx4 v[84:87], v6, s[12:15], s100 offen sc1
    v_mfma_f32_16x16x32_bf16 a[252:255], v[108:111], v[88:91], a[252:255]
    v_mfma_f32_16x16x32_bf16 a[252:255], v[124:127], v[92:95], a[252:255]
    s_waitcnt vmcnt(14) lgkmcnt(0)
    v_mfma_f32_16x16x32_bf16 a[160:163], v[128:131], v[24:27], a[160:163]
    ds_read_b64_tr_b16 v[96:97], v13 offset:32768
    ds_read_b64_tr_b16 v[98:99], v13 offset:34816
    v_mfma_f32_16x16x32_bf16 a[160:163], v[144:147], v[28:31], a[160:163]
    buffer_load_dwordx4 v[88:91], v7, s[12:15], s43 offen sc1
    v_mfma_f32_16x16x32_bf16 a[164:167], v[132:135], v[24:27], a[164:167]
    ds_read_b64_tr_b16 v[100:101], v14 offset:32768
    ds_read_b64_tr_b16 v[102:103], v14 offset:34816
    v_mfma_f32_16x16x32_bf16 a[164:167], v[148:151], v[28:31], a[164:167]
    ds_read_b64_tr_b16 v[104:105], v13 offset:33280
    ds_read_b64_tr_b16 v[106:107], v13 offset:35328
    v_mfma_f32_16x16x32_bf16 a[168:171], v[136:139], v[24:27], a[168:171]
    ds_read_b64_tr_b16 v[108:109], v14 offset:33280
    ds_read_b64_tr_b16 v[110:111], v14 offset:35328
    v_mfma_f32_16x16x32_bf16 a[168:171], v[152:155], v[28:31], a[168:171]
    buffer_load_dwordx4 v[92:95], v7, s[12:15], s100 offen sc1
    v_mfma_f32_16x16x32_bf16 a[172:175], v[140:143], v[24:27], a[172:175]
    ds_read_b64_tr_b16 v[112:113], v13 offset:49152
    ds_read_b64_tr_b16 v[114:115], v13 offset:51200
    v_mfma_f32_16x16x32_bf16 a[172:175], v[156:159], v[28:31], a[172:175]
    s_waitcnt vmcnt(14)
    v_mfma_f32_16x16x32_bf16 a[176:179], v[128:131], v[32:35], a[176:179]
    ds_read_b64_tr_b16 v[116:117], v14 offset:49152
    ds_read_b64_tr_b16 v[118:119], v14 offset:51200
    v_mfma_f32_16x16x32_bf16 a[176:179], v[144:147], v[36:39], a[176:179]
    buffer_load_dwordx4 v[24:27], v8, s[12:15], s43 offen sc1
    v_mfma_f32_16x16x32_bf16 a[180:183], v[132:135], v[32:35], a[180:183]
    ds_read_b64_tr_b16 v[120:121], v13 offset:49664
    ds_read_b64_tr_b16 v[122:123], v13 offset:51712
    v_mfma_f32_16x16x32_bf16 a[180:183], v[148:151], v[36:39], a[180:183]
    ds_read_b64_tr_b16 v[124:125], v14 offset:49664
    ds_read_b64_tr_b16 v[126:127], v14 offset:51712
    v_mfma_f32_16x16x32_bf16 a[184:187], v[136:139], v[32:35], a[184:187]
    v_mfma_f32_16x16x32_bf16 a[184:187], v[152:155], v[36:39], a[184:187]
    buffer_load_dwordx4 v[28:31], v8, s[12:15], s100 offen sc1
    v_mfma_f32_16x16x32_bf16 a[188:191], v[140:143], v[32:35], a[188:191]
    v_mfma_f32_16x16x32_bf16 a[188:191], v[156:159], v[36:39], a[188:191]
    s_waitcnt vmcnt(14)
    v_mfma_f32_16x16x32_bf16 a[192:195], v[128:131], v[40:43], a[192:195]
    v_mfma_f32_16x16x32_bf16 a[192:195], v[144:147], v[44:47], a[192:195]
    buffer_load_dwordx4 v[32:35], v9, s[12:15], s43 offen sc1
    v_mfma_f32_16x16x32_bf16 a[196:199], v[132:135], v[40:43], a[196:199]
    v_mfma_f32_16x16x32_bf16 a[196:199], v[148:151], v[44:47], a[196:199]
    v_mfma_f32_16x16x32_bf16 a[200:203], v[136:139], v[40:43], a[200:203]
    v_mfma_f32_16x16x32_bf16 a[200:203], v[152:155], v[44:47], a[200:203]
    buffer_load_dwordx4 v[36:39], v9, s[12:15], s100 offen sc1
    v_mfma_f32_16x16x32_bf16 a[204:207], v[140:143], v[40:43], a[204:207]
    v_mfma_f32_16x16x32_bf16 a[204:207], v[156:159], v[44:47], a[204:207]
    s_waitcnt vmcnt(14)
    v_mfma_f32_16x16x32_bf16 a[208:211], v[128:131], v[48:51], a[208:211]
    v_mfma_f32_16x16x32_bf16 a[208:211], v[144:147], v[52:55], a[208:211]
    buffer_load_dwordx4 v[40:43], v10, s[12:15], s43 offen sc1
    v_mfma_f32_16x16x32_bf16 a[212:215], v[132:135], v[48:51], a[212:215]
    v_mfma_f32_16x16x32_bf16 a[212:215], v[148:151], v[52:55], a[212:215]
    v_mfma_f32_16x16x32_bf16 a[216:219], v[136:139], v[48:51], a[216:219]
    v_mfma_f32_16x16x32_bf16 a[216:219], v[152:155], v[52:55], a[216:219]
    buffer_load_dwordx4 v[44:47], v10, s[12:15], s100 offen sc1
    v_mfma_f32_16x16x32_bf16 a[220:223], v[140:143], v[48:51], a[220:223]
    v_mfma_f32_16x16x32_bf16 a[220:223], v[156:159], v[52:55], a[220:223]
    s_waitcnt vmcnt(14)
    v_mfma_f32_16x16x32_bf16 a[224:227], v[128:131], v[56:59], a[224:227]
    v_mfma_f32_16x16x32_bf16 a[224:227], v[144:147], v[60:63], a[224:227]
    s_add_u32 s4, s24, 16384
    buffer_load_dwordx4 v[48:51], v5, s[12:15], s4 offen sc1
    v_mfma_f32_16x16x32_bf16 a[228:231], v[132:135], v[56:59], a[228:231]
    v_mfma_f32_16x16x32_bf16 a[228:231], v[148:151], v[60:63], a[228:231]
    v_mfma_f32_16x16x32_bf16 a[232:235], v[136:139], v[56:59], a[232:235]
    v_mfma_f32_16x16x32_bf16 a[232:235], v[152:155], v[60:63], a[232:235]
    s_add_u32 s5, s25, 16384
    buffer_load_dwordx4 v[52:55], v5, s[12:15], s5 offen sc1
    v_mfma_f32_16x16x32_bf16 a[236:239], v[140:143], v[56:59], a[236:239]
    v_mfma_f32_16x16x32_bf16 a[236:239], v[156:159], v[60:63], a[236:239]
    s_waitcnt vmcnt(14)
    v_mfma_f32_16x16x32_bf16 a[240:243], v[128:131], v[64:67], a[240:243]
    v_mfma_f32_16x16x32_bf16 a[240:243], v[144:147], v[68:71], a[240:243]
    buffer_load_dwordx4 v[56:59], v6, s[12:15], s4 offen sc1
    v_mfma_f32_16x16x32_bf16 a[244:247], v[132:135], v[64:67], a[244:247]
    v_mfma_f32_16x16x32_bf16 a[244:247], v[148:151], v[68:71], a[244:247]
    v_mfma_f32_16x16x32_bf16 a[248:251], v[136:139], v[64:67], a[248:251]
    v_mfma_f32_16x16x32_bf16 a[248:251], v[152:155], v[68:71], a[248:251]
    buffer_load_dwordx4 v[60:63], v6, s[12:15], s5 offen sc1
    v_mfma_f32_16x16x32_bf16 a[252:255], v[140:143], v[64:67], a[252:255]
    v_mfma_f32_16x16x32_bf16 a[252:255], v[156:159], v[68:71], a[252:255]
    s_waitcnt vmcnt(14) lgkmcnt(0)
    v_mfma_f32_16x16x32_bf16 a[160:163], v[160:163], v[72:75], a[160:163]
    v_mfma_f32_16x16x32_bf16 a[160:163], v[176:179], v[76:79], a[160:163]
    buffer_load_dwordx4 v[64:67], v7, s[12:15], s4 offen sc1
    v_mfma_f32_16x16x32_bf16 a[164:167], v[164:167], v[72:75], a[164:167]
    v_mfma_f32_16x16x32_bf16 a[164:167], v[180:183], v[76:79], a[164:167]
    v_mfma_f32_16x16x32_bf16 a[168:171], v[168:171], v[72:75], a[168:171]
    v_mfma_f32_16x16x32_bf16 a[168:171], v[184:187], v[76:79], a[168:171]
    buffer_load_dwordx4 v[68:71], v7, s[12:15], s5 offen sc1
    v_mfma_f32_16x16x32_bf16 a[172:175], v[172:175], v[72:75], a[172:175]
    v_mfma_f32_16x16x32_bf16 a[172:175], v[188:191], v[76:79], a[172:175]
    s_waitcnt vmcnt(14)
    v_mfma_f32_16x16x32_bf16 a[176:179], v[160:163], v[80:83], a[176:179]
    v_mfma_f32_16x16x32_bf16 a[176:179], v[176:179], v[84:87], a[176:179]
    buffer_load_dwordx4 v[72:75], v8, s[12:15], s4 offen sc1
    v_mfma_f32_16x16x32_bf16 a[180:183], v[164:167], v[80:83], a[180:183]
    v_mfma_f32_16x16x32_bf16 a[180:183], v[180:183], v[84:87], a[180:183]
    v_mfma_f32_16x16x32_bf16 a[184:187], v[168:171], v[80:83], a[184:187]
    v_mfma_f32_16x16x32_bf16 a[184:187], v[184:187], v[84:87], a[184:187]
    buffer_load_dwordx4 v[76:79], v8, s[12:15], s5 offen sc1
    v_mfma_f32_16x16x32_bf16 a[188:191], v[172:175], v[80:83], a[188:191]
    v_mfma_f32_16x16x32_bf16 a[188:191], v[188:191], v[84:87], a[188:191]
    s_waitcnt vmcnt(14)
    v_mfma_f32_16x16x32_bf16 a[192:195], v[160:163], v[88:91], a[192:195]
    v_mfma_f32_16x16x32_bf16 a[192:195], v[176:179], v[92:95], a[192:195]
    buffer_load_dwordx4 v[80:83], v9, s[12:15], s4 offen sc1
    v_mfma_f32_16x16x32_bf16 a[196:199], v[164:167], v[88:91], a[196:199]
    v_mfma_f32_16x16x32_bf16 a[196:199], v[180:183], v[92:95], a[196:199]
    v_mfma_f32_16x16x32_bf16 a[200:203], v[168:171], v[88:91], a[200:203]
    v_mfma_f32_16x16x32_bf16 a[200:203], v[184:187], v[92:95], a[200:203]
    buffer_load_dwordx4 v[84:87], v9, s[12:15], s5 offen sc1
    v_mfma_f32_16x16x32_bf16 a[204:207], v[172:175], v[88:91], a[204:207]
    v_mfma_f32_16x16x32_bf16 a[204:207], v[188:191], v[92:95], a[204:207]
    s_waitcnt vmcnt(14)
    v_mfma_f32_16x16x32_bf16 a[208:211], v[160:163], v[24:27], a[208:211]
    v_mfma_f32_16x16x32_bf16 a[208:211], v[176:179], v[28:31], a[208:211]
    buffer_load_dwordx4 v[88:91], v10, s[12:15], s4 offen sc1
    v_mfma_f32_16x16x32_bf16 a[212:215], v[164:167], v[24:27], a[212:215]
    v_mfma_f32_16x16x32_bf16 a[212:215], v[180:183], v[28:31], a[212:215]
    v_mfma_f32_16x16x32_bf16 a[216:219], v[168:171], v[24:27], a[216:219]
    v_mfma_f32_16x16x32_bf16 a[216:219], v[184:187], v[28:31], a[216:219]
    buffer_load_dwordx4 v[92:95], v10, s[12:15], s5 offen sc1
    v_mfma_f32_16x16x32_bf16 a[220:223], v[172:175], v[24:27], a[220:223]
    v_mfma_f32_16x16x32_bf16 a[220:223], v[188:191], v[28:31], a[220:223]
    s_waitcnt vmcnt(14)
    v_mfma_f32_16x16x32_bf16 a[224:227], v[160:163], v[32:35], a[224:227]
    v_mfma_f32_16x16x32_bf16 a[224:227], v[176:179], v[36:39], a[224:227]
    s_add_u32 s6, s26, 16384
    buffer_load_dwordx4 v[24:27], v5, s[12:15], s6 offen sc1
    v_mfma_f32_16x16x32_bf16 a[228:231], v[164:167], v[32:35], a[228:231]
    v_mfma_f32_16x16x32_bf16 a[228:231], v[180:183], v[36:39], a[228:231]
    v_mfma_f32_16x16x32_bf16 a[232:235], v[168:171], v[32:35], a[232:235]
    v_mfma_f32_16x16x32_bf16 a[232:235], v[184:187], v[36:39], a[232:235]
    s_add_u32 s7, s27, 16384
    buffer_load_dwordx4 v[28:31], v5, s[12:15], s7 offen sc1
    v_mfma_f32_16x16x32_bf16 a[236:239], v[172:175], v[32:35], a[236:239]
    v_mfma_f32_16x16x32_bf16 a[236:239], v[188:191], v[36:39], a[236:239]
    s_waitcnt vmcnt(14)
    v_mfma_f32_16x16x32_bf16 a[240:243], v[160:163], v[40:43], a[240:243]
    v_mfma_f32_16x16x32_bf16 a[240:243], v[176:179], v[44:47], a[240:243]
    buffer_load_dwordx4 v[32:35], v6, s[12:15], s6 offen sc1
    v_mfma_f32_16x16x32_bf16 a[244:247], v[164:167], v[40:43], a[244:247]
    v_mfma_f32_16x16x32_bf16 a[244:247], v[180:183], v[44:47], a[244:247]
    v_mfma_f32_16x16x32_bf16 a[248:251], v[168:171], v[40:43], a[248:251]
    v_mfma_f32_16x16x32_bf16 a[248:251], v[184:187], v[44:47], a[248:251]
    buffer_load_dwordx4 v[36:39], v6, s[12:15], s7 offen sc1
    v_mfma_f32_16x16x32_bf16 a[252:255], v[172:175], v[40:43], a[252:255]
    v_mfma_f32_16x16x32_bf16 a[252:255], v[188:191], v[44:47], a[252:255]
    s_waitcnt vmcnt(14) lgkmcnt(0)
    v_mfma_f32_16x16x32_bf16 a[160:163], v[192:195], v[48:51], a[160:163]
    v_mfma_f32_16x16x32_bf16 a[160:163], v[208:211], v[52:55], a[160:163]
    buffer_load_dwordx4 v[40:43], v7, s[12:15], s6 offen sc1
    v_mfma_f32_16x16x32_bf16 a[164:167], v[196:199], v[48:51], a[164:167]
    v_mfma_f32_16x16x32_bf16 a[164:167], v[212:215], v[52:55], a[164:167]
    v_mfma_f32_16x16x32_bf16 a[168:171], v[200:203], v[48:51], a[168:171]
    v_mfma_f32_16x16x32_bf16 a[168:171], v[216:219], v[52:55], a[168:171]
    buffer_load_dwordx4 v[44:47], v7, s[12:15], s7 offen sc1
    v_mfma_f32_16x16x32_bf16 a[172:175], v[204:207], v[48:51], a[172:175]
    v_mfma_f32_16x16x32_bf16 a[172:175], v[220:223], v[52:55], a[172:175]
    s_waitcnt vmcnt(14)
    v_mfma_f32_16x16x32_bf16 a[176:179], v[192:195], v[56:59], a[176:179]
    v_mfma_f32_16x16x32_bf16 a[176:179], v[208:211], v[60:63], a[176:179]
    buffer_load_dwordx4 v[48:51], v8, s[12:15], s6 offen sc1
    v_mfma_f32_16x16x32_bf16 a[180:183], v[196:199], v[56:59], a[180:183]
    v_mfma_f32_16x16x32_bf16 a[180:183], v[212:215], v[60:63], a[180:183]
    v_mfma_f32_16x16x32_bf16 a[184:187], v[200:203], v[56:59], a[184:187]
    v_mfma_f32_16x16x32_bf16 a[184:187], v[216:219], v[60:63], a[184:187]
    buffer_load_dwordx4 v[52:55], v8, s[12:15], s7 offen sc1
    v_mfma_f32_16x16x32_bf16 a[188:191], v[204:207], v[56:59], a[188:191]
    v_mfma_f32_16x16x32_bf16 a[188:191], v[220:223], v[60:63], a[188:191]
    s_waitcnt vmcnt(14)
    v_mfma_f32_16x16x32_bf16 a[192:195], v[192:195], v[64:67], a[192:195]
    v_mfma_f32_16x16x32_bf16 a[192:195], v[208:211], v[68:71], a[192:195]
    buffer_load_dwordx4 v[56:59], v9, s[12:15], s6 offen sc1
    v_mfma_f32_16x16x32_bf16 a[196:199], v[196:199], v[64:67], a[196:199]
    v_mfma_f32_16x16x32_bf16 a[196:199], v[212:215], v[68:71], a[196:199]
    v_mfma_f32_16x16x32_bf16 a[200:203], v[200:203], v[64:67], a[200:203]
    v_mfma_f32_16x16x32_bf16 a[200:203], v[216:219], v[68:71], a[200:203]
    buffer_load_dwordx4 v[60:63], v9, s[12:15], s7 offen sc1
    v_mfma_f32_16x16x32_bf16 a[204:207], v[204:207], v[64:67], a[204:207]
    v_mfma_f32_16x16x32_bf16 a[204:207], v[220:223], v[68:71], a[204:207]
    s_waitcnt vmcnt(14)
    v_mfma_f32_16x16x32_bf16 a[208:211], v[192:195], v[72:75], a[208:211]
    v_mfma_f32_16x16x32_bf16 a[208:211], v[208:211], v[76:79], a[208:211]
    buffer_load_dwordx4 v[64:67], v10, s[12:15], s6 offen sc1
    v_mfma_f32_16x16x32_bf16 a[212:215], v[196:199], v[72:75], a[212:215]
    v_mfma_f32_16x16x32_bf16 a[212:215], v[212:215], v[76:79], a[212:215]
    v_mfma_f32_16x16x32_bf16 a[216:219], v[200:203], v[72:75], a[216:219]
    v_mfma_f32_16x16x32_bf16 a[216:219], v[216:219], v[76:79], a[216:219]
    buffer_load_dwordx4 v[68:71], v10, s[12:15], s7 offen sc1
    v_mfma_f32_16x16x32_bf16 a[220:223], v[204:207], v[72:75], a[220:223]
    v_mfma_f32_16x16x32_bf16 a[220:223], v[220:223], v[76:79], a[220:223]
    s_waitcnt vmcnt(14)
    v_mfma_f32_16x16x32_bf16 a[224:227], v[192:195], v[80:83], a[224:227]
    v_mfma_f32_16x16x32_bf16 a[224:227], v[208:211], v[84:87], a[224:227]
    s_add_u32 s40, s28, 16384
    buffer_load_dwordx4 v[72:75], v5, s[12:15], s40 offen sc1
    v_mfma_f32_16x16x32_bf16 a[228:231], v[196:199], v[80:83], a[228:231]
    v_mfma_f32_16x16x32_bf16 a[228:231], v[212:215], v[84:87], a[228:231]
    v_mfma_f32_16x16x32_bf16 a[232:235], v[200:203], v[80:83], a[232:235]
    v_mfma_f32_16x16x32_bf16 a[232:235], v[216:219], v[84:87], a[232:235]
    s_add_u32 s41, s29, 16384
    buffer_load_dwordx4 v[76:79], v5, s[12:15], s41 offen sc1
    v_mfma_f32_16x16x32_bf16 a[236:239], v[204:207], v[80:83], a[236:239]
    v_mfma_f32_16x16x32_bf16 a[236:239], v[220:223], v[84:87], a[236:239]
    s_waitcnt vmcnt(14)
    v_mfma_f32_16x16x32_bf16 a[240:243], v[192:195], v[88:91], a[240:243]
    v_mfma_f32_16x16x32_bf16 a[240:243], v[208:211], v[92:95], a[240:243]
    buffer_load_dwordx4 v[80:83], v6, s[12:15], s40 offen sc1
    v_mfma_f32_16x16x32_bf16 a[244:247], v[196:199], v[88:91], a[244:247]
    v_mfma_f32_16x16x32_bf16 a[244:247], v[212:215], v[92:95], a[244:247]
    v_mfma_f32_16x16x32_bf16 a[248:251], v[200:203], v[88:91], a[248:251]
    v_mfma_f32_16x16x32_bf16 a[248:251], v[216:219], v[92:95], a[248:251]
    buffer_load_dwordx4 v[84:87], v6, s[12:15], s41 offen sc1
    v_mfma_f32_16x16x32_bf16 a[252:255], v[204:207], v[88:91], a[252:255]
    v_mfma_f32_16x16x32_bf16 a[252:255], v[220:223], v[92:95], a[252:255]
    s_waitcnt vmcnt(14) lgkmcnt(0)
    v_mfma_f32_16x16x32_bf16 a[160:163], a[0:3], v[24:27], a[160:163]
    v_mfma_f32_16x16x32_bf16 a[160:163], a[16:19], v[28:31], a[160:163]
    buffer_load_dwordx4 v[88:91], v7, s[12:15], s40 offen sc1
    v_mfma_f32_16x16x32_bf16 a[164:167], a[4:7], v[24:27], a[164:167]
    v_mfma_f32_16x16x32_bf16 a[164:167], a[20:23], v[28:31], a[164:167]
    v_mfma_f32_16x16x32_bf16 a[168:171], a[8:11], v[24:27], a[168:171]
    v_mfma_f32_16x16x32_bf16 a[168:171], a[24:27], v[28:31], a[168:171]
    buffer_load_dwordx4 v[92:95], v7, s[12:15], s41 offen sc1
    v_mfma_f32_16x16x32_bf16 a[172:175], a[12:15], v[24:27], a[172:175]
    v_mfma_f32_16x16x32_bf16 a[172:175], a[28:31], v[28:31], a[172:175]
    s_waitcnt vmcnt(14)
    v_mfma_f32_16x16x32_bf16 a[176:179], a[0:3], v[32:35], a[176:179]
    v_mfma_f32_16x16x32_bf16 a[176:179], a[16:19], v[36:39], a[176:179]
    buffer_load_dwordx4 v[24:27], v8, s[12:15], s40 offen sc1
    v_mfma_f32_16x16x32_bf16 a[180:183], a[4:7], v[32:35], a[180:183]
    v_mfma_f32_16x16x32_bf16 a[180:183], a[20:23], v[36:39], a[180:183]
    v_mfma_f32_16x16x32_bf16 a[184:187], a[8:11], v[32:35], a[184:187]
    v_mfma_f32_16x16x32_bf16 a[184:187], a[24:27], v[36:39], a[184:187]
    buffer_load_dwordx4 v[28:31], v8, s[12:15], s41 offen sc1
    v_mfma_f32_16x16x32_bf16 a[188:191], a[12:15], v[32:35], a[188:191]
    v_mfma_f32_16x16x32_bf16 a[188:191], a[28:31], v[36:39], a[188:191]
    s_waitcnt vmcnt(14)
    v_mfma_f32_16x16x32_bf16 a[192:195], a[0:3], v[40:43], a[192:195]
    v_mfma_f32_16x16x32_bf16 a[192:195], a[16:19], v[44:47], a[192:195]
    buffer_load_dwordx4 v[32:35], v9, s[12:15], s40 offen sc1
    v_mfma_f32_16x16x32_bf16 a[196:199], a[4:7], v[40:43], a[196:199]
    v_mfma_f32_16x16x32_bf16 a[196:199], a[20:23], v[44:47], a[196:199]
    v_mfma_f32_16x16x32_bf16 a[200:203], a[8:11], v[40:43], a[200:203]
    v_mfma_f32_16x16x32_bf16 a[200:203], a[24:27], v[44:47], a[200:203]
    buffer_load_dwordx4 v[36:39], v9, s[12:15], s41 offen sc1
    v_mfma_f32_16x16x32_bf16 a[204:207], a[12:15], v[40:43], a[204:207]
    v_mfma_f32_16x16x32_bf16 a[204:207], a[28:31], v[44:47], a[204:207]
    s_waitcnt vmcnt(14)
    v_mfma_f32_16x16x32_bf16 a[208:211], a[0:3], v[48:51], a[208:211]
    v_mfma_f32_16x16x32_bf16 a[208:211], a[16:19], v[52:55], a[208:211]
    buffer_load_dwordx4 v[40:43], v10, s[12:15], s40 offen sc1
    v_mfma_f32_16x16x32_bf16 a[212:215], a[4:7], v[48:51], a[212:215]
    v_mfma_f32_16x16x32_bf16 a[212:215], a[20:23], v[52:55], a[212:215]
    v_mfma_f32_16x16x32_bf16 a[216:219], a[8:11], v[48:51], a[216:219]
    v_mfma_f32_16x16x32_bf16 a[216:219], a[24:27], v[52:55], a[216:219]
    buffer_load_dwordx4 v[44:47], v10, s[12:15], s41 offen sc1
    v_mfma_f32_16x16x32_bf16 a[220:223], a[12:15], v[48:51], a[220:223]
    v_mfma_f32_16x16x32_bf16 a[220:223], a[28:31], v[52:55], a[220:223]
    s_waitcnt vmcnt(14)
    v_mfma_f32_16x16x32_bf16 a[224:227], a[0:3], v[56:59], a[224:227]
    v_mfma_f32_16x16x32_bf16 a[224:227], a[16:19], v[60:63], a[224:227]
    s_add_u32 s43, s30, 16384
    buffer_load_dwordx4 v[48:51], v5, s[12:15], s43 offen sc1
    v_mfma_f32_16x16x32_bf16 a[228:231], a[4:7], v[56:59], a[228:231]
    v_mfma_f32_16x16x32_bf16 a[228:231], a[20:23], v[60:63], a[228:231]
    v_mfma_f32_16x16x32_bf16 a[232:235], a[8:11], v[56:59], a[232:235]
    v_mfma_f32_16x16x32_bf16 a[232:235], a[24:27], v[60:63], a[232:235]
    s_add_u32 s100, s31, 16384
    buffer_load_dwordx4 v[52:55], v5, s[12:15], s100 offen sc1
    v_mfma_f32_16x16x32_bf16 a[236:239], a[12:15], v[56:59], a[236:239]
    v_mfma_f32_16x16x32_bf16 a[236:239], a[28:31], v[60:63], a[236:239]
    s_waitcnt vmcnt(14)
    v_mfma_f32_16x16x32_bf16 a[240:243], a[0:3], v[64:67], a[240:243]
    v_mfma_f32_16x16x32_bf16 a[240:243], a[16:19], v[68:71], a[240:243]
    buffer_load_dwordx4 v[56:59], v6, s[12:15], s43 offen sc1
    v_mfma_f32_16x16x32_bf16 a[244:247], a[4:7], v[64:67], a[244:247]
    v_mfma_f32_16x16x32_bf16 a[244:247], a[20:23], v[68:71], a[244:247]
    v_mfma_f32_16x16x32_bf16 a[248:251], a[8:11], v[64:67], a[248:251]
    v_mfma_f32_16x16x32_bf16 a[248:251], a[24:27], v[68:71], a[248:251]
    buffer_load_dwordx4 v[60:63], v6, s[12:15], s100 offen sc1
    v_mfma_f32_16x16x32_bf16 a[252:255], a[12:15], v[64:67], a[252:255]
    v_mfma_f32_16x16x32_bf16 a[252:255], a[28:31], v[68:71], a[252:255]
    s_waitcnt vmcnt(14) lgkmcnt(0)
    v_mfma_f32_16x16x32_bf16 a[160:163], v[224:227], v[72:75], a[160:163]
    v_mfma_f32_16x16x32_bf16 a[160:163], v[240:243], v[76:79], a[160:163]
    buffer_load_dwordx4 v[64:67], v7, s[12:15], s43 offen sc1
    v_mfma_f32_16x16x32_bf16 a[164:167], v[228:231], v[72:75], a[164:167]
    v_mfma_f32_16x16x32_bf16 a[164:167], v[244:247], v[76:79], a[164:167]
    v_mfma_f32_16x16x32_bf16 a[168:171], v[232:235], v[72:75], a[168:171]
    v_mfma_f32_16x16x32_bf16 a[168:171], v[248:251], v[76:79], a[168:171]
    buffer_load_dwordx4 v[68:71], v7, s[12:15], s100 offen sc1
    v_mfma_f32_16x16x32_bf16 a[172:175], v[236:239], v[72:75], a[172:175]
    v_mfma_f32_16x16x32_bf16 a[172:175], v[252:255], v[76:79], a[172:175]
    s_waitcnt vmcnt(14)
    v_mfma_f32_16x16x32_bf16 a[176:179], v[224:227], v[80:83], a[176:179]
    v_mfma_f32_16x16x32_bf16 a[176:179], v[240:243], v[84:87], a[176:179]
    buffer_load_dwordx4 v[72:75], v8, s[12:15], s43 offen sc1
    v_mfma_f32_16x16x32_bf16 a[180:183], v[228:231], v[80:83], a[180:183]
    v_mfma_f32_16x16x32_bf16 a[180:183], v[244:247], v[84:87], a[180:183]
    v_mfma_f32_16x16x32_bf16 a[184:187], v[232:235], v[80:83], a[184:187]
    v_mfma_f32_16x16x32_bf16 a[184:187], v[248:251], v[84:87], a[184:187]
    buffer_load_dwordx4 v[76:79], v8, s[12:15], s100 offen sc1
    v_mfma_f32_16x16x32_bf16 a[188:191], v[236:239], v[80:83], a[188:191]
    v_mfma_f32_16x16x32_bf16 a[188:191], v[252:255], v[84:87], a[188:191]
    s_waitcnt vmcnt(14)
    v_mfma_f32_16x16x32_bf16 a[192:195], v[224:227], v[88:91], a[192:195]
    v_mfma_f32_16x16x32_bf16 a[192:195], v[240:243], v[92:95], a[192:195]
    buffer_load_dwordx4 v[80:83], v9, s[12:15], s43 offen sc1
    v_mfma_f32_16x16x32_bf16 a[196:199], v[228:231], v[88:91], a[196:199]
    v_mfma_f32_16x16x32_bf16 a[196:199], v[244:247], v[92:95], a[196:199]
    v_mfma_f32_16x16x32_bf16 a[200:203], v[232:235], v[88:91], a[200:203]
    v_mfma_f32_16x16x32_bf16 a[200:203], v[248:251], v[92:95], a[200:203]
    buffer_load_dwordx4 v[84:87], v9, s[12:15], s100 offen sc1
    v_mfma_f32_16x16x32_bf16 a[204:207], v[236:239], v[88:91], a[204:207]
    v_mfma_f32_16x16x32_bf16 a[204:207], v[252:255], v[92:95], a[204:207]
    s_waitcnt vmcnt(14)
    v_mfma_f32_16x16x32_bf16 a[208:211], v[224:227], v[24:27], a[208:211]
    v_mfma_f32_16x16x32_bf16 a[208:211], v[240:243], v[28:31], a[208:211]
    buffer_load_dwordx4 v[88:91], v10, s[12:15], s43 offen sc1
    v_mfma_f32_16x16x32_bf16 a[212:215], v[228:231], v[24:27], a[212:215]
    v_mfma_f32_16x16x32_bf16 a[212:215], v[244:247], v[28:31], a[212:215]
    v_mfma_f32_16x16x32_bf16 a[216:219], v[232:235], v[24:27], a[216:219]
    v_mfma_f32_16x16x32_bf16 a[216:219], v[248:251], v[28:31], a[216:219]
    buffer_load_dwordx4 v[92:95], v10, s[12:15], s100 offen sc1
    v_mfma_f32_16x16x32_bf16 a[220:223], v[236:239], v[24:27], a[220:223]
    v_mfma_f32_16x16x32_bf16 a[220:223], v[252:255], v[28:31], a[220:223]
    s_waitcnt vmcnt(14)
    v_mfma_f32_16x16x32_bf16 a[224:227], v[224:227], v[32:35], a[224:227]
    v_mfma_f32_16x16x32_bf16 a[224:227], v[240:243], v[36:39], a[224:227]
    s_add_u32 s4, s24, 24576
    buffer_load_dwordx4 v[24:27], v5, s[12:15], s4 offen sc1
    v_mfma_f32_16x16x32_bf16 a[228:231], v[228:231], v[32:35], a[228:231]
    v_mfma_f32_16x16x32_bf16 a[228:231], v[244:247], v[36:39], a[228:231]
    v_mfma_f32_16x16x32_bf16 a[232:235], v[232:235], v[32:35], a[232:235]
    v_mfma_f32_16x16x32_bf16 a[232:235], v[248:251], v[36:39], a[232:235]
    s_add_u32 s5, s25, 24576
    buffer_load_dwordx4 v[28:31], v5, s[12:15], s5 offen sc1
    v_mfma_f32_16x16x32_bf16 a[236:239], v[236:239], v[32:35], a[236:239]
    v_mfma_f32_16x16x32_bf16 a[236:239], v[252:255], v[36:39], a[236:239]
    s_waitcnt vmcnt(14)
    v_mfma_f32_16x16x32_bf16 a[240:243], v[224:227], v[40:43], a[240:243]
    v_mfma_f32_16x16x32_bf16 a[240:243], v[240:243], v[44:47], a[240:243]
    buffer_load_dwordx4 v[32:35], v6, s[12:15], s4 offen sc1
    v_mfma_f32_16x16x32_bf16 a[244:247], v[228:231], v[40:43], a[244:247]
    v_mfma_f32_16x16x32_bf16 a[244:247], v[244:247], v[44:47], a[244:247]
    v_mfma_f32_16x16x32_bf16 a[248:251], v[232:235], v[40:43], a[248:251]
    v_mfma_f32_16x16x32_bf16 a[248:251], v[248:251], v[44:47], a[248:251]
    buffer_load_dwordx4 v[36:39], v6, s[12:15], s5 offen sc1
    v_mfma_f32_16x16x32_bf16 a[252:255], v[236:239], v[40:43], a[252:255]
    v_mfma_f32_16x16x32_bf16 a[252:255], v[252:255], v[44:47], a[252:255]
    s_waitcnt vmcnt(14) lgkmcnt(0)
    v_mfma_f32_16x16x32_bf16 a[160:163], a[32:35], v[48:51], a[160:163]
    v_mfma_f32_16x16x32_bf16 a[160:163], a[48:51], v[52:55], a[160:163]
    buffer_load_dwordx4 v[40:43], v7, s[12:15], s4 offen sc1
    v_mfma_f32_16x16x32_bf16 a[164:167], a[36:39], v[48:51], a[164:167]
    v_mfma_f32_16x16x32_bf16 a[164:167], a[52:55], v[52:55], a[164:167]
    v_mfma_f32_16x16x32_bf16 a[168:171], a[40:43], v[48:51], a[168:171]
    v_mfma_f32_16x16x32_bf16 a[168:171], a[56:59], v[52:55], a[168:171]
    buffer_load_dwordx4 v[44:47], v7, s[12:15], s5 offen sc1
    v_mfma_f32_16x16x32_bf16 a[172:175], a[44:47], v[48:51], a[172:175]
    v_mfma_f32_16x16x32_bf16 a[172:175], a[60:63], v[52:55], a[172:175]
    s_waitcnt vmcnt(14)
    v_mfma_f32_16x16x32_bf16 a[176:179], a[32:35], v[56:59], a[176:179]
    v_mfma_f32_16x16x32_bf16 a[176:179], a[48:51], v[60:63], a[176:179]
    buffer_load_dwordx4 v[48:51], v8, s[12:15], s4 offen sc1
    v_mfma_f32_16x16x32_bf16 a[180:183], a[36:39], v[56:59], a[180:183]
    v_mfma_f32_16x16x32_bf16 a[180:183], a[52:55], v[60:63], a[180:183]
    v_mfma_f32_16x16x32_bf16 a[184:187], a[40:43], v[56:59], a[184:187]
    v_mfma_f32_16x16x32_bf16 a[184:187], a[56:59], v[60:63], a[184:187]
    buffer_load_dwordx4 v[52:55], v8, s[12:15], s5 offen sc1
    v_mfma_f32_16x16x32_bf16 a[188:191], a[44:47], v[56:59], a[188:191]
    v_mfma_f32_16x16x32_bf16 a[188:191], a[60:63], v[60:63], a[188:191]
    s_waitcnt vmcnt(14)
    v_mfma_f32_16x16x32_bf16 a[192:195], a[32:35], v[64:67], a[192:195]
    v_mfma_f32_16x16x32_bf16 a[192:195], a[48:51], v[68:71], a[192:195]
    buffer_load_dwordx4 v[56:59], v9, s[12:15], s4 offen sc1
    v_mfma_f32_16x16x32_bf16 a[196:199], a[36:39], v[64:67], a[196:199]
    v_mfma_f32_16x16x32_bf16 a[196:199], a[52:55], v[68:71], a[196:199]
    v_mfma_f32_16x16x32_bf16 a[200:203], a[40:43], v[64:67], a[200:203]
    v_mfma_f32_16x16x32_bf16 a[200:203], a[56:59], v[68:71], a[200:203]
    buffer_load_dwordx4 v[60:63], v9, s[12:15], s5 offen sc1
    v_mfma_f32_16x16x32_bf16 a[204:207], a[44:47], v[64:67], a[204:207]
    v_mfma_f32_16x16x32_bf16 a[204:207], a[60:63], v[68:71], a[204:207]
    s_waitcnt vmcnt(14)
    v_mfma_f32_16x16x32_bf16 a[208:211], a[32:35], v[72:75], a[208:211]
    v_mfma_f32_16x16x32_bf16 a[208:211], a[48:51], v[76:79], a[208:211]
    buffer_load_dwordx4 v[64:67], v10, s[12:15], s4 offen sc1
    v_mfma_f32_16x16x32_bf16 a[212:215], a[36:39], v[72:75], a[212:215]
    v_mfma_f32_16x16x32_bf16 a[212:215], a[52:55], v[76:79], a[212:215]
    v_mfma_f32_16x16x32_bf16 a[216:219], a[40:43], v[72:75], a[216:219]
    v_mfma_f32_16x16x32_bf16 a[216:219], a[56:59], v[76:79], a[216:219]
    buffer_load_dwordx4 v[68:71], v10, s[12:15], s5 offen sc1
    v_mfma_f32_16x16x32_bf16 a[220:223], a[44:47], v[72:75], a[220:223]
    v_mfma_f32_16x16x32_bf16 a[220:223], a[60:63], v[76:79], a[220:223]
    s_waitcnt vmcnt(14)
    v_mfma_f32_16x16x32_bf16 a[224:227], a[32:35], v[80:83], a[224:227]
    v_mfma_f32_16x16x32_bf16 a[224:227], a[48:51], v[84:87], a[224:227]
    s_add_u32 s6, s26, 24576
    buffer_load_dwordx4 v[72:75], v5, s[12:15], s6 offen sc1
    v_mfma_f32_16x16x32_bf16 a[228:231], a[36:39], v[80:83], a[228:231]
    v_mfma_f32_16x16x32_bf16 a[228:231], a[52:55], v[84:87], a[228:231]
    v_mfma_f32_16x16x32_bf16 a[232:235], a[40:43], v[80:83], a[232:235]
    v_mfma_f32_16x16x32_bf16 a[232:235], a[56:59], v[84:87], a[232:235]
    s_add_u32 s7, s27, 24576
    buffer_load_dwordx4 v[76:79], v5, s[12:15], s7 offen sc1
    v_mfma_f32_16x16x32_bf16 a[236:239], a[44:47], v[80:83], a[236:239]
    v_mfma_f32_16x16x32_bf16 a[236:239], a[60:63], v[84:87], a[236:239]
    s_waitcnt vmcnt(14)
    v_mfma_f32_16x16x32_bf16 a[240:243], a[32:35], v[88:91], a[240:243]
    v_mfma_f32_16x16x32_bf16 a[240:243], a[48:51], v[92:95], a[240:243]
    buffer_load_dwordx4 v[80:83], v6, s[12:15], s6 offen sc1
    v_mfma_f32_16x16x32_bf16 a[244:247], a[36:39], v[88:91], a[244:247]
    v_mfma_f32_16x16x32_bf16 a[244:247], a[52:55], v[92:95], a[244:247]
    v_mfma_f32_16x16x32_bf16 a[248:251], a[40:43], v[88:91], a[248:251]
    v_mfma_f32_16x16x32_bf16 a[248:251], a[56:59], v[92:95], a[248:251]
    buffer_load_dwordx4 v[84:87], v6, s[12:15], s7 offen sc1
    v_mfma_f32_16x16x32_bf16 a[252:255], a[44:47], v[88:91], a[252:255]
    v_mfma_f32_16x16x32_bf16 a[252:255], a[60:63], v[92:95], a[252:255]
    s_waitcnt vmcnt(14) lgkmcnt(0)
    v_mfma_f32_16x16x32_bf16 a[160:163], a[64:67], v[24:27], a[160:163]
    v_mfma_f32_16x16x32_bf16 a[160:163], a[80:83], v[28:31], a[160:163]
    buffer_load_dwordx4 v[88:91], v7, s[12:15], s6 offen sc1
    v_mfma_f32_16x16x32_bf16 a[164:167], a[68:71], v[24:27], a[164:167]
    v_mfma_f32_16x16x32_bf16 a[164:167], a[84:87], v[28:31], a[164:167]
    v_mfma_f32_16x16x32_bf16 a[168:171], a[72:75], v[24:27], a[168:171]
    v_mfma_f32_16x16x32_bf16 a[168:171], a[88:91], v[28:31], a[168:171]
    buffer_load_dwordx4 v[92:95], v7, s[12:15], s7 offen sc1
    v_mfma_f32_16x16x32_bf16 a[172:175], a[76:79], v[24:27], a[172:175]
    v_mfma_f32_16x16x32_bf16 a[172:175], a[92:95], v[28:31], a[172:175]
    s_waitcnt vmcnt(14)
    v_mfma_f32_16x16x32_bf16 a[176:179], a[64:67], v[32:35], a[176:179]
    v_mfma_f32_16x16x32_bf16 a[176:179], a[80:83], v[36:39], a[176:179]
    buffer_load_dwordx4 v[24:27], v8, s[12:15], s6 offen sc1
    v_mfma_f32_16x16x32_bf16 a[180:183], a[68:71], v[32:35], a[180:183]
    v_mfma_f32_16x16x32_bf16 a[180:183], a[84:87], v[36:39], a[180:183]
    v_mfma_f32_16x16x32_bf16 a[184:187], a[72:75], v[32:35], a[184:187]
    v_mfma_f32_16x16x32_bf16 a[184:187], a[88:91], v[36:39], a[184:187]
    buffer_load_dwordx4 v[28:31], v8, s[12:15], s7 offen sc1
    v_mfma_f32_16x16x32_bf16 a[188:191], a[76:79], v[32:35], a[188:191]
    v_mfma_f32_16x16x32_bf16 a[188:191], a[92:95], v[36:39], a[188:191]
    s_waitcnt vmcnt(14)
    v_mfma_f32_16x16x32_bf16 a[192:195], a[64:67], v[40:43], a[192:195]
    v_mfma_f32_16x16x32_bf16 a[192:195], a[80:83], v[44:47], a[192:195]
    buffer_load_dwordx4 v[32:35], v9, s[12:15], s6 offen sc1
    v_mfma_f32_16x16x32_bf16 a[196:199], a[68:71], v[40:43], a[196:199]
    v_mfma_f32_16x16x32_bf16 a[196:199], a[84:87], v[44:47], a[196:199]
    v_mfma_f32_16x16x32_bf16 a[200:203], a[72:75], v[40:43], a[200:203]
    v_mfma_f32_16x16x32_bf16 a[200:203], a[88:91], v[44:47], a[200:203]
    buffer_load_dwordx4 v[36:39], v9, s[12:15], s7 offen sc1
    v_mfma_f32_16x16x32_bf16 a[204:207], a[76:79], v[40:43], a[204:207]
    v_mfma_f32_16x16x32_bf16 a[204:207], a[92:95], v[44:47], a[204:207]
    s_waitcnt vmcnt(14)
    v_mfma_f32_16x16x32_bf16 a[208:211], a[64:67], v[48:51], a[208:211]
    v_mfma_f32_16x16x32_bf16 a[208:211], a[80:83], v[52:55], a[208:211]
    buffer_load_dwordx4 v[40:43], v10, s[12:15], s6 offen sc1
    v_mfma_f32_16x16x32_bf16 a[212:215], a[68:71], v[48:51], a[212:215]
    v_mfma_f32_16x16x32_bf16 a[212:215], a[84:87], v[52:55], a[212:215]
    v_mfma_f32_16x16x32_bf16 a[216:219], a[72:75], v[48:51], a[216:219]
    v_mfma_f32_16x16x32_bf16 a[216:219], a[88:91], v[52:55], a[216:219]
    buffer_load_dwordx4 v[44:47], v10, s[12:15], s7 offen sc1
    v_mfma_f32_16x16x32_bf16 a[220:223], a[76:79], v[48:51], a[220:223]
    v_mfma_f32_16x16x32_bf16 a[220:223], a[92:95], v[52:55], a[220:223]
    s_waitcnt vmcnt(14)
    v_mfma_f32_16x16x32_bf16 a[224:227], a[64:67], v[56:59], a[224:227]
    v_mfma_f32_16x16x32_bf16 a[224:227], a[80:83], v[60:63], a[224:227]
    s_add_u32 s40, s28, 24576
    buffer_load_dwordx4 v[48:51], v5, s[12:15], s40 offen sc1
    v_mfma_f32_16x16x32_bf16 a[228:231], a[68:71], v[56:59], a[228:231]
    v_mfma_f32_16x16x32_bf16 a[228:231], a[84:87], v[60:63], a[228:231]
    v_mfma_f32_16x16x32_bf16 a[232:235], a[72:75], v[56:59], a[232:235]
    v_mfma_f32_16x16x32_bf16 a[232:235], a[88:91], v[60:63], a[232:235]
    s_add_u32 s41, s29, 24576
    buffer_load_dwordx4 v[52:55], v5, s[12:15], s41 offen sc1
    v_mfma_f32_16x16x32_bf16 a[236:239], a[76:79], v[56:59], a[236:239]
    v_mfma_f32_16x16x32_bf16 a[236:239], a[92:95], v[60:63], a[236:239]
    s_waitcnt vmcnt(14)
    v_mfma_f32_16x16x32_bf16 a[240:243], a[64:67], v[64:67], a[240:243]
    v_mfma_f32_16x16x32_bf16 a[240:243], a[80:83], v[68:71], a[240:243]
    s_add_u32 s43, s30, 24576
    buffer_load_dwordx4 v[56:59], v5, s[12:15], s43 offen sc1
    v_mfma_f32_16x16x32_bf16 a[244:247], a[68:71], v[64:67], a[244:247]
    v_mfma_f32_16x16x32_bf16 a[244:247], a[84:87], v[68:71], a[244:247]
    v_mfma_f32_16x16x32_bf16 a[248:251], a[72:75], v[64:67], a[248:251]
    v_mfma_f32_16x16x32_bf16 a[248:251], a[88:91], v[68:71], a[248:251]
    s_add_u32 s100, s31, 24576
    buffer_load_dwordx4 v[60:63], v5, s[12:15], s100 offen sc1
    v_mfma_f32_16x16x32_bf16 a[252:255], a[76:79], v[64:67], a[252:255]
    v_mfma_f32_16x16x32_bf16 a[252:255], a[92:95], v[68:71], a[252:255]
    s_waitcnt vmcnt(14) lgkmcnt(0)
    v_mfma_f32_16x16x32_bf16 a[160:163], a[96:99], v[72:75], a[160:163]
    v_mfma_f32_16x16x32_bf16 a[160:163], a[112:115], v[76:79], a[160:163]
    buffer_load_dwordx4 v[64:67], v6, s[12:15], s40 offen sc1
    v_mfma_f32_16x16x32_bf16 a[164:167], a[100:103], v[72:75], a[164:167]
    v_mfma_f32_16x16x32_bf16 a[164:167], a[116:119], v[76:79], a[164:167]
    v_mfma_f32_16x16x32_bf16 a[168:171], a[104:107], v[72:75], a[168:171]
    v_mfma_f32_16x16x32_bf16 a[168:171], a[120:123], v[76:79], a[168:171]
    buffer_load_dwordx4 v[68:71], v6, s[12:15], s41 offen sc1
    v_mfma_f32_16x16x32_bf16 a[172:175], a[108:111], v[72:75], a[172:175]
    v_mfma_f32_16x16x32_bf16 a[172:175], a[124:127], v[76:79], a[172:175]
    s_waitcnt vmcnt(14)
    v_mfma_f32_16x16x32_bf16 a[176:179], a[96:99], v[80:83], a[176:179]
    v_mfma_f32_16x16x32_bf16 a[176:179], a[112:115], v[84:87], a[176:179]
    buffer_load_dwordx4 v[72:75], v6, s[12:15], s43 offen sc1
    v_mfma_f32_16x16x32_bf16 a[180:183], a[100:103], v[80:83], a[180:183]
    v_mfma_f32_16x16x32_bf16 a[180:183], a[116:119], v[84:87], a[180:183]
    v_mfma_f32_16x16x32_bf16 a[184:187], a[104:107], v[80:83], a[184:187]
    v_mfma_f32_16x16x32_bf16 a[184:187], a[120:123], v[84:87], a[184:187]
    buffer_load_dwordx4 v[76:79], v6, s[12:15], s100 offen sc1
    v_mfma_f32_16x16x32_bf16 a[188:191], a[108:111], v[80:83], a[188:191]
    v_mfma_f32_16x16x32_bf16 a[188:191], a[124:127], v[84:87], a[188:191]
    s_waitcnt vmcnt(14)
    v_mfma_f32_16x16x32_bf16 a[192:195], a[96:99], v[88:91], a[192:195]
    v_mfma_f32_16x16x32_bf16 a[192:195], a[112:115], v[92:95], a[192:195]
    buffer_load_dwordx4 v[80:83], v7, s[12:15], s40 offen sc1
    v_mfma_f32_16x16x32_bf16 a[196:199], a[100:103], v[88:91], a[196:199]
    v_mfma_f32_16x16x32_bf16 a[196:199], a[116:119], v[92:95], a[196:199]
    v_mfma_f32_16x16x32_bf16 a[200:203], a[104:107], v[88:91], a[200:203]
    v_mfma_f32_16x16x32_bf16 a[200:203], a[120:123], v[92:95], a[200:203]
    buffer_load_dwordx4 v[84:87], v7, s[12:15], s41 offen sc1
    v_mfma_f32_16x16x32_bf16 a[204:207], a[108:111], v[88:91], a[204:207]
    v_mfma_f32_16x16x32_bf16 a[204:207], a[124:127], v[92:95], a[204:207]
    s_waitcnt vmcnt(14)
    v_mfma_f32_16x16x32_bf16 a[208:211], a[96:99], v[24:27], a[208:211]
    v_mfma_f32_16x16x32_bf16 a[208:211], a[112:115], v[28:31], a[208:211]
    buffer_load_dwordx4 v[88:91], v7, s[12:15], s43 offen sc1
    v_mfma_f32_16x16x32_bf16 a[212:215], a[100:103], v[24:27], a[212:215]
    v_mfma_f32_16x16x32_bf16 a[212:215], a[116:119], v[28:31], a[212:215]
    v_mfma_f32_16x16x32_bf16 a[216:219], a[104:107], v[24:27], a[216:219]
    v_mfma_f32_16x16x32_bf16 a[216:219], a[120:123], v[28:31], a[216:219]
    buffer_load_dwordx4 v[92:95], v7, s[12:15], s100 offen sc1
    v_mfma_f32_16x16x32_bf16 a[220:223], a[108:111], v[24:27], a[220:223]
    v_mfma_f32_16x16x32_bf16 a[220:223], a[124:127], v[28:31], a[220:223]
    s_waitcnt vmcnt(14)
    v_mfma_f32_16x16x32_bf16 a[224:227], a[96:99], v[32:35], a[224:227]
    v_mfma_f32_16x16x32_bf16 a[224:227], a[112:115], v[36:39], a[224:227]
    buffer_load_dwordx4 v[24:27], v8, s[12:15], s40 offen sc1
    v_mfma_f32_16x16x32_bf16 a[228:231], a[100:103], v[32:35], a[228:231]
    v_mfma_f32_16x16x32_bf16 a[228:231], a[116:119], v[36:39], a[228:231]
    v_mfma_f32_16x16x32_bf16 a[232:235], a[104:107], v[32:35], a[232:235]
    v_mfma_f32_16x16x32_bf16 a[232:235], a[120:123], v[36:39], a[232:235]
    buffer_load_dwordx4 v[28:31], v8, s[12:15], s41 offen sc1
    v_mfma_f32_16x16x32_bf16 a[236:239], a[108:111], v[32:35], a[236:239]
    v_mfma_f32_16x16x32_bf16 a[236:239], a[124:127], v[36:39], a[236:239]
    s_waitcnt vmcnt(14)
    v_mfma_f32_16x16x32_bf16 a[240:243], a[96:99], v[40:43], a[240:243]
    v_mfma_f32_16x16x32_bf16 a[240:243], a[112:115], v[44:47], a[240:243]
    buffer_load_dwordx4 v[32:35], v8, s[12:15], s43 offen sc1
    v_mfma_f32_16x16x32_bf16 a[244:247], a[100:103], v[40:43], a[244:247]
    v_mfma_f32_16x16x32_bf16 a[244:247], a[116:119], v[44:47], a[244:247]
    v_mfma_f32_16x16x32_bf16 a[248:251], a[104:107], v[40:43], a[248:251]
    v_mfma_f32_16x16x32_bf16 a[248:251], a[120:123], v[44:47], a[248:251]
    buffer_load_dwordx4 v[36:39], v8, s[12:15], s100 offen sc1
    v_mfma_f32_16x16x32_bf16 a[252:255], a[108:111], v[40:43], a[252:255]
    v_mfma_f32_16x16x32_bf16 a[252:255], a[124:127], v[44:47], a[252:255]
    s_waitcnt vmcnt(12)
    v_mfma_f32_16x16x32_bf16 a[160:163], a[128:131], v[48:51], a[160:163]
    v_mfma_f32_16x16x32_bf16 a[160:163], a[144:147], v[52:55], a[160:163]
    buffer_load_dwordx4 v[40:43], v9, s[12:15], s40 offen sc1
    v_mfma_f32_16x16x32_bf16 a[160:163], v[96:99], v[56:59], a[160:163]
    v_mfma_f32_16x16x32_bf16 a[160:163], v[112:115], v[60:63], a[160:163]
    v_mfma_f32_16x16x32_bf16 a[164:167], a[132:135], v[48:51], a[164:167]
    v_mfma_f32_16x16x32_bf16 a[164:167], a[148:151], v[52:55], a[164:167]
    buffer_load_dwordx4 v[44:47], v9, s[12:15], s41 offen sc1
    v_mfma_f32_16x16x32_bf16 a[164:167], v[100:103], v[56:59], a[164:167]
    v_mfma_f32_16x16x32_bf16 a[164:167], v[116:119], v[60:63], a[164:167]
    v_mfma_f32_16x16x32_bf16 a[168:171], a[136:139], v[48:51], a[168:171]
    v_mfma_f32_16x16x32_bf16 a[168:171], a[152:155], v[52:55], a[168:171]
    v_mfma_f32_16x16x32_bf16 a[168:171], v[104:107], v[56:59], a[168:171]
    v_mfma_f32_16x16x32_bf16 a[168:171], v[120:123], v[60:63], a[168:171]
    v_mfma_f32_16x16x32_bf16 a[172:175], a[140:143], v[48:51], a[172:175]
    v_mfma_f32_16x16x32_bf16 a[172:175], a[156:159], v[52:55], a[172:175]
    v_mfma_f32_16x16x32_bf16 a[172:175], v[108:111], v[56:59], a[172:175]
    v_mfma_f32_16x16x32_bf16 a[172:175], v[124:127], v[60:63], a[172:175]
    ds_write_b128 v20, a[160:163] offset:0
    s_waitcnt vmcnt(10)
    v_mfma_f32_16x16x32_bf16 a[176:179], a[128:131], v[64:67], a[176:179]
    v_mfma_f32_16x16x32_bf16 a[176:179], a[144:147], v[68:71], a[176:179]
    buffer_load_dwordx4 v[48:51], v9, s[12:15], s43 offen sc1
    v_mfma_f32_16x16x32_bf16 a[176:179], v[96:99], v[72:75], a[176:179]
    v_mfma_f32_16x16x32_bf16 a[176:179], v[112:115], v[76:79], a[176:179]
    ds_write_b128 v20, a[164:167] offset:1024
    v_mfma_f32_16x16x32_bf16 a[180:183], a[132:135], v[64:67], a[180:183]
    v_mfma_f32_16x16x32_bf16 a[180:183], a[148:151], v[68:71], a[180:183]
    buffer_load_dwordx4 v[52:55], v9, s[12:15], s100 offen sc1
    v_mfma_f32_16x16x32_bf16 a[180:183], v[100:103], v[72:75], a[180:183]
    v_mfma_f32_16x16x32_bf16 a[180:183], v[116:119], v[76:79], a[180:183]
    ds_write_b128 v20, a[168:171] offset:2048
    v_mfma_f32_16x16x32_bf16 a[184:187], a[136:139], v[64:67], a[184:187]
    v_mfma_f32_16x16x32_bf16 a[184:187], a[152:155], v[68:71], a[184:187]
    buffer_load_dwordx4 v[56:59], v10, s[12:15], s40 offen sc1
    v_mfma_f32_16x16x32_bf16 a[184:187], v[104:107], v[72:75], a[184:187]
    v_mfma_f32_16x16x32_bf16 a[184:187], v[120:123], v[76:79], a[184:187]
    ds_write_b128 v20, a[172:175] offset:3072
    v_mfma_f32_16x16x32_bf16 a[188:191], a[140:143], v[64:67], a[188:191]
    v_mfma_f32_16x16x32_bf16 a[188:191], a[156:159], v[68:71], a[188:191]
    buffer_load_dwordx4 v[60:63], v10, s[12:15], s41 offen sc1
    v_mfma_f32_16x16x32_bf16 a[188:191], v[108:111], v[72:75], a[188:191]
    v_mfma_f32_16x16x32_bf16 a[188:191], v[124:127], v[76:79], a[188:191]
    ds_write_b128 v20, a[176:179] offset:16384
    s_waitcnt vmcnt(10)
    v_mfma_f32_16x16x32_bf16 a[192:195], a[128:131], v[80:83], a[192:195]
    v_mfma_f32_16x16x32_bf16 a[192:195], a[144:147], v[84:87], a[192:195]
    buffer_load_dwordx4 v[64:67], v10, s[12:15], s43 offen sc1
    v_mfma_f32_16x16x32_bf16 a[192:195], v[96:99], v[88:91], a[192:195]
    v_mfma_f32_16x16x32_bf16 a[192:195], v[112:115], v[92:95], a[192:195]
    ds_write_b128 v20, a[180:183] offset:17408
    v_mfma_f32_16x16x32_bf16 a[196:199], a[132:135], v[80:83], a[196:199]
    v_mfma_f32_16x16x32_bf16 a[196:199], a[148:151], v[84:87], a[196:199]
    buffer_load_dwordx4 v[68:71], v10, s[12:15], s100 offen sc1
    v_mfma_f32_16x16x32_bf16 a[196:199], v[100:103], v[88:91], a[196:199]
    v_mfma_f32_16x16x32_bf16 a[196:199], v[116:119], v[92:95], a[196:199]
    ds_write_b128 v20, a[184:187] offset:18432
    v_mfma_f32_16x16x32_bf16 a[200:203], a[136:139], v[80:83], a[200:203]
    v_mfma_f32_16x16x32_bf16 a[200:203], a[152:155], v[84:87], a[200:203]
    v_mfma_f32_16x16x32_bf16 a[200:203], v[104:107], v[88:91], a[200:203]
    v_mfma_f32_16x16x32_bf16 a[200:203], v[120:123], v[92:95], a[200:203]
    ds_write_b128 v20, a[188:191] offset:19456
    v_mfma_f32_16x16x32_bf16 a[204:207], a[140:143], v[80:83], a[204:207]
    v_mfma_f32_16x16x32_bf16 a[204:207], a[156:159], v[84:87], a[204:207]
    v_mfma_f32_16x16x32_bf16 a[204:207], v[108:111], v[88:91], a[204:207]
    v_mfma_f32_16x16x32_bf16 a[204:207], v[124:127], v[92:95], a[204:207]
    ds_write_b128 v20, a[192:195] offset:32768
    s_waitcnt vmcnt(8)
    v_mfma_f32_16x16x32_bf16 a[208:211], a[128:131], v[24:27], a[208:211]
    v_mfma_f32_16x16x32_bf16 a[208:211], a[144:147], v[28:31], a[208:211]
    v_mfma_f32_16x16x32_bf16 a[208:211], v[96:99], v[32:35], a[208:211]
    v_mfma_f32_16x16x32_bf16 a[208:211], v[112:115], v[36:39], a[208:211]
    ds_write_b128 v20, a[196:199] offset:33792
    v_mfma_f32_16x16x32_bf16 a[212:215], a[132:135], v[24:27], a[212:215]
    v_mfma_f32_16x16x32_bf16 a[212:215], a[148:151], v[28:31], a[212:215]
    v_mfma_f32_16x16x32_bf16 a[212:215], v[100:103], v[32:35], a[212:215]
    v_mfma_f32_16x16x32_bf16 a[212:215], v[116:119], v[36:39], a[212:215]
    ds_write_b128 v20, a[200:203] offset:34816
    v_mfma_f32_16x16x32_bf16 a[216:219], a[136:139], v[24:27], a[216:219]
    v_mfma_f32_16x16x32_bf16 a[216:219], a[152:155], v[28:31], a[216:219]
    v_mfma_f32_16x16x32_bf16 a[216:219], v[104:107], v[32:35], a[216:219]
    v_mfma_f32_16x16x32_bf16 a[216:219], v[120:123], v[36:39], a[216:219]
    ds_write_b128 v20, a[204:207] offset:35840
    v_mfma_f32_16x16x32_bf16 a[220:223], a[140:143], v[24:27], a[220:223]
    v_mfma_f32_16x16x32_bf16 a[220:223], a[156:159], v[28:31], a[220:223]
    v_mfma_f32_16x16x32_bf16 a[220:223], v[108:111], v[32:35], a[220:223]
    v_mfma_f32_16x16x32_bf16 a[220:223], v[124:127], v[36:39], a[220:223]
    ds_write_b128 v20, a[208:211] offset:49152
    s_waitcnt vmcnt(4)
    v_mfma_f32_16x16x32_bf16 a[224:227], a[128:131], v[40:43], a[224:227]
    v_mfma_f32_16x16x32_bf16 a[224:227], a[144:147], v[44:47], a[224:227]
    v_mfma_f32_16x16x32_bf16 a[224:227], v[96:99], v[48:51], a[224:227]
    v_mfma_f32_16x16x32_bf16 a[224:227], v[112:115], v[52:55], a[224:227]
    ds_write_b128 v20, a[212:215] offset:50176
    v_mfma_f32_16x16x32_bf16 a[228:231], a[132:135], v[40:43], a[228:231]
    v_mfma_f32_16x16x32_bf16 a[228:231], a[148:151], v[44:47], a[228:231]
    v_mfma_f32_16x16x32_bf16 a[228:231], v[100:103], v[48:51], a[228:231]
    v_mfma_f32_16x16x32_bf16 a[228:231], v[116:119], v[52:55], a[228:231]
    ds_write_b128 v20, a[216:219] offset:51200
    v_mfma_f32_16x16x32_bf16 a[232:235], a[136:139], v[40:43], a[232:235]
    v_mfma_f32_16x16x32_bf16 a[232:235], a[152:155], v[44:47], a[232:235]
    v_mfma_f32_16x16x32_bf16 a[232:235], v[104:107], v[48:51], a[232:235]
    v_mfma_f32_16x16x32_bf16 a[232:235], v[120:123], v[52:55], a[232:235]
    ds_write_b128 v20, a[220:223] offset:52224
    v_mfma_f32_16x16x32_bf16 a[236:239], a[140:143], v[40:43], a[236:239]
    v_mfma_f32_16x16x32_bf16 a[236:239], a[156:159], v[44:47], a[236:239]
    v_mfma_f32_16x16x32_bf16 a[236:239], v[108:111], v[48:51], a[236:239]
    v_mfma_f32_16x16x32_bf16 a[236:239], v[124:127], v[52:55], a[236:239]
    ds_write_b128 v22, a[224:227] offset:0
    s_waitcnt vmcnt(0)
    v_mfma_f32_16x16x32_bf16 a[240:243], a[128:131], v[56:59], a[240:243]
    v_mfma_f32_16x16x32_bf16 a[240:243], a[144:147], v[60:63], a[240:243]
    v_mfma_f32_16x16x32_bf16 a[240:243], v[96:99], v[64:67], a[240:243]
    v_mfma_f32_16x16x32_bf16 a[240:243], v[112:115], v[68:71], a[240:243]
    ds_write_b128 v22, a[228:231] offset:1024
    v_mfma_f32_16x16x32_bf16 a[244:247], a[132:135], v[56:59], a[244:247]
    v_mfma_f32_16x16x32_bf16 a[244:247], a[148:151], v[60:63], a[244:247]
    v_mfma_f32_16x16x32_bf16 a[244:247], v[100:103], v[64:67], a[244:247]
    v_mfma_f32_16x16x32_bf16 a[244:247], v[116:119], v[68:71], a[244:247]
    ds_write_b128 v22, a[232:235] offset:2048
    v_mfma_f32_16x16x32_bf16 a[248:251], a[136:139], v[56:59], a[248:251]
    v_mfma_f32_16x16x32_bf16 a[248:251], a[152:155], v[60:63], a[248:251]
    v_mfma_f32_16x16x32_bf16 a[248:251], v[104:107], v[64:67], a[248:251]
    v_mfma_f32_16x16x32_bf16 a[248:251], v[120:123], v[68:71], a[248:251]
    ds_write_b128 v22, a[236:239] offset:3072
    v_mfma_f32_16x16x32_bf16 a[252:255], a[140:143], v[56:59], a[252:255]
    v_mfma_f32_16x16x32_bf16 a[252:255], a[156:159], v[60:63], a[252:255]
    v_mfma_f32_16x16x32_bf16 a[252:255], v[108:111], v[64:67], a[252:255]
    v_mfma_f32_16x16x32_bf16 a[252:255], v[124:127], v[68:71], a[252:255]
    ds_write_b128 v22, a[240:243] offset:16384
    s_nop 1
    ds_write_b128 v22, a[244:247] offset:17408
    ds_write_b128 v22, a[248:251] offset:18432
    s_nop 4
    ds_write_b128 v22, a[252:255] offset:19456
    s_branch L1_reduce
L1_small:
    s_add_u32 s4, s24, 0
    buffer_load_dwordx4 v[24:27], v5, s[12:15], s4 offen sc1
    s_add_u32 s5, s25, 0
    buffer_load_dwordx4 v[28:31], v5, s[12:15], s5 offen sc1
    buffer_load_dwordx4 v[32:35], v6, s[12:15], s4 offen sc1
    buffer_load_dwordx4 v[36:39], v6, s[12:15], s5 offen sc1
    buffer_load_dwordx4 v[40:43], v7, s[12:15], s4 offen sc1
    buffer_load_dwordx4 v[44:47], v7, s[12:15], s5 offen sc1
    buffer_load_dwordx4 v[48:51], v8, s[12:15], s4 offen sc1
    buffer_load_dwordx4 v[52:55], v8, s[12:15], s5 offen sc1
    buffer_load_dwordx4 v[56:59], v9, s[12:15], s4 offen sc1
    buffer_load_dwordx4 v[60:63], v9, s[12:15], s5 offen sc1
    s_add_u32 s6, s26, 0
    buffer_load_dwordx4 v[64:67], v5, s[12:15], s6 offen sc1
    s_add_u32 s7, s27, 0
    buffer_load_dwordx4 v[68:71], v5, s[12:15], s7 offen sc1
    buffer_load_dwordx4 v[72:75], v6, s[12:15], s6 offen sc1
    buffer_load_dwordx4 v[76:79], v6, s[12:15], s7 offen sc1
    buffer_load_dwordx4 v[80:83], v7, s[12:15], s6 offen sc1
    buffer_load_dwordx4 v[84:87], v7, s[12:15], s7 offen sc1
    buffer_load_dwordx4 v[88:91], v8, s[12:15], s6 offen sc1
    buffer_load_dwordx4 v[92:95], v8, s[12:15], s7 offen sc1
    s_waitcnt vmcnt(46)
    v_add_u32 v20, s39, v1
    v_add_u32 v22, 65536, v20
    v_bfe_u32 v23, v1, 4, 4
    v_mul_u32_u24 v23, 1152, v23
    v_lshrrev_b32 v0, 9, v1
    v_lshl_add_u32 v23, v0, 4, v23
    v_bfe_u32 v0, v1, 8, 1
    v_lshl_add_u32 v23, v0, 5, v23
    s_mul_i32 s54, s38, 3
    s_add_u32 s54, s54, 0
    s_lshr_b32 s57, s54, 1
    s_and_b32 s54, s54, 1
    s_lshl_b32 s56, s57, 14
    s_lshl_b32 s58, s54, 11
    s_add_u32 s56, s56, s58
    v_add_u32 v0, s56, v1
    s_mul_i32 s57, s57, 18432
    s_lshl_b32 s54, s54, 6
    s_add_u32 s45, s54, s57
    s_mul_i32 s54, s38, 3
    s_add_u32 s54, s54, 1
    s_lshr_b32 s57, s54, 1
    s_and_b32 s54, s54, 1
    s_lshl_b32 s56, s57, 14
    s_lshl_b32 s58, s54, 11
    s_add_u32 s56, s56, s58
    v_add_u32 v17, s56, v1
    s_mul_i32 s57, s57, 18432
    s_lshl_b32 s54, s54, 6
    s_add_u32 s46, s54, s57
    s_mul_i32 s54, s38, 3
    s_add_u32 s54, s54, 2
    s_lshr_b32 s57, s54, 1
    s_and_b32 s54, s54, 1
    s_lshl_b32 s56, s57, 14
    s_lshl_b32 s58, s54, 11
    s_add_u32 s56, s56, s58
    v_add_u32 v18, s56, v1
    s_mul_i32 s57, s57, 18432
    s_lshl_b32 s54, s54, 6
    s_add_u32 s47, s54, s57
    s_waitcnt vmcnt(16) lgkmcnt(0)
    v_mfma_f32_16x16x32_bf16 a[160:163], v[224:227], v[24:27], 0
    v_mfma_f32_16x16x32_bf16 a[160:163], v[240:243], v[28:31], a[160:163]
    v_mfma_f32_16x16x32_bf16 a[164:167], v[228:231], v[24:27], 0
    v_mfma_f32_16x16x32_bf16 a[164:167], v[244:247], v[28:31], a[164:167]
    v_mfma_f32_16x16x32_bf16 a[168:171], v[232:235], v[24:27], 0
    v_mfma_f32_16x16x32_bf16 a[168:171], v[248:251], v[28:31], a[168:171]
    v_mfma_f32_16x16x32_bf16 a[172:175], v[236:239], v[24:27], 0
    v_mfma_f32_16x16x32_bf16 a[172:175], v[252:255], v[28:31], a[172:175]
    s_waitcnt vmcnt(14)
    v_mfma_f32_16x16x32_bf16 a[176:179], v[224:227], v[32:35], 0
    v_mfma_f32_16x16x32_bf16 a[176:179], v[240:243], v[36:39], a[176:179]
    buffer_load_dwordx4 v[24:27], v9, s[12:15], s6 offen sc1
    v_mfma_f32_16x16x32_bf16 a[180:183], v[228:231], v[32:35], 0
    v_mfma_f32_16x16x32_bf16 a[180:183], v[244:247], v[36:39], a[180:183]
    v_mfma_f32_16x16x32_bf16 a[184:187], v[232:235], v[32:35], 0
    v_mfma_f32_16x16x32_bf16 a[184:187], v[248:251], v[36:39], a[184:187]
    buffer_load_dwordx4 v[28:31], v9, s[12:15], s7 offen sc1
    v_mfma_f32_16x16x32_bf16 a[188:191], v[236:239], v[32:35], 0
    v_mfma_f32_16x16x32_bf16 a[188:191], v[252:255], v[36:39], a[188:191]
    s_waitcnt vmcnt(14)
    v_mfma_f32_16x16x32_bf16 a[192:195], v[224:227], v[40:43], 0
    v_mfma_f32_16x16x32_bf16 a[192:195], v[240:243], v[44:47], a[192:195]
    s_add_u32 s40, s28, 0
    buffer_load_dwordx4 v[32:35], v5, s[12:15], s40 offen sc1
    v_mfma_f32_16x16x32_bf16 a[196:199], v[228:231], v[40:43], 0
    v_mfma_f32_16x16x32_bf16 a[196:199], v[244:247], v[44:47], a[196:199]
    v_mfma_f32_16x16x32_bf16 a[200:203], v[232:235], v[40:43], 0
    v_mfma_f32_16x16x32_bf16 a[200:203], v[248:251], v[44:47], a[200:203]
    s_add_u32 s41, s29, 0
    buffer_load_dwordx4 v[36:39], v5, s[12:15], s41 offen sc1
    v_mfma_f32_16x16x32_bf16 a[204:207], v[236:239], v[40:43], 0
    v_mfma_f32_16x16x32_bf16 a[204:207], v[252:255], v[44:47], a[204:207]
    s_waitcnt vmcnt(14)
    v_mfma_f32_16x16x32_bf16 a[208:211], v[224:227], v[48:51], 0
    v_mfma_f32_16x16x32_bf16 a[208:211], v[240:243], v[52:55], a[208:211]
    buffer_load_dwordx4 v[40:43], v6, s[12:15], s40 offen sc1
    v_mfma_f32_16x16x32_bf16 a[212:215], v[228:231], v[48:51], 0
    v_mfma_f32_16x16x32_bf16 a[212:215], v[244:247], v[52:55], a[212:215]
    v_mfma_f32_16x16x32_bf16 a[216:219], v[232:235], v[48:51], 0
    v_mfma_f32_16x16x32_bf16 a[216:219], v[248:251], v[52:55], a[216:219]
    buffer_load_dwordx4 v[44:47], v6, s[12:15], s41 offen sc1
    v_mfma_f32_16x16x32_bf16 a[220:223], v[236:239], v[48:51], 0
    v_mfma_f32_16x16x32_bf16 a[220:223], v[252:255], v[52:55], a[220:223]
    s_waitcnt vmcnt(14)
    v_mfma_f32_16x16x32_bf16 a[224:227], v[224:227], v[56:59], 0
    v_mfma_f32_16x16x32_bf16 a[224:227], v[240:243], v[60:63], a[224:227]
    buffer_load_dwordx4 v[48:51], v7, s[12:15], s40 offen sc1
    v_mfma_f32_16x16x32_bf16 a[228:231], v[228:231], v[56:59], 0
    v_mfma_f32_16x16x32_bf16 a[228:231], v[244:247], v[60:63], a[228:231]
    v_mfma_f32_16x16x32_bf16 a[232:235], v[232:235], v[56:59], 0
    v_mfma_f32_16x16x32_bf16 a[232:235], v[248:251], v[60:63], a[232:235]
    buffer_load_dwordx4 v[52:55], v7, s[12:15], s41 offen sc1
    v_mfma_f32_16x16x32_bf16 a[236:239], v[236:239], v[56:59], 0
    v_mfma_f32_16x16x32_bf16 a[236:239], v[252:255], v[60:63], a[236:239]
    s_waitcnt vmcnt(14) lgkmcnt(0)
    v_mfma_f32_16x16x32_bf16 a[160:163], a[32:35], v[64:67], a[160:163]
    ds_read_b64_tr_b16 v[224:225], v13 offset:32768
    ds_read_b64_tr_b16 v[226:227], v13 offset:34816
    v_mfma_f32_16x16x32_bf16 a[160:163], a[48:51], v[68:71], a[160:163]
    buffer_load_dwordx4 v[56:59], v8, s[12:15], s40 offen sc1
    v_mfma_f32_16x16x32_bf16 a[164:167], a[36:39], v[64:67], a[164:167]
    ds_read_b64_tr_b16 v[228:229], v14 offset:32768
    ds_read_b64_tr_b16 v[230:231], v14 offset:34816
    v_mfma_f32_16x16x32_bf16 a[164:167], a[52:55], v[68:71], a[164:167]
    ds_read_b64_tr_b16 v[232:233], v13 offset:33280
    ds_read_b64_tr_b16 v[234:235], v13 offset:35328
    v_mfma_f32_16x16x32_bf16 a[168:171], a[40:43], v[64:67], a[168:171]
    ds_read_b64_tr_b16 v[236:237], v14 offset:33280
    ds_read_b64_tr_b16 v[238:239], v14 offset:35328
    v_mfma_f32_16x16x32_bf16 a[168:171], a[56:59], v[68:71], a[168:171]
    buffer_load_dwordx4 v[60:63], v8, s[12:15], s41 offen sc1
    v_mfma_f32_16x16x32_bf16 a[172:175], a[44:47], v[64:67], a[172:175]
    ds_read_b64_tr_b16 v[240:241], v13 offset:49152
    ds_read_b64_tr_b16 v[242:243], v13 offset:51200
    v_mfma_f32_16x16x32_bf16 a[172:175], a[60:63], v[68:71], a[172:175]
    s_waitcnt vmcnt(14)
    v_mfma_f32_16x16x32_bf16 a[176:179], a[32:35], v[72:75], a[176:179]
    ds_read_b64_tr_b16 v[244:245], v14 offset:49152
    ds_read_b64_tr_b16 v[246:247], v14 offset:51200
    v_mfma_f32_16x16x32_bf16 a[176:179], a[48:51], v[76:79], a[176:179]
    buffer_load_dwordx4 v[64:67], v9, s[12:15], s40 offen sc1
    v_mfma_f32_16x16x32_bf16 a[180:183], a[36:39], v[72:75], a[180:183]
    ds_read_b64_tr_b16 v[248:249], v13 offset:49664
    ds_read_b64_tr_b16 v[250:251], v13 offset:51712
    v_mfma_f32_16x16x32_bf16 a[180:183], a[52:55], v[76:79], a[180:183]
    ds_read_b64_tr_b16 v[252:253], v14 offset:49664
    ds_read_b64_tr_b16 v[254:255], v14 offset:51712
    v_mfma_f32_16x16x32_bf16 a[184:187], a[40:43], v[72:75], a[184:187]
    v_mfma_f32_16x16x32_bf16 a[184:187], a[56:59], v[76:79], a[184:187]
    buffer_load_dwordx4 v[68:71], v9, s[12:15], s41 offen sc1
    v_mfma_f32_16x16x32_bf16 a[188:191], a[44:47], v[72:75], a[188:191]
    v_mfma_f32_16x16x32_bf16 a[188:191], a[60:63], v[76:79], a[188:191]
    s_waitcnt vmcnt(14)
    v_mfma_f32_16x16x32_bf16 a[192:195], a[32:35], v[80:83], a[192:195]
    v_mfma_f32_16x16x32_bf16 a[192:195], a[48:51], v[84:87], a[192:195]
    s_add_u32 s43, s30, 0
    buffer_load_dwordx4 v[72:75], v5, s[12:15], s43 offen sc1
    v_mfma_f32_16x16x32_bf16 a[196:199], a[36:39], v[80:83], a[196:199]
    v_mfma_f32_16x16x32_bf16 a[196:199], a[52:55], v[84:87], a[196:199]
    v_mfma_f32_16x16x32_bf16 a[200:203], a[40:43], v[80:83], a[200:203]
    v_mfma_f32_16x16x32_bf16 a[200:203], a[56:59], v[84:87], a[200:203]
    s_add_u32 s100, s31, 0
    buffer_load_dwordx4 v[76:79], v5, s[12:15], s100 offen sc1
    v_mfma_f32_16x16x32_bf16 a[204:207], a[44:47], v[80:83], a[204:207]
    v_mfma_f32_16x16x32_bf16 a[204:207], a[60:63], v[84:87], a[204:207]
    s_waitcnt vmcnt(14)
    v_mfma_f32_16x16x32_bf16 a[208:211], a[32:35], v[88:91], a[208:211]
    v_mfma_f32_16x16x32_bf16 a[208:211], a[48:51], v[92:95], a[208:211]
    buffer_load_dwordx4 v[80:83], v6, s[12:15], s43 offen sc1
    v_mfma_f32_16x16x32_bf16 a[212:215], a[36:39], v[88:91], a[212:215]
    v_mfma_f32_16x16x32_bf16 a[212:215], a[52:55], v[92:95], a[212:215]
    v_mfma_f32_16x16x32_bf16 a[216:219], a[40:43], v[88:91], a[216:219]
    v_mfma_f32_16x16x32_bf16 a[216:219], a[56:59], v[92:95], a[216:219]
    buffer_load_dwordx4 v[84:87], v6, s[12:15], s100 offen sc1
    v_mfma_f32_16x16x32_bf16 a[220:223], a[44:47], v[88:91], a[220:223]
    v_mfma_f32_16x16x32_bf16 a[220:223], a[60:63], v[92:95], a[220:223]
    s_waitcnt vmcnt(14)
    v_mfma_f32_16x16x32_bf16 a[224:227], a[32:35], v[24:27], a[224:227]
    v_mfma_f32_16x16x32_bf16 a[224:227], a[48:51], v[28:31], a[224:227]
    buffer_load_dwordx4 v[88:91], v7, s[12:15], s43 offen sc1
    v_mfma_f32_16x16x32_bf16 a[228:231], a[36:39], v[24:27], a[228:231]
    v_mfma_f32_16x16x32_bf16 a[228:231], a[52:55], v[28:31], a[228:231]
    v_mfma_f32_16x16x32_bf16 a[232:235], a[40:43], v[24:27], a[232:235]
    v_mfma_f32_16x16x32_bf16 a[232:235], a[56:59], v[28:31], a[232:235]
    buffer_load_dwordx4 v[92:95], v7, s[12:15], s100 offen sc1
    v_mfma_f32_16x16x32_bf16 a[236:239], a[44:47], v[24:27], a[236:239]
    v_mfma_f32_16x16x32_bf16 a[236:239], a[60:63], v[28:31], a[236:239]
    s_waitcnt vmcnt(14) lgkmcnt(0)
    v_mfma_f32_16x16x32_bf16 a[160:163], a[64:67], v[32:35], a[160:163]
    ds_read_b64_tr_b16 a[32:33], v15 offset:0
    ds_read_b64_tr_b16 a[34:35], v15 offset:2048
    v_mfma_f32_16x16x32_bf16 a[160:163], a[80:83], v[36:39], a[160:163]
    buffer_load_dwordx4 v[24:27], v8, s[12:15], s43 offen sc1
    v_mfma_f32_16x16x32_bf16 a[164:167], a[68:71], v[32:35], a[164:167]
    ds_read_b64_tr_b16 a[36:37], v16 offset:0
    ds_read_b64_tr_b16 a[38:39], v16 offset:2048
    v_mfma_f32_16x16x32_bf16 a[164:167], a[84:87], v[36:39], a[164:167]
    ds_read_b64_tr_b16 a[40:41], v15 offset:512
    ds_read_b64_tr_b16 a[42:43], v15 offset:2560
    v_mfma_f32_16x16x32_bf16 a[168:171], a[72:75], v[32:35], a[168:171]
    ds_read_b64_tr_b16 a[44:45], v16 offset:512
    ds_read_b64_tr_b16 a[46:47], v16 offset:2560
    v_mfma_f32_16x16x32_bf16 a[168:171], a[88:91], v[36:39], a[168:171]
    buffer_load_dwordx4 v[28:31], v8, s[12:15], s100 offen sc1
    v_mfma_f32_16x16x32_bf16 a[172:175], a[76:79], v[32:35], a[172:175]
    ds_read_b64_tr_b16 a[48:49], v15 offset:16384
    ds_read_b64_tr_b16 a[50:51], v15 offset:18432
    v_mfma_f32_16x16x32_bf16 a[172:175], a[92:95], v[36:39], a[172:175]
    s_waitcnt vmcnt(14)
    v_mfma_f32_16x16x32_bf16 a[176:179], a[64:67], v[40:43], a[176:179]
    ds_read_b64_tr_b16 a[52:53], v16 offset:16384
    ds_read_b64_tr_b16 a[54:55], v16 offset:18432
    v_mfma_f32_16x16x32_bf16 a[176:179], a[80:83], v[44:47], a[176:179]
    buffer_load_dwordx4 v[32:35], v9, s[12:15], s43 offen sc1
    v_mfma_f32_16x16x32_bf16 a[180:183], a[68:71], v[40:43], a[180:183]
    ds_read_b64_tr_b16 a[56:57], v15 offset:16896
    ds_read_b64_tr_b16 a[58:59], v15 offset:18944
    v_mfma_f32_16x16x32_bf16 a[180:183], a[84:87], v[44:47], a[180:183]
    ds_read_b64_tr_b16 a[60:61], v16 offset:16896
    ds_read_b64_tr_b16 a[62:63], v16 offset:18944
    v_mfma_f32_16x16x32_bf16 a[184:187], a[72:75], v[40:43], a[184:187]
    s_add_u32 m0, s39, 98304
    s_add_u32 s42, s86, 884736
    v_mfma_f32_16x16x32_bf16 a[184:187], a[88:91], v[44:47], a[184:187]
    buffer_load_dwordx4 v[36:39], v9, s[12:15], s100 offen sc1
    v_mfma_f32_16x16x32_bf16 a[188:191], a[76:79], v[40:43], a[188:191]
    buffer_load_dwordx4 v2, s[8:11], s42 offen lds
    v_mfma_f32_16x16x32_bf16 a[188:191], a[92:95], v[44:47], a[188:191]
    s_waitcnt vmcnt(15)
    v_mfma_f32_16x16x32_bf16 a[192:195], a[64:67], v[48:51], a[192:195]
    buffer_load_dwordx4 v3, s[8:11], s42 offen offset:1024 lds
    v_mfma_f32_16x16x32_bf16 a[192:195], a[80:83], v[52:55], a[192:195]
    s_add_u32 s4, s24, 8192
    buffer_load_dwordx4 v[40:43], v5, s[12:15], s4 offen sc1
    v_mfma_f32_16x16x32_bf16 a[196:199], a[68:71], v[48:51], a[196:199]
    buffer_load_dwordx4 v4, s[8:11], s42 offen offset:2048 lds
    v_mfma_f32_16x16x32_bf16 a[196:199], a[84:87], v[52:55], a[196:199]
    buffer_load_dwordx4 v21, s[8:11], s42 offen offset:3072 lds
    v_mfma_f32_16x16x32_bf16 a[200:203], a[72:75], v[48:51], a[200:203]
    s_add_u32 m0, s39, 114688
    s_add_u32 s42, s87, 884736
    v_mfma_f32_16x16x32_bf16 a[200:203], a[88:91], v[52:55], a[200:203]
    s_add_u32 s5, s25, 8192
    buffer_load_dwordx4 v[44:47], v5, s[12:15], s5 offen sc1
    v_mfma_f32_16x16x32_bf16 a[204:207], a[76:79], v[48:51], a[204:207]
    buffer_load_dwordx4 v2, s[8:11], s42 offen lds
    v_mfma_f32_16x16x32_bf16 a[204:207], a[92:95], v[52:55], a[204:207]
    s_waitcnt vmcnt(19)
    v_mfma_f32_16x16x32_bf16 a[208:211], a[64:67], v[56:59], a[208:211]
    buffer_load_dwordx4 v3, s[8:11], s42 offen offset:1024 lds
    v_mfma_f32_16x16x32_bf16 a[208:211], a[80:83], v[60:63], a[208:211]
    buffer_load_dwordx4 v[48:51], v6, s[12:15], s4 offen sc1
    v_mfma_f32_16x16x32_bf16 a[212:215], a[68:71], v[56:59], a[212:215]
    buffer_load_dwordx4 v4, s[8:11], s42 offen offset:2048 lds
    v_mfma_f32_16x16x32_bf16 a[212:215], a[84:87], v[60:63], a[212:215]
    buffer_load_dwordx4 v21, s[8:11], s42 offen offset:3072 lds
    v_mfma_f32_16x16x32_bf16 a[216:219], a[72:75], v[56:59], a[216:219]
    v_mfma_f32_16x16x32_bf16 a[216:219], a[88:91], v[60:63], a[216:219]
    buffer_load_dwordx4 v[52:55], v6, s[12:15], s5 offen sc1
    v_mfma_f32_16x16x32_bf16 a[220:223], a[76:79], v[56:59], a[220:223]
    v_mfma_f32_16x16x32_bf16 a[220:223], a[92:95], v[60:63], a[220:223]
    s_waitcnt vmcnt(22)
    v_mfma_f32_16x16x32_bf16 a[224:227], a[64:67], v[64:67], a[224:227]
    v_mfma_f32_16x16x32_bf16 a[224:227], a[80:83], v[68:71], a[224:227]
    buffer_load_dwordx4 v[56:59], v7, s[12:15], s4 offen sc1
    v_mfma_f32_16x16x32_bf16 a[228:231], a[68:71], v[64:67], a[228:231]
    v_mfma_f32_16x16x32_bf16 a[228:231], a[84:87], v[68:71], a[228:231]
    v_mfma_f32_16x16x32_bf16 a[232:235], a[72:75], v[64:67], a[232:235]
    v_mfma_f32_16x16x32_bf16 a[232:235], a[88:91], v[68:71], a[232:235]
    buffer_load_dwordx4 v[60:63], v7, s[12:15], s5 offen sc1
    v_mfma_f32_16x16x32_bf16 a[236:239], a[76:79], v[64:67], a[236:239]
    v_mfma_f32_16x16x32_bf16 a[236:239], a[92:95], v[68:71], a[236:239]
    s_waitcnt vmcnt(22) lgkmcnt(0)
    v_mfma_f32_16x16x32_bf16 a[160:163], a[96:99], v[72:75], a[160:163]
    ds_read_b64_tr_b16 a[64:65], v13 offset:0
    ds_read_b64_tr_b16 a[66:67], v13 offset:2048
    v_mfma_f32_16x16x32_bf16 a[160:163], a[112:115], v[76:79], a[160:163]
    buffer_load_dwordx4 v[64:67], v8, s[12:15], s4 offen sc1
    v_mfma_f32_16x16x32_bf16 a[164:167], a[100:103], v[72:75], a[164:167]
    ds_read_b64_tr_b16 a[68:69], v14 offset:0
    ds_read_b64_tr_b16 a[70:71], v14 offset:2048
    v_mfma_f32_16x16x32_bf16 a[164:167], a[116:119], v[76:79], a[164:167]
    ds_read_b64_tr_b16 a[72:73], v13 offset:512
    ds_read_b64_tr_b16 a[74:75], v13 offset:2560
    v_mfma_f32_16x16x32_bf16 a[168:171], a[104:107], v[72:75], a[168:171]
    ds_read_b64_tr_b16 a[76:77], v14 offset:512
    ds_read_b64_tr_b16 a[78:79], v14 offset:2560
    v_mfma_f32_16x16x32_bf16 a[168:171], a[120:123], v[76:79], a[168:171]
    buffer_load_dwordx4 v[68:71], v8, s[12:15], s5 offen sc1
    v_mfma_f32_16x16x32_bf16 a[172:175], a[108:111], v[72:75], a[172:175]
    ds_read_b64_tr_b16 a[80:81], v11 offset:16384
    ds_read_b64_tr_b16 a[82:83], v11 offset:18432
    v_mfma_f32_16x16x32_bf16 a[172:175], a[124:127], v[76:79], a[172:175]
    s_waitcnt vmcnt(22)
    v_mfma_f32_16x16x32_bf16 a[176:179], a[96:99], v[80:83], a[176:179]
    ds_read_b64_tr_b16 a[84:85], v12 offset:16384
    ds_read_b64_tr_b16 a[86:87], v12 offset:18432
    v_mfma_f32_16x16x32_bf16 a[176:179], a[112:115], v[84:87], a[176:179]
    buffer_load_dwordx4 v[72:75], v9, s[12:15], s4 offen sc1
    v_mfma_f32_16x16x32_bf16 a[180:183], a[100:103], v[80:83], a[180:183]
    ds_read_b64_tr_b16 a[88:89], v11 offset:16896
    ds_read_b64_tr_b16 a[90:91], v11 offset:18944
    v_mfma_f32_16x16x32_bf16 a[180:183], a[116:119], v[84:87], a[180:183]
    ds_read_b64_tr_b16 a[92:93], v12 offset:16896
    ds_read_b64_tr_b16 a[94:95], v12 offset:18944
    v_mfma_f32_16x16x32_bf16 a[184:187], a[104:107], v[80:83], a[184:187]
    v_mfma_f32_16x16x32_bf16 a[184:187], a[120:123], v[84:87], a[184:187]
    buffer_load_dwordx4 v[76:79], v9, s[12:15], s5 offen sc1
    v_mfma_f32_16x16x32_bf16 a[188:191], a[108:111], v[80:83], a[188:191]
    v_mfma_f32_16x16x32_bf16 a[188:191], a[124:127], v[84:87], a[188:191]
    s_waitcnt vmcnt(22)
    v_mfma_f32_16x16x32_bf16 a[192:195], a[96:99], v[88:91], a[192:195]
    v_mfma_f32_16x16x32_bf16 a[192:195], a[112:115], v[92:95], a[192:195]
    s_add_u32 s6, s26, 8192
    buffer_load_dwordx4 v[80:83], v5, s[12:15], s6 offen sc1
    v_mfma_f32_16x16x32_bf16 a[196:199], a[100:103], v[88:91], a[196:199]
    v_mfma_f32_16x16x32_bf16 a[196:199], a[116:119], v[92:95], a[196:199]
    v_mfma_f32_16x16x32_bf16 a[200:203], a[104:107], v[88:91], a[200:203]
    v_mfma_f32_16x16x32_bf16 a[200:203], a[120:123], v[92:95], a[200:203]
    s_add_u32 s7, s27, 8192
    buffer_load_dwordx4 v[84:87], v5, s[12:15], s7 offen sc1
    v_mfma_f32_16x16x32_bf16 a[204:207], a[108:111], v[88:91], a[204:207]
    v_mfma_f32_16x16x32_bf16 a[204:207], a[124:127], v[92:95], a[204:207]
    s_waitcnt vmcnt(22)
    v_mfma_f32_16x16x32_bf16 a[208:211], a[96:99], v[24:27], a[208:211]
    v_mfma_f32_16x16x32_bf16 a[208:211], a[112:115], v[28:31], a[208:211]
    buffer_load_dwordx4 v[88:91], v6, s[12:15], s6 offen sc1
    v_mfma_f32_16x16x32_bf16 a[212:215], a[100:103], v[24:27], a[212:215]
    v_mfma_f32_16x16x32_bf16 a[212:215], a[116:119], v[28:31], a[212:215]
    v_mfma_f32_16x16x32_bf16 a[216:219], a[104:107], v[24:27], a[216:219]
    v_mfma_f32_16x16x32_bf16 a[216:219], a[120:123], v[28:31], a[216:219]
    buffer_load_dwordx4 v[92:95], v6, s[12:15], s7 offen sc1
    v_mfma_f32_16x16x32_bf16 a[220:223], a[108:111], v[24:27], a[220:223]
    v_mfma_f32_16x16x32_bf16 a[220:223], a[124:127], v[28:31], a[220:223]
    s_waitcnt vmcnt(22)
    v_mfma_f32_16x16x32_bf16 a[224:227], a[96:99], v[32:35], a[224:227]
    v_mfma_f32_16x16x32_bf16 a[224:227], a[112:115], v[36:39], a[224:227]
    buffer_load_dwordx4 v[24:27], v7, s[12:15], s6 offen sc1
    v_mfma_f32_16x16x32_bf16 a[228:231], a[100:103], v[32:35], a[228:231]
    v_mfma_f32_16x16x32_bf16 a[228:231], a[116:119], v[36:39], a[228:231]
    v_mfma_f32_16x16x32_bf16 a[232:235], a[104:107], v[32:35], a[232:235]
    v_mfma_f32_16x16x32_bf16 a[232:235], a[120:123], v[36:39], a[232:235]
    buffer_load_dwordx4 v[28:31], v7, s[12:15], s7 offen sc1
    v_mfma_f32_16x16x32_bf16 a[236:239], a[108:111], v[32:35], a[236:239]
    v_mfma_f32_16x16x32_bf16 a[236:239], a[124:127], v[36:39], a[236:239]
    s_waitcnt vmcnt(18) lgkmcnt(0)
    v_mfma_f32_16x16x32_bf16 a[160:163], a[128:131], v[40:43], a[160:163]
    ds_read_b64_tr_b16 a[96:97], v11 offset:49152
    ds_read_b64_tr_b16 a[98:99], v11 offset:51200
    v_mfma_f32_16x16x32_bf16 a[160:163], a[144:147], v[44:47], a[160:163]
    buffer_load_dwordx4 v[32:35], v8, s[12:15], s6 offen sc1
    v_mfma_f32_16x16x32_bf16 a[164:167], a[132:135], v[40:43], a[164:167]
    ds_read_b64_tr_b16 a[100:101], v12 offset:49152
    ds_read_b64_tr_b16 a[102:103], v12 offset:51200
    v_mfma_f32_16x16x32_bf16 a[164:167], a[148:151], v[44:47], a[164:167]
    ds_read_b64_tr_b16 a[104:105], v11 offset:49664
    ds_read_b64_tr_b16 a[106:107], v11 offset:51712
    v_mfma_f32_16x16x32_bf16 a[168:171], a[136:139], v[40:43], a[168:171]
    ds_read_b64_tr_b16 a[108:109], v12 offset:49664
    ds_read_b64_tr_b16 a[110:111], v12 offset:51712
    v_mfma_f32_16x16x32_bf16 a[168:171], a[152:155], v[44:47], a[168:171]
    buffer_load_dwordx4 v[36:39], v8, s[12:15], s7 offen sc1
    v_mfma_f32_16x16x32_bf16 a[172:175], a[140:143], v[40:43], a[172:175]
    ds_read_b64_tr_b16 a[112:113], v11 offset:32768
    ds_read_b64_tr_b16 a[114:115], v11 offset:34816
    v_mfma_f32_16x16x32_bf16 a[172:175], a[156:159], v[44:47], a[172:175]
    s_waitcnt vmcnt(14)
    v_mfma_f32_16x16x32_bf16 a[176:179], a[128:131], v[48:51], a[176:179]
    ds_read_b64_tr_b16 a[116:117], v12 offset:32768
    ds_read_b64_tr_b16 a[118:119], v12 offset:34816
    v_mfma_f32_16x16x32_bf16 a[176:179], a[144:147], v[52:55], a[176:179]
    buffer_load_dwordx4 v[40:43], v9, s[12:15], s6 offen sc1
    v_mfma_f32_16x16x32_bf16 a[180:183], a[132:135], v[48:51], a[180:183]
    ds_read_b64_tr_b16 a[120:121], v11 offset:33280
    ds_read_b64_tr_b16 a[122:123], v11 offset:35328
    v_mfma_f32_16x16x32_bf16 a[180:183], a[148:151], v[52:55], a[180:183]
    ds_read_b64_tr_b16 a[124:125], v12 offset:33280
    ds_read_b64_tr_b16 a[126:127], v12 offset:35328
    v_mfma_f32_16x16x32_bf16 a[184:187], a[136:139], v[48:51], a[184:187]
    v_mfma_f32_16x16x32_bf16 a[184:187], a[152:155], v[52:55], a[184:187]
    buffer_load_dwordx4 v[44:47], v9, s[12:15], s7 offen sc1
    v_mfma_f32_16x16x32_bf16 a[188:191], a[140:143], v[48:51], a[188:191]
    v_mfma_f32_16x16x32_bf16 a[188:191], a[156:159], v[52:55], a[188:191]
    s_waitcnt vmcnt(14)
    v_mfma_f32_16x16x32_bf16 a[192:195], a[128:131], v[56:59], a[192:195]
    v_mfma_f32_16x16x32_bf16 a[192:195], a[144:147], v[60:63], a[192:195]
    s_add_u32 s40, s28, 8192
    buffer_load_dwordx4 v[48:51], v5, s[12:15], s40 offen sc1
    v_mfma_f32_16x16x32_bf16 a[196:199], a[132:135], v[56:59], a[196:199]
    v_mfma_f32_16x16x32_bf16 a[196:199], a[148:151], v[60:63], a[196:199]
    v_mfma_f32_16x16x32_bf16 a[200:203], a[136:139], v[56:59], a[200:203]
    v_mfma_f32_16x16x32_bf16 a[200:203], a[152:155], v[60:63], a[200:203]
    s_add_u32 s41, s29, 8192
    buffer_load_dwordx4 v[52:55], v5, s[12:15], s41 offen sc1
    v_mfma_f32_16x16x32_bf16 a[204:207], a[140:143], v[56:59], a[204:207]
    v_mfma_f32_16x16x32_bf16 a[204:207], a[156:159], v[60:63], a[204:207]
    s_waitcnt vmcnt(14)
    v_mfma_f32_16x16x32_bf16 a[208:211], a[128:131], v[64:67], a[208:211]
    v_mfma_f32_16x16x32_bf16 a[208:211], a[144:147], v[68:71], a[208:211]
    buffer_load_dwordx4 v[56:59], v6, s[12:15], s40 offen sc1
    v_mfma_f32_16x16x32_bf16 a[212:215], a[132:135], v[64:67], a[212:215]
    v_mfma_f32_16x16x32_bf16 a[212:215], a[148:151], v[68:71], a[212:215]
    v_mfma_f32_16x16x32_bf16 a[216:219], a[136:139], v[64:67], a[216:219]
    v_mfma_f32_16x16x32_bf16 a[216:219], a[152:155], v[68:71], a[216:219]
    buffer_load_dwordx4 v[60:63], v6, s[12:15], s41 offen sc1
    v_mfma_f32_16x16x32_bf16 a[220:223], a[140:143], v[64:67], a[220:223]
    v_mfma_f32_16x16x32_bf16 a[220:223], a[156:159], v[68:71], a[220:223]
    s_waitcnt vmcnt(14)
    v_mfma_f32_16x16x32_bf16 a[224:227], a[128:131], v[72:75], a[224:227]
    v_mfma_f32_16x16x32_bf16 a[224:227], a[144:147], v[76:79], a[224:227]
    buffer_load_dwordx4 v[64:67], v7, s[12:15], s40 offen sc1
    v_mfma_f32_16x16x32_bf16 a[228:231], a[132:135], v[72:75], a[228:231]
    v_mfma_f32_16x16x32_bf16 a[228:231], a[148:151], v[76:79], a[228:231]
    v_mfma_f32_16x16x32_bf16 a[232:235], a[136:139], v[72:75], a[232:235]
    v_mfma_f32_16x16x32_bf16 a[232:235], a[152:155], v[76:79], a[232:235]
    buffer_load_dwordx4 v[68:71], v7, s[12:15], s41 offen sc1
    v_mfma_f32_16x16x32_bf16 a[236:239], a[140:143], v[72:75], a[236:239]
    v_mfma_f32_16x16x32_bf16 a[236:239], a[156:159], v[76:79], a[236:239]
    s_waitcnt vmcnt(14) lgkmcnt(0)
    v_mfma_f32_16x16x32_bf16 a[160:163], v[96:99], v[80:83], a[160:163]
    ds_read_b64_tr_b16 a[128:129], v11 offset:0
    ds_read_b64_tr_b16 a[130:131], v11 offset:2048
    v_mfma_f32_16x16x32_bf16 a[160:163], v[112:115], v[84:87], a[160:163]
    buffer_load_dwordx4 v[72:75], v8, s[12:15], s40 offen sc1
    v_mfma_f32_16x16x32_bf16 a[164:167], v[100:103], v[80:83], a[164:167]
    ds_read_b64_tr_b16 a[132:133], v12 offset:0
    ds_read_b64_tr_b16 a[134:135], v12 offset:2048
    v_mfma_f32_16x16x32_bf16 a[164:167], v[116:119], v[84:87], a[164:167]
    ds_read_b64_tr_b16 a[136:137], v11 offset:512
    ds_read_b64_tr_b16 a[138:139], v11 offset:2560
    v_mfma_f32_16x16x32_bf16 a[168:171], v[104:107], v[80:83], a[168:171]
    ds_read_b64_tr_b16 a[140:141], v12 offset:512
    ds_read_b64_tr_b16 a[142:143], v12 offset:2560
    v_mfma_f32_16x16x32_bf16 a[168:171], v[120:123], v[84:87], a[168:171]
    buffer_load_dwordx4 v[76:79], v8, s[12:15], s41 offen sc1
    v_mfma_f32_16x16x32_bf16 a[172:175], v[108:111], v[80:83], a[172:175]
    ds_read_b64_tr_b16 a[144:145], v13 offset:16384
    ds_read_b64_tr_b16 a[146:147], v13 offset:18432
    v_mfma_f32_16x16x32_bf16 a[172:175], v[124:127], v[84:87], a[172:175]
    s_waitcnt vmcnt(14)
    v_mfma_f32_16x16x32_bf16 a[176:179], v[96:99], v[88:91], a[176:179]
    ds_read_b64_tr_b16 a[148:149], v14 offset:16384
    ds_read_b64_tr_b16 a[150:151], v14 offset:18432
    v_mfma_f32_16x16x32_bf16 a[176:179], v[112:115], v[92:95], a[176:179]
    buffer_load_dwordx4 v[80:83], v9, s[12:15], s40 offen sc1
    v_mfma_f32_16x16x32_bf16 a[180:183], v[100:103], v[88:91], a[180:183]
    ds_read_b64_tr_b16 a[152:153], v13 offset:16896
    ds_read_b64_tr_b16 a[154:155], v13 offset:18944
    v_mfma_f32_16x16x32_bf16 a[180:183], v[116:119], v[92:95], a[180:183]
    ds_read_b64_tr_b16 a[156:157], v14 offset:16896
    ds_read_b64_tr_b16 a[158:159], v14 offset:18944
    v_mfma_f32_16x16x32_bf16 a[184:187], v[104:107], v[88:91], a[184:187]
    v_mfma_f32_16x16x32_bf16 a[184:187], v[120:123], v[92:95], a[184:187]
    buffer_load_dwordx4 v[84:87], v9, s[12:15], s41 offen sc1
    v_mfma_f32_16x16x32_bf16 a[188:191], v[108:111], v[88:91], a[188:191]
    v_mfma_f32_16x16x32_bf16 a[188:191], v[124:127], v[92:95], a[188:191]
    s_waitcnt vmcnt(14)
    v_mfma_f32_16x16x32_bf16 a[192:195], v[96:99], v[24:27], a[192:195]
    v_mfma_f32_16x16x32_bf16 a[192:195], v[112:115], v[28:31], a[192:195]
    s_add_u32 s43, s30, 8192
    buffer_load_dwordx4 v[88:91], v5, s[12:15], s43 offen sc1
    v_mfma_f32_16x16x32_bf16 a[196:199], v[100:103], v[24:27], a[196:199]
    v_mfma_f32_16x16x32_bf16 a[196:199], v[116:119], v[28:31], a[196:199]
    v_mfma_f32_16x16x32_bf16 a[200:203], v[104:107], v[24:27], a[200:203]
    v_mfma_f32_16x16x32_bf16 a[200:203], v[120:123], v[28:31], a[200:203]
    s_add_u32 s100, s31, 8192
    buffer_load_dwordx4 v[92:95], v5, s[12:15], s100 offen sc1
    v_mfma_f32_16x16x32_bf16 a[204:207], v[108:111], v[24:27], a[204:207]
    v_mfma_f32_16x16x32_bf16 a[204:207], v[124:127], v[28:31], a[204:207]
    s_waitcnt vmcnt(14)
    v_mfma_f32_16x16x32_bf16 a[208:211], v[96:99], v[32:35], a[208:211]
    v_mfma_f32_16x16x32_bf16 a[208:211], v[112:115], v[36:39], a[208:211]
    buffer_load_dwordx4 v[24:27], v6, s[12:15], s43 offen sc1
    v_mfma_f32_16x16x32_bf16 a[212:215], v[100:103], v[32:35], a[212:215]
    v_mfma_f32_16x16x32_bf16 a[212:215], v[116:119], v[36:39], a[212:215]
    v_mfma_f32_16x16x32_bf16 a[216:219], v[104:107], v[32:35], a[216:219]
    v_mfma_f32_16x16x32_bf16 a[216:219], v[120:123], v[36:39], a[216:219]
    buffer_load_dwordx4 v[28:31], v6, s[12:15], s100 offen sc1
    v_mfma_f32_16x16x32_bf16 a[220:223], v[108:111], v[32:35], a[220:223]
    v_mfma_f32_16x16x32_bf16 a[220:223], v[124:127], v[36:39], a[220:223]
    s_waitcnt vmcnt(14)
    v_mfma_f32_16x16x32_bf16 a[224:227], v[96:99], v[40:43], a[224:227]
    v_mfma_f32_16x16x32_bf16 a[224:227], v[112:115], v[44:47], a[224:227]
    buffer_load_dwordx4 v[32:35], v7, s[12:15], s43 offen sc1
    v_mfma_f32_16x16x32_bf16 a[228:231], v[100:103], v[40:43], a[228:231]
    v_mfma_f32_16x16x32_bf16 a[228:231], v[116:119], v[44:47], a[228:231]
    v_mfma_f32_16x16x32_bf16 a[232:235], v[104:107], v[40:43], a[232:235]
    v_mfma_f32_16x16x32_bf16 a[232:235], v[120:123], v[44:47], a[232:235]
    buffer_load_dwordx4 v[36:39], v7, s[12:15], s100 offen sc1
    v_mfma_f32_16x16x32_bf16 a[236:239], v[108:111], v[40:43], a[236:239]
    v_mfma_f32_16x16x32_bf16 a[236:239], v[124:127], v[44:47], a[236:239]
    s_waitcnt vmcnt(14) lgkmcnt(0)
    v_mfma_f32_16x16x32_bf16 a[160:163], v[128:131], v[48:51], a[160:163]
    ds_read_b64_tr_b16 v[96:97], v13 offset:32768
    ds_read_b64_tr_b16 v[98:99], v13 offset:34816
    v_mfma_f32_16x16x32_bf16 a[160:163], v[144:147], v[52:55], a[160:163]
    buffer_load_dwordx4 v[40:43], v8, s[12:15], s43 offen sc1
    v_mfma_f32_16x16x32_bf16 a[164:167], v[132:135], v[48:51], a[164:167]
    ds_read_b64_tr_b16 v[100:101], v14 offset:32768
    ds_read_b64_tr_b16 v[102:103], v14 offset:34816
    v_mfma_f32_16x16x32_bf16 a[164:167], v[148:151], v[52:55], a[164:167]
    ds_read_b64_tr_b16 v[104:105], v13 offset:33280
    ds_read_b64_tr_b16 v[106:107], v13 offset:35328
    v_mfma_f32_16x16x32_bf16 a[168:171], v[136:139], v[48:51], a[168:171]
    ds_read_b64_tr_b16 v[108:109], v14 offset:33280
    ds_read_b64_tr_b16 v[110:111], v14 offset:35328
    v_mfma_f32_16x16x32_bf16 a[168:171], v[152:155], v[52:55], a[168:171]
    buffer_load_dwordx4 v[44:47], v8, s[12:15], s100 offen sc1
    v_mfma_f32_16x16x32_bf16 a[172:175], v[140:143], v[48:51], a[172:175]
    ds_read_b64_tr_b16 v[112:113], v13 offset:49152
    ds_read_b64_tr_b16 v[114:115], v13 offset:51200
    v_mfma_f32_16x16x32_bf16 a[172:175], v[156:159], v[52:55], a[172:175]
    s_waitcnt vmcnt(14)
    v_mfma_f32_16x16x32_bf16 a[176:179], v[128:131], v[56:59], a[176:179]
    ds_read_b64_tr_b16 v[116:117], v14 offset:49152
    ds_read_b64_tr_b16 v[118:119], v14 offset:51200
    v_mfma_f32_16x16x32_bf16 a[176:179], v[144:147], v[60:63], a[176:179]
    buffer_load_dwordx4 v[48:51], v9, s[12:15], s43 offen sc1
    v_mfma_f32_16x16x32_bf16 a[180:183], v[132:135], v[56:59], a[180:183]
    ds_read_b64_tr_b16 v[120:121], v13 offset:49664
    ds_read_b64_tr_b16 v[122:123], v13 offset:51712
    v_mfma_f32_16x16x32_bf16 a[180:183], v[148:151], v[60:63], a[180:183]
    ds_read_b64_tr_b16 v[124:125], v14 offset:49664
    ds_read_b64_tr_b16 v[126:127], v14 offset:51712
    v_mfma_f32_16x16x32_bf16 a[184:187], v[136:139], v[56:59], a[184:187]
    v_mfma_f32_16x16x32_bf16 a[184:187], v[152:155], v[60:63], a[184:187]
    buffer_load_dwordx4 v[52:55], v9, s[12:15], s100 offen sc1
    v_mfma_f32_16x16x32_bf16 a[188:191], v[140:143], v[56:59], a[188:191]
    v_mfma_f32_16x16x32_bf16 a[188:191], v[156:159], v[60:63], a[188:191]
    s_waitcnt vmcnt(14)
    v_mfma_f32_16x16x32_bf16 a[192:195], v[128:131], v[64:67], a[192:195]
    v_mfma_f32_16x16x32_bf16 a[192:195], v[144:147], v[68:71], a[192:195]
    s_add_u32 s4, s24, 16384
    buffer_load_dwordx4 v[56:59], v5, s[12:15], s4 offen sc1
    v_mfma_f32_16x16x32_bf16 a[196:199], v[132:135], v[64:67], a[196:199]
    v_mfma_f32_16x16x32_bf16 a[196:199], v[148:151], v[68:71], a[196:199]
    v_mfma_f32_16x16x32_bf16 a[200:203], v[136:139], v[64:67], a[200:203]
    v_mfma_f32_16x16x32_bf16 a[200:203], v[152:155], v[68:71], a[200:203]
    s_add_u32 s5, s25, 16384
    buffer_load_dwordx4 v[60:63], v5, s[12:15], s5 offen sc1
    v_mfma_f32_16x16x32_bf16 a[204:207], v[140:143], v[64:67], a[204:207]
    v_mfma_f32_16x16x32_bf16 a[204:207], v[156:159], v[68:71], a[204:207]
    s_waitcnt vmcnt(14)
    v_mfma_f32_16x16x32_bf16 a[208:211], v[128:131], v[72:75], a[208:211]
    v_mfma_f32_16x16x32_bf16 a[208:211], v[144:147], v[76:79], a[208:211]
    buffer_load_dwordx4 v[64:67], v6, s[12:15], s4 offen sc1
    v_mfma_f32_16x16x32_bf16 a[212:215], v[132:135], v[72:75], a[212:215]
    v_mfma_f32_16x16x32_bf16 a[212:215], v[148:151], v[76:79], a[212:215]
    v_mfma_f32_16x16x32_bf16 a[216:219], v[136:139], v[72:75], a[216:219]
    v_mfma_f32_16x16x32_bf16 a[216:219], v[152:155], v[76:79], a[216:219]
    buffer_load_dwordx4 v[68:71], v6, s[12:15], s5 offen sc1
    v_mfma_f32_16x16x32_bf16 a[220:223], v[140:143], v[72:75], a[220:223]
    v_mfma_f32_16x16x32_bf16 a[220:223], v[156:159], v[76:79], a[220:223]
    s_waitcnt vmcnt(14)
    v_mfma_f32_16x16x32_bf16 a[224:227], v[128:131], v[80:83], a[224:227]
    v_mfma_f32_16x16x32_bf16 a[224:227], v[144:147], v[84:87], a[224:227]
    buffer_load_dwordx4 v[72:75], v7, s[12:15], s4 offen sc1
    v_mfma_f32_16x16x32_bf16 a[228:231], v[132:135], v[80:83], a[228:231]
    v_mfma_f32_16x16x32_bf16 a[228:231], v[148:151], v[84:87], a[228:231]
    v_mfma_f32_16x16x32_bf16 a[232:235], v[136:139], v[80:83], a[232:235]
    v_mfma_f32_16x16x32_bf16 a[232:235], v[152:155], v[84:87], a[232:235]
    buffer_load_dwordx4 v[76:79], v7, s[12:15], s5 offen sc1
    v_mfma_f32_16x16x32_bf16 a[236:239], v[140:143], v[80:83], a[236:239]
    v_mfma_f32_16x16x32_bf16 a[236:239], v[156:159], v[84:87], a[236:239]
    s_waitcnt vmcnt(14) lgkmcnt(0)
    v_mfma_f32_16x16x32_bf16 a[160:163], v[160:163], v[88:91], a[160:163]
    v_mfma_f32_16x16x32_bf16 a[160:163], v[176:179], v[92:95], a[160:163]
    buffer_load_dwordx4 v[80:83], v8, s[12:15], s4 offen sc1
    v_mfma_f32_16x16x32_bf16 a[164:167], v[164:167], v[88:91], a[164:167]
    v_mfma_f32_16x16x32_bf16 a[164:167], v[180:183], v[92:95], a[164:167]
    v_mfma_f32_16x16x32_bf16 a[168:171], v[168:171], v[88:91], a[168:171]
    v_mfma_f32_16x16x32_bf16 a[168:171], v[184:187], v[92:95], a[168:171]
    buffer_load_dwordx4 v[84:87], v8, s[12:15], s5 offen sc1
    v_mfma_f32_16x16x32_bf16 a[172:175], v[172:175], v[88:91], a[172:175]
    v_mfma_f32_16x16x32_bf16 a[172:175], v[188:191], v[92:95], a[172:175]
    s_waitcnt vmcnt(14)
    v_mfma_f32_16x16x32_bf16 a[176:179], v[160:163], v[24:27], a[176:179]
    v_mfma_f32_16x16x32_bf16 a[176:179], v[176:179], v[28:31], a[176:179]
    buffer_load_dwordx4 v[88:91], v9, s[12:15], s4 offen sc1
    v_mfma_f32_16x16x32_bf16 a[180:183], v[164:167], v[24:27], a[180:183]
    v_mfma_f32_16x16x32_bf16 a[180:183], v[180:183], v[28:31], a[180:183]
    v_mfma_f32_16x16x32_bf16 a[184:187], v[168:171], v[24:27], a[184:187]
    v_mfma_f32_16x16x32_bf16 a[184:187], v[184:187], v[28:31], a[184:187]
    buffer_load_dwordx4 v[92:95], v9, s[12:15], s5 offen sc1
    v_mfma_f32_16x16x32_bf16 a[188:191], v[172:175], v[24:27], a[188:191]
    v_mfma_f32_16x16x32_bf16 a[188:191], v[188:191], v[28:31], a[188:191]
    s_waitcnt vmcnt(14)
    v_mfma_f32_16x16x32_bf16 a[192:195], v[160:163], v[32:35], a[192:195]
    v_mfma_f32_16x16x32_bf16 a[192:195], v[176:179], v[36:39], a[192:195]
    s_add_u32 s6, s26, 16384
    buffer_load_dwordx4 v[24:27], v5, s[12:15], s6 offen sc1
    v_mfma_f32_16x16x32_bf16 a[196:199], v[164:167], v[32:35], a[196:199]
    v_mfma_f32_16x16x32_bf16 a[196:199], v[180:183], v[36:39], a[196:199]
    v_mfma_f32_16x16x32_bf16 a[200:203], v[168:171], v[32:35], a[200:203]
    v_mfma_f32_16x16x32_bf16 a[200:203], v[184:187], v[36:39], a[200:203]
    s_add_u32 s7, s27, 16384
    buffer_load_dwordx4 v[28:31], v5, s[12:15], s7 offen sc1
    v_mfma_f32_16x16x32_bf16 a[204:207], v[172:175], v[32:35], a[204:207]
    v_mfma_f32_16x16x32_bf16 a[204:207], v[188:191], v[36:39], a[204:207]
    s_waitcnt vmcnt(14)
    v_mfma_f32_16x16x32_bf16 a[208:211], v[160:163], v[40:43], a[208:211]
    v_mfma_f32_16x16x32_bf16 a[208:211], v[176:179], v[44:47], a[208:211]
    buffer_load_dwordx4 v[32:35], v6, s[12:15], s6 offen sc1
    v_mfma_f32_16x16x32_bf16 a[212:215], v[164:167], v[40:43], a[212:215]
    v_mfma_f32_16x16x32_bf16 a[212:215], v[180:183], v[44:47], a[212:215]
    v_mfma_f32_16x16x32_bf16 a[216:219], v[168:171], v[40:43], a[216:219]
    v_mfma_f32_16x16x32_bf16 a[216:219], v[184:187], v[44:47], a[216:219]
    buffer_load_dwordx4 v[36:39], v6, s[12:15], s7 offen sc1
    v_mfma_f32_16x16x32_bf16 a[220:223], v[172:175], v[40:43], a[220:223]
    v_mfma_f32_16x16x32_bf16 a[220:223], v[188:191], v[44:47], a[220:223]
    s_waitcnt vmcnt(14)
    v_mfma_f32_16x16x32_bf16 a[224:227], v[160:163], v[48:51], a[224:227]
    v_mfma_f32_16x16x32_bf16 a[224:227], v[176:179], v[52:55], a[224:227]
    buffer_load_dwordx4 v[40:43], v7, s[12:15], s6 offen sc1
    v_mfma_f32_16x16x32_bf16 a[228:231], v[164:167], v[48:51], a[228:231]
    v_mfma_f32_16x16x32_bf16 a[228:231], v[180:183], v[52:55], a[228:231]
    v_mfma_f32_16x16x32_bf16 a[232:235], v[168:171], v[48:51], a[232:235]
    v_mfma_f32_16x16x32_bf16 a[232:235], v[184:187], v[52:55], a[232:235]
    buffer_load_dwordx4 v[44:47], v7, s[12:15], s7 offen sc1
    v_mfma_f32_16x16x32_bf16 a[236:239], v[172:175], v[48:51], a[236:239]
    v_mfma_f32_16x16x32_bf16 a[236:239], v[188:191], v[52:55], a[236:239]
    s_waitcnt vmcnt(14) lgkmcnt(0)
    v_mfma_f32_16x16x32_bf16 a[160:163], v[192:195], v[56:59], a[160:163]
    v_mfma_f32_16x16x32_bf16 a[160:163], v[208:211], v[60:63], a[160:163]
    buffer_load_dwordx4 v[48:51], v8, s[12:15], s6 offen sc1
    v_mfma_f32_16x16x32_bf16 a[164:167], v[196:199], v[56:59], a[164:167]
    v_mfma_f32_16x16x32_bf16 a[164:167], v[212:215], v[60:63], a[164:167]
    v_mfma_f32_16x16x32_bf16 a[168:171], v[200:203], v[56:59], a[168:171]
    v_mfma_f32_16x16x32_bf16 a[168:171], v[216:219], v[60:63], a[168:171]
    buffer_load_dwordx4 v[52:55], v8, s[12:15], s7 offen sc1
    v_mfma_f32_16x16x32_bf16 a[172:175], v[204:207], v[56:59], a[172:175]
    v_mfma_f32_16x16x32_bf16 a[172:175], v[220:223], v[60:63], a[172:175]
    s_waitcnt vmcnt(14)
    v_mfma_f32_16x16x32_bf16 a[176:179], v[192:195], v[64:67], a[176:179]
    v_mfma_f32_16x16x32_bf16 a[176:179], v[208:211], v[68:71], a[176:179]
    buffer_load_dwordx4 v[56:59], v9, s[12:15], s6 offen sc1
    v_mfma_f32_16x16x32_bf16 a[180:183], v[196:199], v[64:67], a[180:183]
    v_mfma_f32_16x16x32_bf16 a[180:183], v[212:215], v[68:71], a[180:183]
    v_mfma_f32_16x16x32_bf16 a[184:187], v[200:203], v[64:67], a[184:187]
    v_mfma_f32_16x16x32_bf16 a[184:187], v[216:219], v[68:71], a[184:187]
    buffer_load_dwordx4 v[60:63], v9, s[12:15], s7 offen sc1
    v_mfma_f32_16x16x32_bf16 a[188:191], v[204:207], v[64:67], a[188:191]
    v_mfma_f32_16x16x32_bf16 a[188:191], v[220:223], v[68:71], a[188:191]
    s_waitcnt vmcnt(14)
    v_mfma_f32_16x16x32_bf16 a[192:195], v[192:195], v[72:75], a[192:195]
    v_mfma_f32_16x16x32_bf16 a[192:195], v[208:211], v[76:79], a[192:195]
    s_add_u32 s40, s28, 16384
    buffer_load_dwordx4 v[64:67], v5, s[12:15], s40 offen sc1
    v_mfma_f32_16x16x32_bf16 a[196:199], v[196:199], v[72:75], a[196:199]
    v_mfma_f32_16x16x32_bf16 a[196:199], v[212:215], v[76:79], a[196:199]
    v_mfma_f32_16x16x32_bf16 a[200:203], v[200:203], v[72:75], a[200:203]
    v_mfma_f32_16x16x32_bf16 a[200:203], v[216:219], v[76:79], a[200:203]
    s_add_u32 s41, s29, 16384
    buffer_load_dwordx4 v[68:71], v5, s[12:15], s41 offen sc1
    v_mfma_f32_16x16x32_bf16 a[204:207], v[204:207], v[72:75], a[204:207]
    v_mfma_f32_16x16x32_bf16 a[204:207], v[220:223], v[76:79], a[204:207]
    s_waitcnt vmcnt(14)
    v_mfma_f32_16x16x32_bf16 a[208:211], v[192:195], v[80:83], a[208:211]
    v_mfma_f32_16x16x32_bf16 a[208:211], v[208:211], v[84:87], a[208:211]
    buffer_load_dwordx4 v[72:75], v6, s[12:15], s40 offen sc1
    v_mfma_f32_16x16x32_bf16 a[212:215], v[196:199], v[80:83], a[212:215]
    v_mfma_f32_16x16x32_bf16 a[212:215], v[212:215], v[84:87], a[212:215]
    v_mfma_f32_16x16x32_bf16 a[216:219], v[200:203], v[80:83], a[216:219]
    v_mfma_f32_16x16x32_bf16 a[216:219], v[216:219], v[84:87], a[216:219]
    buffer_load_dwordx4 v[76:79], v6, s[12:15], s41 offen sc1
    v_mfma_f32_16x16x32_bf16 a[220:223], v[204:207], v[80:83], a[220:223]
    v_mfma_f32_16x16x32_bf16 a[220:223], v[220:223], v[84:87], a[220:223]
    s_waitcnt vmcnt(14)
    v_mfma_f32_16x16x32_bf16 a[224:227], v[192:195], v[88:91], a[224:227]
    v_mfma_f32_16x16x32_bf16 a[224:227], v[208:211], v[92:95], a[224:227]
    buffer_load_dwordx4 v[80:83], v7, s[12:15], s40 offen sc1
    v_mfma_f32_16x16x32_bf16 a[228:231], v[196:199], v[88:91], a[228:231]
    v_mfma_f32_16x16x32_bf16 a[228:231], v[212:215], v[92:95], a[228:231]
    v_mfma_f32_16x16x32_bf16 a[232:235], v[200:203], v[88:91], a[232:235]
    v_mfma_f32_16x16x32_bf16 a[232:235], v[216:219], v[92:95], a[232:235]
    buffer_load_dwordx4 v[84:87], v7, s[12:15], s41 offen sc1
    v_mfma_f32_16x16x32_bf16 a[236:239], v[204:207], v[88:91], a[236:239]
    v_mfma_f32_16x16x32_bf16 a[236:239], v[220:223], v[92:95], a[236:239]
    s_waitcnt vmcnt(14) lgkmcnt(0)
    v_mfma_f32_16x16x32_bf16 a[160:163], a[0:3], v[24:27], a[160:163]
    v_mfma_f32_16x16x32_bf16 a[160:163], a[16:19], v[28:31], a[160:163]
    buffer_load_dwordx4 v[88:91], v8, s[12:15], s40 offen sc1
    v_mfma_f32_16x16x32_bf16 a[164:167], a[4:7], v[24:27], a[164:167]
    v_mfma_f32_16x16x32_bf16 a[164:167], a[20:23], v[28:31], a[164:167]
    v_mfma_f32_16x16x32_bf16 a[168:171], a[8:11], v[24:27], a[168:171]
    v_mfma_f32_16x16x32_bf16 a[168:171], a[24:27], v[28:31], a[168:171]
    buffer_load_dwordx4 v[92:95], v8, s[12:15], s41 offen sc1
    v_mfma_f32_16x16x32_bf16 a[172:175], a[12:15], v[24:27], a[172:175]
    v_mfma_f32_16x16x32_bf16 a[172:175], a[28:31], v[28:31], a[172:175]
    s_waitcnt vmcnt(14)
    v_mfma_f32_16x16x32_bf16 a[176:179], a[0:3], v[32:35], a[176:179]
    v_mfma_f32_16x16x32_bf16 a[176:179], a[16:19], v[36:39], a[176:179]
    buffer_load_dwordx4 v[24:27], v9, s[12:15], s40 offen sc1
    v_mfma_f32_16x16x32_bf16 a[180:183], a[4:7], v[32:35], a[180:183]
    v_mfma_f32_16x16x32_bf16 a[180:183], a[20:23], v[36:39], a[180:183]
    v_mfma_f32_16x16x32_bf16 a[184:187], a[8:11], v[32:35], a[184:187]
    v_mfma_f32_16x16x32_bf16 a[184:187], a[24:27], v[36:39], a[184:187]
    buffer_load_dwordx4 v[28:31], v9, s[12:15], s41 offen sc1
    v_mfma_f32_16x16x32_bf16 a[188:191], a[12:15], v[32:35], a[188:191]
    v_mfma_f32_16x16x32_bf16 a[188:191], a[28:31], v[36:39], a[188:191]
    s_waitcnt vmcnt(14)
    v_mfma_f32_16x16x32_bf16 a[192:195], a[0:3], v[40:43], a[192:195]
    v_mfma_f32_16x16x32_bf16 a[192:195], a[16:19], v[44:47], a[192:195]
    s_add_u32 s43, s30, 16384
    buffer_load_dwordx4 v[32:35], v5, s[12:15], s43 offen sc1
    v_mfma_f32_16x16x32_bf16 a[196:199], a[4:7], v[40:43], a[196:199]
    v_mfma_f32_16x16x32_bf16 a[196:199], a[20:23], v[44:47], a[196:199]
    v_mfma_f32_16x16x32_bf16 a[200:203], a[8:11], v[40:43], a[200:203]
    v_mfma_f32_16x16x32_bf16 a[200:203], a[24:27], v[44:47], a[200:203]
    s_add_u32 s100, s31, 16384
    buffer_load_dwordx4 v[36:39], v5, s[12:15], s100 offen sc1
    v_mfma_f32_16x16x32_bf16 a[204:207], a[12:15], v[40:43], a[204:207]
    v_mfma_f32_16x16x32_bf16 a[204:207], a[28:31], v[44:47], a[204:207]
    s_waitcnt vmcnt(14)
    v_mfma_f32_16x16x32_bf16 a[208:211], a[0:3], v[48:51], a[208:211]
    v_mfma_f32_16x16x32_bf16 a[208:211], a[16:19], v[52:55], a[208:211]
    buffer_load_dwordx4 v[40:43], v6, s[12:15], s43 offen sc1
    v_mfma_f32_16x16x32_bf16 a[212:215], a[4:7], v[48:51], a[212:215]
    v_mfma_f32_16x16x32_bf16 a[212:215], a[20:23], v[52:55], a[212:215]
    v_mfma_f32_16x16x32_bf16 a[216:219], a[8:11], v[48:51], a[216:219]
    v_mfma_f32_16x16x32_bf16 a[216:219], a[24:27], v[52:55], a[216:219]
    buffer_load_dwordx4 v[44:47], v6, s[12:15], s100 offen sc1
    v_mfma_f32_16x16x32_bf16 a[220:223], a[12:15], v[48:51], a[220:223]
    v_mfma_f32_16x16x32_bf16 a[220:223], a[28:31], v[52:55], a[220:223]
    s_waitcnt vmcnt(14)
    v_mfma_f32_16x16x32_bf16 a[224:227], a[0:3], v[56:59], a[224:227]
    v_mfma_f32_16x16x32_bf16 a[224:227], a[16:19], v[60:63], a[224:227]
    buffer_load_dwordx4 v[48:51], v7, s[12:15], s43 offen sc1
    v_mfma_f32_16x16x32_bf16 a[228:231], a[4:7], v[56:59], a[228:231]
    v_mfma_f32_16x16x32_bf16 a[228:231], a[20:23], v[60:63], a[228:231]
    v_mfma_f32_16x16x32_bf16 a[232:235], a[8:11], v[56:59], a[232:235]
    v_mfma_f32_16x16x32_bf16 a[232:235], a[24:27], v[60:63], a[232:235]
    buffer_load_dwordx4 v[52:55], v7, s[12:15], s100 offen sc1
    v_mfma_f32_16x16x32_bf16 a[236:239], a[12:15], v[56:59], a[236:239]
    v_mfma_f32_16x16x32_bf16 a[236:239], a[28:31], v[60:63], a[236:239]
    s_waitcnt vmcnt(14) lgkmcnt(0)
    v_mfma_f32_16x16x32_bf16 a[160:163], v[224:227], v[64:67], a[160:163]
    v_mfma_f32_16x16x32_bf16 a[160:163], v[240:243], v[68:71], a[160:163]
    buffer_load_dwordx4 v[56:59], v8, s[12:15], s43 offen sc1
    v_mfma_f32_16x16x32_bf16 a[164:167], v[228:231], v[64:67], a[164:167]
    v_mfma_f32_16x16x32_bf16 a[164:167], v[244:247], v[68:71], a[164:167]
    v_mfma_f32_16x16x32_bf16 a[168:171], v[232:235], v[64:67], a[168:171]
    v_mfma_f32_16x16x32_bf16 a[168:171], v[248:251], v[68:71], a[168:171]
    buffer_load_dwordx4 v[60:63], v8, s[12:15], s100 offen sc1
    v_mfma_f32_16x16x32_bf16 a[172:175], v[236:239], v[64:67], a[172:175]
    v_mfma_f32_16x16x32_bf16 a[172:175], v[252:255], v[68:71], a[172:175]
    s_waitcnt vmcnt(14)
    v_mfma_f32_16x16x32_bf16 a[176:179], v[224:227], v[72:75], a[176:179]
    v_mfma_f32_16x16x32_bf16 a[176:179], v[240:243], v[76:79], a[176:179]
    buffer_load_dwordx4 v[64:67], v9, s[12:15], s43 offen sc1
    v_mfma_f32_16x16x32_bf16 a[180:183], v[228:231], v[72:75], a[180:183]
    v_mfma_f32_16x16x32_bf16 a[180:183], v[244:247], v[76:79], a[180:183]
    v_mfma_f32_16x16x32_bf16 a[184:187], v[232:235], v[72:75], a[184:187]
    v_mfma_f32_16x16x32_bf16 a[184:187], v[248:251], v[76:79], a[184:187]
    buffer_load_dwordx4 v[68:71], v9, s[12:15], s100 offen sc1
    v_mfma_f32_16x16x32_bf16 a[188:191], v[236:239], v[72:75], a[188:191]
    v_mfma_f32_16x16x32_bf16 a[188:191], v[252:255], v[76:79], a[188:191]
    s_waitcnt vmcnt(14)
    v_mfma_f32_16x16x32_bf16 a[192:195], v[224:227], v[80:83], a[192:195]
    v_mfma_f32_16x16x32_bf16 a[192:195], v[240:243], v[84:87], a[192:195]
    s_add_u32 s4, s24, 24576
    buffer_load_dwordx4 v[72:75], v5, s[12:15], s4 offen sc1
    v_mfma_f32_16x16x32_bf16 a[196:199], v[228:231], v[80:83], a[196:199]
    v_mfma_f32_16x16x32_bf16 a[196:199], v[244:247], v[84:87], a[196:199]
    v_mfma_f32_16x16x32_bf16 a[200:203], v[232:235], v[80:83], a[200:203]
    v_mfma_f32_16x16x32_bf16 a[200:203], v[248:251], v[84:87], a[200:203]
    s_add_u32 s5, s25, 24576
    buffer_load_dwordx4 v[76:79], v5, s[12:15], s5 offen sc1
    v_mfma_f32_16x16x32_bf16 a[204:207], v[236:239], v[80:83], a[204:207]
    v_mfma_f32_16x16x32_bf16 a[204:207], v[252:255], v[84:87], a[204:207]
    s_waitcnt vmcnt(14)
    v_mfma_f32_16x16x32_bf16 a[208:211], v[224:227], v[88:91], a[208:211]
    v_mfma_f32_16x16x32_bf16 a[208:211], v[240:243], v[92:95], a[208:211]
    buffer_load_dwordx4 v[80:83], v6, s[12:15], s4 offen sc1
    v_mfma_f32_16x16x32_bf16 a[212:215], v[228:231], v[88:91], a[212:215]
    v_mfma_f32_16x16x32_bf16 a[212:215], v[244:247], v[92:95], a[212:215]
    v_mfma_f32_16x16x32_bf16 a[216:219], v[232:235], v[88:91], a[216:219]
    v_mfma_f32_16x16x32_bf16 a[216:219], v[248:251], v[92:95], a[216:219]
    buffer_load_dwordx4 v[84:87], v6, s[12:15], s5 offen sc1
    v_mfma_f32_16x16x32_bf16 a[220:223], v[236:239], v[88:91], a[220:223]
    v_mfma_f32_16x16x32_bf16 a[220:223], v[252:255], v[92:95], a[220:223]
    s_waitcnt vmcnt(14)
    v_mfma_f32_16x16x32_bf16 a[224:227], v[224:227], v[24:27], a[224:227]
    v_mfma_f32_16x16x32_bf16 a[224:227], v[240:243], v[28:31], a[224:227]
    buffer_load_dwordx4 v[88:91], v7, s[12:15], s4 offen sc1
    v_mfma_f32_16x16x32_bf16 a[228:231], v[228:231], v[24:27], a[228:231]
    v_mfma_f32_16x16x32_bf16 a[228:231], v[244:247], v[28:31], a[228:231]
    v_mfma_f32_16x16x32_bf16 a[232:235], v[232:235], v[24:27], a[232:235]
    v_mfma_f32_16x16x32_bf16 a[232:235], v[248:251], v[28:31], a[232:235]
    buffer_load_dwordx4 v[92:95], v7, s[12:15], s5 offen sc1
    v_mfma_f32_16x16x32_bf16 a[236:239], v[236:239], v[24:27], a[236:239]
    v_mfma_f32_16x16x32_bf16 a[236:239], v[252:255], v[28:31], a[236:239]
    s_waitcnt vmcnt(14) lgkmcnt(0)
    v_mfma_f32_16x16x32_bf16 a[160:163], a[32:35], v[32:35], a[160:163]
    v_mfma_f32_16x16x32_bf16 a[160:163], a[48:51], v[36:39], a[160:163]
    buffer_load_dwordx4 v[24:27], v8, s[12:15], s4 offen sc1
    v_mfma_f32_16x16x32_bf16 a[164:167], a[36:39], v[32:35], a[164:167]
    v_mfma_f32_16x16x32_bf16 a[164:167], a[52:55], v[36:39], a[164:167]
    v_mfma_f32_16x16x32_bf16 a[168:171], a[40:43], v[32:35], a[168:171]
    v_mfma_f32_16x16x32_bf16 a[168:171], a[56:59], v[36:39], a[168:171]
    buffer_load_dwordx4 v[28:31], v8, s[12:15], s5 offen sc1
    v_mfma_f32_16x16x32_bf16 a[172:175], a[44:47], v[32:35], a[172:175]
    v_mfma_f32_16x16x32_bf16 a[172:175], a[60:63], v[36:39], a[172:175]
    s_waitcnt vmcnt(14)
    v_mfma_f32_16x16x32_bf16 a[176:179], a[32:35], v[40:43], a[176:179]
    v_mfma_f32_16x16x32_bf16 a[176:179], a[48:51], v[44:47], a[176:179]
    buffer_load_dwordx4 v[32:35], v9, s[12:15], s4 offen sc1
    v_mfma_f32_16x16x32_bf16 a[180:183], a[36:39], v[40:43], a[180:183]
    v_mfma_f32_16x16x32_bf16 a[180:183], a[52:55], v[44:47], a[180:183]
    v_mfma_f32_16x16x32_bf16 a[184:187], a[40:43], v[40:43], a[184:187]
    v_mfma_f32_16x16x32_bf16 a[184:187], a[56:59], v[44:47], a[184:187]
    buffer_load_dwordx4 v[36:39], v9, s[12:15], s5 offen sc1
    v_mfma_f32_16x16x32_bf16 a[188:191], a[44:47], v[40:43], a[188:191]
    v_mfma_f32_16x16x32_bf16 a[188:191], a[60:63], v[44:47], a[188:191]
    s_waitcnt vmcnt(14)
    v_mfma_f32_16x16x32_bf16 a[192:195], a[32:35], v[48:51], a[192:195]
    v_mfma_f32_16x16x32_bf16 a[192:195], a[48:51], v[52:55], a[192:195]
    s_add_u32 s6, s26, 24576
    buffer_load_dwordx4 v[40:43], v5, s[12:15], s6 offen sc1
    v_mfma_f32_16x16x32_bf16 a[196:199], a[36:39], v[48:51], a[196:199]
    v_mfma_f32_16x16x32_bf16 a[196:199], a[52:55], v[52:55], a[196:199]
    v_mfma_f32_16x16x32_bf16 a[200:203], a[40:43], v[48:51], a[200:203]
    v_mfma_f32_16x16x32_bf16 a[200:203], a[56:59], v[52:55], a[200:203]
    s_add_u32 s7, s27, 24576
    buffer_load_dwordx4 v[44:47], v5, s[12:15], s7 offen sc1
    v_mfma_f32_16x16x32_bf16 a[204:207], a[44:47], v[48:51], a[204:207]
    v_mfma_f32_16x16x32_bf16 a[204:207], a[60:63], v[52:55], a[204:207]
    s_waitcnt vmcnt(14)
    v_mfma_f32_16x16x32_bf16 a[208:211], a[32:35], v[56:59], a[208:211]
    v_mfma_f32_16x16x32_bf16 a[208:211], a[48:51], v[60:63], a[208:211]
    buffer_load_dwordx4 v[48:51], v6, s[12:15], s6 offen sc1
    v_mfma_f32_16x16x32_bf16 a[212:215], a[36:39], v[56:59], a[212:215]
    v_mfma_f32_16x16x32_bf16 a[212:215], a[52:55], v[60:63], a[212:215]
    v_mfma_f32_16x16x32_bf16 a[216:219], a[40:43], v[56:59], a[216:219]
    v_mfma_f32_16x16x32_bf16 a[216:219], a[56:59], v[60:63], a[216:219]
    buffer_load_dwordx4 v[52:55], v6, s[12:15], s7 offen sc1
    v_mfma_f32_16x16x32_bf16 a[220:223], a[44:47], v[56:59], a[220:223]
    v_mfma_f32_16x16x32_bf16 a[220:223], a[60:63], v[60:63], a[220:223]
    s_waitcnt vmcnt(14)
    v_mfma_f32_16x16x32_bf16 a[224:227], a[32:35], v[64:67], a[224:227]
    v_mfma_f32_16x16x32_bf16 a[224:227], a[48:51], v[68:71], a[224:227]
    buffer_load_dwordx4 v[56:59], v7, s[12:15], s6 offen sc1
    v_mfma_f32_16x16x32_bf16 a[228:231], a[36:39], v[64:67], a[228:231]
    v_mfma_f32_16x16x32_bf16 a[228:231], a[52:55], v[68:71], a[228:231]
    v_mfma_f32_16x16x32_bf16 a[232:235], a[40:43], v[64:67], a[232:235]
    v_mfma_f32_16x16x32_bf16 a[232:235], a[56:59], v[68:71], a[232:235]
    buffer_load_dwordx4 v[60:63], v7, s[12:15], s7 offen sc1
    v_mfma_f32_16x16x32_bf16 a[236:239], a[44:47], v[64:67], a[236:239]
    v_mfma_f32_16x16x32_bf16 a[236:239], a[60:63], v[68:71], a[236:239]
    s_waitcnt vmcnt(14) lgkmcnt(0)
    v_mfma_f32_16x16x32_bf16 a[160:163], a[64:67], v[72:75], a[160:163]
    v_mfma_f32_16x16x32_bf16 a[160:163], a[80:83], v[76:79], a[160:163]
    buffer_load_dwordx4 v[64:67], v8, s[12:15], s6 offen sc1
    v_mfma_f32_16x16x32_bf16 a[164:167], a[68:71], v[72:75], a[164:167]
    v_mfma_f32_16x16x32_bf16 a[164:167], a[84:87], v[76:79], a[164:167]
    v_mfma_f32_16x16x32_bf16 a[168:171], a[72:75], v[72:75], a[168:171]
    v_mfma_f32_16x16x32_bf16 a[168:171], a[88:91], v[76:79], a[168:171]
    buffer_load_dwordx4 v[68:71], v8, s[12:15], s7 offen sc1
    v_mfma_f32_16x16x32_bf16 a[172:175], a[76:79], v[72:75], a[172:175]
    v_mfma_f32_16x16x32_bf16 a[172:175], a[92:95], v[76:79], a[172:175]
    s_waitcnt vmcnt(14)
    v_mfma_f32_16x16x32_bf16 a[176:179], a[64:67], v[80:83], a[176:179]
    v_mfma_f32_16x16x32_bf16 a[176:179], a[80:83], v[84:87], a[176:179]
    buffer_load_dwordx4 v[72:75], v9, s[12:15], s6 offen sc1
    v_mfma_f32_16x16x32_bf16 a[180:183], a[68:71], v[80:83], a[180:183]
    v_mfma_f32_16x16x32_bf16 a[180:183], a[84:87], v[84:87], a[180:183]
    v_mfma_f32_16x16x32_bf16 a[184:187], a[72:75], v[80:83], a[184:187]
    v_mfma_f32_16x16x32_bf16 a[184:187], a[88:91], v[84:87], a[184:187]
    buffer_load_dwordx4 v[76:79], v9, s[12:15], s7 offen sc1
    v_mfma_f32_16x16x32_bf16 a[188:191], a[76:79], v[80:83], a[188:191]
    v_mfma_f32_16x16x32_bf16 a[188:191], a[92:95], v[84:87], a[188:191]
    s_waitcnt vmcnt(14)
    v_mfma_f32_16x16x32_bf16 a[192:195], a[64:67], v[88:91], a[192:195]
    v_mfma_f32_16x16x32_bf16 a[192:195], a[80:83], v[92:95], a[192:195]
    s_add_u32 s40, s28, 24576
    buffer_load_dwordx4 v[80:83], v5, s[12:15], s40 offen sc1
    v_mfma_f32_16x16x32_bf16 a[196:199], a[68:71], v[88:91], a[196:199]
    v_mfma_f32_16x16x32_bf16 a[196:199], a[84:87], v[92:95], a[196:199]
    v_mfma_f32_16x16x32_bf16 a[200:203], a[72:75], v[88:91], a[200:203]
    v_mfma_f32_16x16x32_bf16 a[200:203], a[88:91], v[92:95], a[200:203]
    s_add_u32 s41, s29, 24576
    buffer_load_dwordx4 v[84:87], v5, s[12:15], s41 offen sc1
    v_mfma_f32_16x16x32_bf16 a[204:207], a[76:79], v[88:91], a[204:207]
    v_mfma_f32_16x16x32_bf16 a[204:207], a[92:95], v[92:95], a[204:207]
    s_waitcnt vmcnt(14)
    v_mfma_f32_16x16x32_bf16 a[208:211], a[64:67], v[24:27], a[208:211]
    v_mfma_f32_16x16x32_bf16 a[208:211], a[80:83], v[28:31], a[208:211]
    s_add_u32 s43, s30, 24576
    buffer_load_dwordx4 v[88:91], v5, s[12:15], s43 offen sc1
    v_mfma_f32_16x16x32_bf16 a[212:215], a[68:71], v[24:27], a[212:215]
    v_mfma_f32_16x16x32_bf16 a[212:215], a[84:87], v[28:31], a[212:215]
    v_mfma_f32_16x16x32_bf16 a[216:219], a[72:75], v[24:27], a[216:219]
    v_mfma_f32_16x16x32_bf16 a[216:219], a[88:91], v[28:31], a[216:219]
    s_add_u32 s100, s31, 24576
    buffer_load_dwordx4 v[92:95], v5, s[12:15], s100 offen sc1
    v_mfma_f32_16x16x32_bf16 a[220:223], a[76:79], v[24:27], a[220:223]
    v_mfma_f32_16x16x32_bf16 a[220:223], a[92:95], v[28:31], a[220:223]
    s_waitcnt vmcnt(14)
    v_mfma_f32_16x16x32_bf16 a[224:227], a[64:67], v[32:35], a[224:227]
    v_mfma_f32_16x16x32_bf16 a[224:227], a[80:83], v[36:39], a[224:227]
    buffer_load_dwordx4 v[24:27], v6, s[12:15], s40 offen sc1
    v_mfma_f32_16x16x32_bf16 a[228:231], a[68:71], v[32:35], a[228:231]
    v_mfma_f32_16x16x32_bf16 a[228:231], a[84:87], v[36:39], a[228:231]
    v_mfma_f32_16x16x32_bf16 a[232:235], a[72:75], v[32:35], a[232:235]
    v_mfma_f32_16x16x32_bf16 a[232:235], a[88:91], v[36:39], a[232:235]
    buffer_load_dwordx4 v[28:31], v6, s[12:15], s41 offen sc1
    v_mfma_f32_16x16x32_bf16 a[236:239], a[76:79], v[32:35], a[236:239]
    v_mfma_f32_16x16x32_bf16 a[236:239], a[92:95], v[36:39], a[236:239]
    s_waitcnt vmcnt(14) lgkmcnt(0)
    v_mfma_f32_16x16x32_bf16 a[160:163], a[96:99], v[40:43], a[160:163]
    v_mfma_f32_16x16x32_bf16 a[160:163], a[112:115], v[44:47], a[160:163]
    buffer_load_dwordx4 v[32:35], v6, s[12:15], s43 offen sc1
    v_mfma_f32_16x16x32_bf16 a[164:167], a[100:103], v[40:43], a[164:167]
    v_mfma_f32_16x16x32_bf16 a[164:167], a[116:119], v[44:47], a[164:167]
    v_mfma_f32_16x16x32_bf16 a[168:171], a[104:107], v[40:43], a[168:171]
    v_mfma_f32_16x16x32_bf16 a[168:171], a[120:123], v[44:47], a[168:171]
    buffer_load_dwordx4 v[36:39], v6, s[12:15], s100 offen sc1
    v_mfma_f32_16x16x32_bf16 a[172:175], a[108:111], v[40:43], a[172:175]
    v_mfma_f32_16x16x32_bf16 a[172:175], a[124:127], v[44:47], a[172:175]
    s_waitcnt vmcnt(14)
    v_mfma_f32_16x16x32_bf16 a[176:179], a[96:99], v[48:51], a[176:179]
    v_mfma_f32_16x16x32_bf16 a[176:179], a[112:115], v[52:55], a[176:179]
    buffer_load_dwordx4 v[40:43], v7, s[12:15], s40 offen sc1
    v_mfma_f32_16x16x32_bf16 a[180:183], a[100:103], v[48:51], a[180:183]
    v_mfma_f32_16x16x32_bf16 a[180:183], a[116:119], v[52:55], a[180:183]
    v_mfma_f32_16x16x32_bf16 a[184:187], a[104:107], v[48:51], a[184:187]
    v_mfma_f32_16x16x32_bf16 a[184:187], a[120:123], v[52:55], a[184:187]
    buffer_load_dwordx4 v[44:47], v7, s[12:15], s41 offen sc1
    v_mfma_f32_16x16x32_bf16 a[188:191], a[108:111], v[48:51], a[188:191]
    v_mfma_f32_16x16x32_bf16 a[188:191], a[124:127], v[52:55], a[188:191]
    s_waitcnt vmcnt(14)
    v_mfma_f32_16x16x32_bf16 a[192:195], a[96:99], v[56:59], a[192:195]
    v_mfma_f32_16x16x32_bf16 a[192:195], a[112:115], v[60:63], a[192:195]
    buffer_load_dwordx4 v[48:51], v7, s[12:15], s43 offen sc1
    v_mfma_f32_16x16x32_bf16 a[196:199], a[100:103], v[56:59], a[196:199]
    v_mfma_f32_16x16x32_bf16 a[196:199], a[116:119], v[60:63], a[196:199]
    v_mfma_f32_16x16x32_bf16 a[200:203], a[104:107], v[56:59], a[200:203]
    v_mfma_f32_16x16x32_bf16 a[200:203], a[120:123], v[60:63], a[200:203]
    buffer_load_dwordx4 v[52:55], v7, s[12:15], s100 offen sc1
    v_mfma_f32_16x16x32_bf16 a[204:207], a[108:111], v[56:59], a[204:207]
    v_mfma_f32_16x16x32_bf16 a[204:207], a[124:127], v[60:63], a[204:207]
    s_waitcnt vmcnt(14)
    v_mfma_f32_16x16x32_bf16 a[208:211], a[96:99], v[64:67], a[208:211]
    v_mfma_f32_16x16x32_bf16 a[208:211], a[112:115], v[68:71], a[208:211]
    buffer_load_dwordx4 v[56:59], v8, s[12:15], s40 offen sc1
    v_mfma_f32_16x16x32_bf16 a[212:215], a[100:103], v[64:67], a[212:215]
    v_mfma_f32_16x16x32_bf16 a[212:215], a[116:119], v[68:71], a[212:215]
    v_mfma_f32_16x16x32_bf16 a[216:219], a[104:107], v[64:67], a[216:219]
    v_mfma_f32_16x16x32_bf16 a[216:219], a[120:123], v[68:71], a[216:219]
    buffer_load_dwordx4 v[60:63], v8, s[12:15], s41 offen sc1
    v_mfma_f32_16x16x32_bf16 a[220:223], a[108:111], v[64:67], a[220:223]
    v_mfma_f32_16x16x32_bf16 a[220:223], a[124:127], v[68:71], a[220:223]
    s_waitcnt vmcnt(14)
    v_mfma_f32_16x16x32_bf16 a[224:227], a[96:99], v[72:75], a[224:227]
    v_mfma_f32_16x16x32_bf16 a[224:227], a[112:115], v[76:79], a[224:227]
    buffer_load_dwordx4 v[64:67], v8, s[12:15], s43 offen sc1
    v_mfma_f32_16x16x32_bf16 a[228:231], a[100:103], v[72:75], a[228:231]
    v_mfma_f32_16x16x32_bf16 a[228:231], a[116:119], v[76:79], a[228:231]
    v_mfma_f32_16x16x32_bf16 a[232:235], a[104:107], v[72:75], a[232:235]
    v_mfma_f32_16x16x32_bf16 a[232:235], a[120:123], v[76:79], a[232:235]
    buffer_load_dwordx4 v[68:71], v8, s[12:15], s100 offen sc1
    v_mfma_f32_16x16x32_bf16 a[236:239], a[108:111], v[72:75], a[236:239]
    v_mfma_f32_16x16x32_bf16 a[236:239], a[124:127], v[76:79], a[236:239]
    s_waitcnt vmcnt(12)
    v_mfma_f32_16x16x32_bf16 a[160:163], a[128:131], v[80:83], a[160:163]
    v_mfma_f32_16x16x32_bf16 a[160:163], a[144:147], v[84:87], a[160:163]
    buffer_load_dwordx4 v[72:75], v9, s[12:15], s40 offen sc1
    v_mfma_f32_16x16x32_bf16 a[160:163], v[96:99], v[88:91], a[160:163]
    v_mfma_f32_16x16x32_bf16 a[160:163], v[112:115], v[92:95], a[160:163]
    v_mfma_f32_16x16x32_bf16 a[164:167], a[132:135], v[80:83], a[164:167]
    v_mfma_f32_16x16x32_bf16 a[164:167], a[148:151], v[84:87], a[164:167]
    buffer_load_dwordx4 v[76:79], v9, s[12:15], s41 offen sc1
    v_mfma_f32_16x16x32_bf16 a[164:167], v[100:103], v[88:91], a[164:167]
    v_mfma_f32_16x16x32_bf16 a[164:167], v[116:119], v[92:95], a[164:167]
    v_mfma_f32_16x16x32_bf16 a[168:171], a[136:139], v[80:83], a[168:171]
    v_mfma_f32_16x16x32_bf16 a[168:171], a[152:155], v[84:87], a[168:171]
    v_mfma_f32_16x16x32_bf16 a[168:171], v[104:107], v[88:91], a[168:171]
    v_mfma_f32_16x16x32_bf16 a[168:171], v[120:123], v[92:95], a[168:171]
    v_mfma_f32_16x16x32_bf16 a[172:175], a[140:143], v[80:83], a[172:175]
    v_mfma_f32_16x16x32_bf16 a[172:175], a[156:159], v[84:87], a[172:175]
    v_mfma_f32_16x16x32_bf16 a[172:175], v[108:111], v[88:91], a[172:175]
    v_mfma_f32_16x16x32_bf16 a[172:175], v[124:127], v[92:95], a[172:175]
    ds_write_b128 v20, a[160:163] offset:0
    s_waitcnt vmcnt(10)
    v_mfma_f32_16x16x32_bf16 a[176:179], a[128:131], v[24:27], a[176:179]
    v_mfma_f32_16x16x32_bf16 a[176:179], a[144:147], v[28:31], a[176:179]
    buffer_load_dwordx4 v[80:83], v9, s[12:15], s43 offen sc1
    v_mfma_f32_16x16x32_bf16 a[176:179], v[96:99], v[32:35], a[176:179]
    v_mfma_f32_16x16x32_bf16 a[176:179], v[112:115], v[36:39], a[176:179]
    ds_write_b128 v20, a[164:167] offset:1024
    v_mfma_f32_16x16x32_bf16 a[180:183], a[132:135], v[24:27], a[180:183]
    v_mfma_f32_16x16x32_bf16 a[180:183], a[148:151], v[28:31], a[180:183]
    buffer_load_dwordx4 v[84:87], v9, s[12:15], s100 offen sc1
    v_mfma_f32_16x16x32_bf16 a[180:183], v[100:103], v[32:35], a[180:183]
    v_mfma_f32_16x16x32_bf16 a[180:183], v[116:119], v[36:39], a[180:183]
    ds_write_b128 v20, a[168:171] offset:2048
    v_mfma_f32_16x16x32_bf16 a[184:187], a[136:139], v[24:27], a[184:187]
    v_mfma_f32_16x16x32_bf16 a[184:187], a[152:155], v[28:31], a[184:187]
    v_mfma_f32_16x16x32_bf16 a[184:187], v[104:107], v[32:35], a[184:187]
    v_mfma_f32_16x16x32_bf16 a[184:187], v[120:123], v[36:39], a[184:187]
    ds_write_b128 v20, a[172:175] offset:3072
    v_mfma_f32_16x16x32_bf16 a[188:191], a[140:143], v[24:27], a[188:191]
    v_mfma_f32_16x16x32_bf16 a[188:191], a[156:159], v[28:31], a[188:191]
    v_mfma_f32_16x16x32_bf16 a[188:191], v[108:111], v[32:35], a[188:191]
    v_mfma_f32_16x16x32_bf16 a[188:191], v[124:127], v[36:39], a[188:191]
    ds_write_b128 v20, a[176:179] offset:16384
    s_waitcnt vmcnt(8)
    v_mfma_f32_16x16x32_bf16 a[192:195], a[128:131], v[40:43], a[192:195]
    v_mfma_f32_16x16x32_bf16 a[192:195], a[144:147], v[44:47], a[192:195]
    v_mfma_f32_16x16x32_bf16 a[192:195], v[96:99], v[48:51], a[192:195]
    v_mfma_f32_16x16x32_bf16 a[192:195], v[112:115], v[52:55], a[192:195]
    ds_write_b128 v20, a[180:183] offset:17408
    v_mfma_f32_16x16x32_bf16 a[196:199], a[132:135], v[40:43], a[196:199]
    v_mfma_f32_16x16x32_bf16 a[196:199], a[148:151], v[44:47], a[196:199]
    v_mfma_f32_16x16x32_bf16 a[196:199], v[100:103], v[48:51], a[196:199]
    v_mfma_f32_16x16x32_bf16 a[196:199], v[116:119], v[52:55], a[196:199]
    ds_write_b128 v20, a[184:187] offset:18432
    v_mfma_f32_16x16x32_bf16 a[200:203], a[136:139], v[40:43], a[200:203]
    v_mfma_f32_16x16x32_bf16 a[200:203], a[152:155], v[44:47], a[200:203]
    v_mfma_f32_16x16x32_bf16 a[200:203], v[104:107], v[48:51], a[200:203]
    v_mfma_f32_16x16x32_bf16 a[200:203], v[120:123], v[52:55], a[200:203]
    ds_write_b128 v20, a[188:191] offset:19456
    v_mfma_f32_16x16x32_bf16 a[204:207], a[140:143], v[40:43], a[204:207]
    v_mfma_f32_16x16x32_bf16 a[204:207], a[156:159], v[44:47], a[204:207]
    v_mfma_f32_16x16x32_bf16 a[204:207], v[108:111], v[48:51], a[204:207]
    v_mfma_f32_16x16x32_bf16 a[204:207], v[124:127], v[52:55], a[204:207]
    ds_write_b128 v20, a[192:195] offset:32768
    s_waitcnt vmcnt(4)
    v_mfma_f32_16x16x32_bf16 a[208:211], a[128:131], v[56:59], a[208:211]
    v_mfma_f32_16x16x32_bf16 a[208:211], a[144:147], v[60:63], a[208:211]
    v_mfma_f32_16x16x32_bf16 a[208:211], v[96:99], v[64:67], a[208:211]
    v_mfma_f32_16x16x32_bf16 a[208:211], v[112:115], v[68:71], a[208:211]
    ds_write_b128 v20, a[196:199] offset:33792
    v_mfma_f32_16x16x32_bf16 a[212:215], a[132:135], v[56:59], a[212:215]
    v_mfma_f32_16x16x32_bf16 a[212:215], a[148:151], v[60:63], a[212:215]
    v_mfma_f32_16x16x32_bf16 a[212:215], v[100:103], v[64:67], a[212:215]
    v_mfma_f32_16x16x32_bf16 a[212:215], v[116:119], v[68:71], a[212:215]
    ds_write_b128 v20, a[200:203] offset:34816
    v_mfma_f32_16x16x32_bf16 a[216:219], a[136:139], v[56:59], a[216:219]
    v_mfma_f32_16x16x32_bf16 a[216:219], a[152:155], v[60:63], a[216:219]
    v_mfma_f32_16x16x32_bf16 a[216:219], v[104:107], v[64:67], a[216:219]
    v_mfma_f32_16x16x32_bf16 a[216:219], v[120:123], v[68:71], a[216:219]
    ds_write_b128 v20, a[204:207] offset:35840
    v_mfma_f32_16x16x32_bf16 a[220:223], a[140:143], v[56:59], a[220:223]
    v_mfma_f32_16x16x32_bf16 a[220:223], a[156:159], v[60:63], a[220:223]
    v_mfma_f32_16x16x32_bf16 a[220:223], v[108:111], v[64:67], a[220:223]
    v_mfma_f32_16x16x32_bf16 a[220:223], v[124:127], v[68:71], a[220:223]
    ds_write_b128 v20, a[208:211] offset:49152
    s_waitcnt vmcnt(0)
    v_mfma_f32_16x16x32_bf16 a[224:227], a[128:131], v[72:75], a[224:227]
    v_mfma_f32_16x16x32_bf16 a[224:227], a[144:147], v[76:79], a[224:227]
    v_mfma_f32_16x16x32_bf16 a[224:227], v[96:99], v[80:83], a[224:227]
    v_mfma_f32_16x16x32_bf16 a[224:227], v[112:115], v[84:87], a[224:227]
    ds_write_b128 v20, a[212:215] offset:50176
    v_mfma_f32_16x16x32_bf16 a[228:231], a[132:135], v[72:75], a[228:231]
    v_mfma_f32_16x16x32_bf16 a[228:231], a[148:151], v[76:79], a[228:231]
    v_mfma_f32_16x16x32_bf16 a[228:231], v[100:103], v[80:83], a[228:231]
    v_mfma_f32_16x16x32_bf16 a[228:231], v[116:119], v[84:87], a[228:231]
    ds_write_b128 v20, a[216:219] offset:51200
    v_mfma_f32_16x16x32_bf16 a[232:235], a[136:139], v[72:75], a[232:235]
    v_mfma_f32_16x16x32_bf16 a[232:235], a[152:155], v[76:79], a[232:235]
    v_mfma_f32_16x16x32_bf16 a[232:235], v[104:107], v[80:83], a[232:235]
    v_mfma_f32_16x16x32_bf16 a[232:235], v[120:123], v[84:87], a[232:235]
    ds_write_b128 v20, a[220:223] offset:52224
    v_mfma_f32_16x16x32_bf16 a[236:239], a[140:143], v[72:75], a[236:239]
    v_mfma_f32_16x16x32_bf16 a[236:239], a[156:159], v[76:79], a[236:239]
    v_mfma_f32_16x16x32_bf16 a[236:239], v[108:111], v[80:83], a[236:239]
    v_mfma_f32_16x16x32_bf16 a[236:239], v[124:127], v[84:87], a[236:239]
    ds_write_b128 v22, a[224:227] offset:0
    s_nop 1
    ds_write_b128 v22, a[228:231] offset:1024
    ds_write_b128 v22, a[232:235] offset:2048
    s_nop 4
    ds_write_b128 v22, a[236:239] offset:3072
L1_reduce:
    s_waitcnt lgkmcnt(0)
    s_barrier
    ds_read_b128 v[24:27], v0 offset:0
    ds_read_b128 v[28:31], v0 offset:1024
    ds_read_b128 v[32:35], v0 offset:4096
    ds_read_b128 v[36:39], v0 offset:5120
    ds_read_b128 v[40:43], v0 offset:8192
    ds_read_b128 v[44:47], v0 offset:9216
    ds_read_b128 v[48:51], v0 offset:12288
    ds_read_b128 v[52:55], v0 offset:13312
    ds_read_b128 v[56:59], v17 offset:0
    ds_read_b128 v[60:63], v17 offset:1024
    ds_read_b128 v[64:67], v17 offset:4096
    ds_read_b128 v[68:71], v17 offset:5120
    ds_read_b128 v[72:75], v17 offset:8192
    ds_read_b128 v[76:79], v17 offset:9216
    ds_read_b128 v[80:83], v17 offset:12288
    ds_read_b128 v[84:87], v17 offset:13312
    ds_read_b128 v[88:91], v18 offset:0
    ds_read_b128 v[92:95], v18 offset:1024
    ds_read_b128 v[96:99], v18 offset:4096
    ds_read_b128 v[100:103], v18 offset:5120
    ds_read_b128 v[104:107], v18 offset:8192
    ds_read_b128 v[108:111], v18 offset:9216
    ds_read_b128 v[112:115], v18 offset:12288
    ds_read_b128 v[116:119], v18 offset:13312
    s_waitcnt lgkmcnt(15)
    v_pk_add_f32 v[24:25], v[24:25], v[32:33]
    v_pk_add_f32 v[40:41], v[40:41], v[48:49]
    v_pk_add_f32 v[26:27], v[26:27], v[34:35]
    v_pk_add_f32 v[42:43], v[42:43], v[50:51]
    v_pk_add_f32 v[28:29], v[28:29], v[36:37]
    v_pk_add_f32 v[44:45], v[44:45], v[52:53]
    v_pk_add_f32 v[30:31], v[30:31], v[38:39]
    v_pk_add_f32 v[46:47], v[46:47], v[54:55]
    v_pk_add_f32 v[24:25], v[24:25], v[40:41]
    v_pk_add_f32 v[26:27], v[26:27], v[42:43]
    v_pk_add_f32 v[28:29], v[28:29], v[44:45]
    v_pk_add_f32 v[30:31], v[30:31], v[46:47]
    v_cvt_pk_bf16_f32 v120, v24, v25
    v_cvt_pk_bf16_f32 v122, v28, v29
    v_cvt_pk_bf16_f32 v121, v26, v27
    v_cvt_pk_bf16_f32 v123, v30, v31
    v_permlane16_swap_b32 v120, v122
    s_nop 0
    v_permlane16_swap_b32 v121, v123
    buffer_store_dwordx4 v[120:123], v23, s[16:19], s45 offen
    s_waitcnt lgkmcnt(8)
    v_pk_add_f32 v[56:57], v[56:57], v[64:65]
    v_pk_add_f32 v[72:73], v[72:73], v[80:81]
    v_pk_add_f32 v[58:59], v[58:59], v[66:67]
    v_pk_add_f32 v[74:75], v[74:75], v[82:83]
    v_pk_add_f32 v[60:61], v[60:61], v[68:69]
    v_pk_add_f32 v[76:77], v[76:77], v[84:85]
    v_pk_add_f32 v[62:63], v[62:63], v[70:71]
    v_pk_add_f32 v[78:79], v[78:79], v[86:87]
    v_pk_add_f32 v[56:57], v[56:57], v[72:73]
    v_pk_add_f32 v[58:59], v[58:59], v[74:75]
    v_pk_add_f32 v[60:61], v[60:61], v[76:77]
    v_pk_add_f32 v[62:63], v[62:63], v[78:79]
    v_cvt_pk_bf16_f32 v124, v56, v57
    v_cvt_pk_bf16_f32 v126, v60, v61
    v_cvt_pk_bf16_f32 v125, v58, v59
    v_cvt_pk_bf16_f32 v127, v62, v63
    v_permlane16_swap_b32 v124, v126
    s_nop 0
    v_permlane16_swap_b32 v125, v127
    buffer_store_dwordx4 v[124:127], v23, s[16:19], s46 offen
    s_waitcnt lgkmcnt(0)
    v_pk_add_f32 v[88:89], v[88:89], v[96:97]
    v_pk_add_f32 v[104:105], v[104:105], v[112:113]
    v_pk_add_f32 v[90:91], v[90:91], v[98:99]
    v_pk_add_f32 v[106:107], v[106:107], v[114:115]
    v_pk_add_f32 v[92:93], v[92:93], v[100:101]
    v_pk_add_f32 v[108:109], v[108:109], v[116:117]
    v_pk_add_f32 v[94:95], v[94:95], v[102:103]
    v_pk_add_f32 v[110:111], v[110:111], v[118:119]
    v_pk_add_f32 v[88:89], v[88:89], v[104:105]
    v_pk_add_f32 v[90:91], v[90:91], v[106:107]
    v_pk_add_f32 v[92:93], v[92:93], v[108:109]
    v_pk_add_f32 v[94:95], v[94:95], v[110:111]
    v_cvt_pk_bf16_f32 v128, v88, v89
    v_cvt_pk_bf16_f32 v130, v92, v93
    v_cvt_pk_bf16_f32 v129, v90, v91
    v_cvt_pk_bf16_f32 v131, v94, v95
    v_permlane16_swap_b32 v128, v130
    s_nop 0
    v_permlane16_swap_b32 v129, v131
    buffer_store_dwordx4 v[128:131], v23, s[16:19], s47 offen
L1_done:
    s_endpgm
L1_fallback:
    s_mov_b32 s47, 1
    s_waitcnt vmcnt(0) lgkmcnt(0)
    v_mov_b32 v248, 0xff800000
    v_mov_b32 v249, 0xff800000
    v_mov_b32 v250, 0xff800000
    v_mov_b32 v251, 0xff800000
    v_mov_b32 v252, 0xff800000
    s_mov_b32 s45, 0
    s_mov_b32 s43, 0
    v_add_u32 v11, s43, v7
    v_add_u32 v13, s43, v9
    v_add_u32 v15, s43, v10
    v_xor_b32 v14, 32, v13
    v_xor_b32 v16, 32, v15
    v_add_u32 v12, s43, v8
L1_scan:
    s_barrier
    s_mov_b32 m0, s39
    s_nop 0
    buffer_load_dwordx4 v5, s[16:19], s45 offen nt lds
    buffer_load_dwordx4 v6, s[16:19], s45 offen offset:1024 nt lds
    buffer_load_dwordx4 v5, s[16:19], s45 offen offset:2048 nt lds
    buffer_load_dwordx4 v6, s[16:19], s45 offen offset:3072 nt lds
    s_add_u32 s45, s45, 16384
    s_waitcnt vmcnt(0)
    s_barrier
    ds_read_b128 a[184:187], v11 offset:0
    ds_read_b128 a[188:191], v11 offset:256
    ds_read_b128 a[192:195], v11 offset:512
    ds_read_b128 a[196:199], v11 offset:768
    s_waitcnt lgkmcnt(0)
    v_mfma_f32_16x16x32_bf16 v[216:219], a[184:187], v[24:27], 0
    v_mfma_f32_16x16x32_bf16 v[216:219], a[188:191], v[28:31], v[216:219]
    v_mfma_f32_16x16x32_bf16 v[216:219], a[192:195], v[32:35], v[216:219]
    v_mfma_f32_16x16x32_bf16 v[216:219], a[196:199], v[36:39], v[216:219]
    v_mfma_f32_16x16x32_bf16 v[220:223], a[184:187], v[40:43], 0
    v_mfma_f32_16x16x32_bf16 v[220:223], a[188:191], v[44:47], v[220:223]
    v_mfma_f32_16x16x32_bf16 v[220:223], a[192:195], v[48:51], v[220:223]
    v_mfma_f32_16x16x32_bf16 v[220:223], a[196:199], v[52:55], v[220:223]
    v_mfma_f32_16x16x32_bf16 v[224:227], a[184:187], v[56:59], 0
    v_mfma_f32_16x16x32_bf16 v[224:227], a[188:191], v[60:63], v[224:227]
    v_mfma_f32_16x16x32_bf16 v[224:227], a[192:195], v[64:67], v[224:227]
    v_mfma_f32_16x16x32_bf16 v[224:227], a[196:199], v[68:71], v[224:227]
    v_mfma_f32_16x16x32_bf16 v[228:231], a[184:187], v[72:75], 0
    v_mfma_f32_16x16x32_bf16 v[228:231], a[188:191], v[76:79], v[228:231]
    v_mfma_f32_16x16x32_bf16 v[228:231], a[192:195], v[80:83], v[228:231]
    v_mfma_f32_16x16x32_bf16 v[228:231], a[196:199], v[84:87], v[228:231]
    v_mfma_f32_16x16x32_bf16 v[232:235], a[184:187], v[88:91], 0
    v_mfma_f32_16x16x32_bf16 v[232:235], a[188:191], v[92:95], v[232:235]
    v_mfma_f32_16x16x32_bf16 v[232:235], a[192:195], v[96:99], v[232:235]
    v_mfma_f32_16x16x32_bf16 v[232:235], a[196:199], v[100:103], v[232:235]
    s_nop 7
    v_max3_f32 v248, v248, v216, v217
    v_max3_f32 v248, v248, v218, v219
    v_max3_f32 v249, v249, v220, v221
    v_max3_f32 v249, v249, v222, v223
    v_max3_f32 v250, v250, v224, v225
    v_max3_f32 v250, v250, v226, v227
    v_max3_f32 v251, v251, v228, v229
    v_max3_f32 v251, v251, v230, v231
    v_max3_f32 v252, v252, v232, v233
    v_max3_f32 v252, v252, v234, v235
    ds_read_b128 a[184:187], v11 offset:4096
    ds_read_b128 a[188:191], v11 offset:4352
    ds_read_b128 a[192:195], v11 offset:4608
    ds_read_b128 a[196:199], v11 offset:4864
    s_waitcnt lgkmcnt(0)
    v_mfma_f32_16x16x32_bf16 v[216:219], a[184:187], v[24:27], 0
    v_mfma_f32_16x16x32_bf16 v[216:219], a[188:191], v[28:31], v[216:219]
    v_mfma_f32_16x16x32_bf16 v[216:219], a[192:195], v[32:35], v[216:219]
    v_mfma_f32_16x16x32_bf16 v[216:219], a[196:199], v[36:39], v[216:219]
    v_mfma_f32_16x16x32_bf16 v[220:223], a[184:187], v[40:43], 0
    v_mfma_f32_16x16x32_bf16 v[220:223], a[188:191], v[44:47], v[220:223]
    v_mfma_f32_16x16x32_bf16 v[220:223], a[192:195], v[48:51], v[220:223]
    v_mfma_f32_16x16x32_bf16 v[220:223], a[196:199], v[52:55], v[220:223]
    v_mfma_f32_16x16x32_bf16 v[224:227], a[184:187], v[56:59], 0
    v_mfma_f32_16x16x32_bf16 v[224:227], a[188:191], v[60:63], v[224:227]
    v_mfma_f32_16x16x32_bf16 v[224:227], a[192:195], v[64:67], v[224:227]
    v_mfma_f32_16x16x32_bf16 v[224:227], a[196:199], v[68:71], v[224:227]
    v_mfma_f32_16x16x32_bf16 v[228:231], a[184:187], v[72:75], 0
    v_mfma_f32_16x16x32_bf16 v[228:231], a[188:191], v[76:79], v[228:231]
    v_mfma_f32_16x16x32_bf16 v[228:231], a[192:195], v[80:83], v[228:231]
    v_mfma_f32_16x16x32_bf16 v[228:231], a[196:199], v[84:87], v[228:231]
    v_mfma_f32_16x16x32_bf16 v[232:235], a[184:187], v[88:91], 0
    v_mfma_f32_16x16x32_bf16 v[232:235], a[188:191], v[92:95], v[232:235]
    v_mfma_f32_16x16x32_bf16 v[232:235], a[192:195], v[96:99], v[232:235]
    v_mfma_f32_16x16x32_bf16 v[232:235], a[196:199], v[100:103], v[232:235]
    s_nop 7
    v_max3_f32 v248, v248, v216, v217
    v_max3_f32 v248, v248, v218, v219
    v_max3_f32 v249, v249, v220, v221
    v_max3_f32 v249, v249, v222, v223
    v_max3_f32 v250, v250, v224, v225
    v_max3_f32 v250, v250, v226, v227
    v_max3_f32 v251, v251, v228, v229
    v_max3_f32 v251, v251, v230, v231
    v_max3_f32 v252, v252, v232, v233
    v_max3_f32 v252, v252, v234, v235
    ds_read_b128 a[184:187], v12 offset:0
    ds_read_b128 a[188:191], v12 offset:256
    ds_read_b128 a[192:195], v12 offset:512
    ds_read_b128 a[196:199], v12 offset:768
    s_waitcnt lgkmcnt(0)
    v_mfma_f32_16x16x32_bf16 v[216:219], a[184:187], v[24:27], 0
    v_mfma_f32_16x16x32_bf16 v[216:219], a[188:191], v[28:31], v[216:219]
    v_mfma_f32_16x16x32_bf16 v[216:219], a[192:195], v[32:35], v[216:219]
    v_mfma_f32_16x16x32_bf16 v[216:219], a[196:199], v[36:39], v[216:219]
    v_mfma_f32_16x16x32_bf16 v[220:223], a[184:187], v[40:43], 0
    v_mfma_f32_16x16x32_bf16 v[220:223], a[188:191], v[44:47], v[220:223]
    v_mfma_f32_16x16x32_bf16 v[220:223], a[192:195], v[48:51], v[220:223]
    v_mfma_f32_16x16x32_bf16 v[220:223], a[196:199], v[52:55], v[220:223]
    v_mfma_f32_16x16x32_bf16 v[224:227], a[184:187], v[56:59], 0
    v_mfma_f32_16x16x32_bf16 v[224:227], a[188:191], v[60:63], v[224:227]
    v_mfma_f32_16x16x32_bf16 v[224:227], a[192:195], v[64:67], v[224:227]
    v_mfma_f32_16x16x32_bf16 v[224:227], a[196:199], v[68:71], v[224:227]
    v_mfma_f32_16x16x32_bf16 v[228:231], a[184:187], v[72:75], 0
    v_mfma_f32_16x16x32_bf16 v[228:231], a[188:191], v[76:79], v[228:231]
    v_mfma_f32_16x16x32_bf16 v[228:231], a[192:195], v[80:83], v[228:231]
    v_mfma_f32_16x16x32_bf16 v[228:231], a[196:199], v[84:87], v[228:231]
    v_mfma_f32_16x16x32_bf16 v[232:235], a[184:187], v[88:91], 0
    v_mfma_f32_16x16x32_bf16 v[232:235], a[188:191], v[92:95], v[232:235]
    v_mfma_f32_16x16x32_bf16 v[232:235], a[192:195], v[96:99], v[232:235]
    v_mfma_f32_16x16x32_bf16 v[232:235], a[196:199], v[100:103], v[232:235]
    s_nop 7
    v_max3_f32 v248, v248, v216, v217
    v_max3_f32 v248, v248, v218, v219
    v_max3_f32 v249, v249, v220, v221
    v_max3_f32 v249, v249, v222, v223
    v_max3_f32 v250, v250, v224, v225
    v_max3_f32 v250, v250, v226, v227
    v_max3_f32 v251, v251, v228, v229
    v_max3_f32 v251, v251, v230, v231
    v_max3_f32 v252, v252, v232, v233
    v_max3_f32 v252, v252, v234, v235
    ds_read_b128 a[184:187], v12 offset:4096
    ds_read_b128 a[188:191], v12 offset:4352
    ds_read_b128 a[192:195], v12 offset:4608
    ds_read_b128 a[196:199], v12 offset:4864
    s_waitcnt lgkmcnt(0)
    v_mfma_f32_16x16x32_bf16 v[216:219], a[184:187], v[24:27], 0
    v_mfma_f32_16x16x32_bf16 v[216:219], a[188:191], v[28:31], v[216:219]
    v_mfma_f32_16x16x32_bf16 v[216:219], a[192:195], v[32:35], v[216:219]
    v_mfma_f32_16x16x32_bf16 v[216:219], a[196:199], v[36:39], v[216:219]
    v_mfma_f32_16x16x32_bf16 v[220:223], a[184:187], v[40:43], 0
    v_mfma_f32_16x16x32_bf16 v[220:223], a[188:191], v[44:47], v[220:223]
    v_mfma_f32_16x16x32_bf16 v[220:223], a[192:195], v[48:51], v[220:223]
    v_mfma_f32_16x16x32_bf16 v[220:223], a[196:199], v[52:55], v[220:223]
    v_mfma_f32_16x16x32_bf16 v[224:227], a[184:187], v[56:59], 0
    v_mfma_f32_16x16x32_bf16 v[224:227], a[188:191], v[60:63], v[224:227]
    v_mfma_f32_16x16x32_bf16 v[224:227], a[192:195], v[64:67], v[224:227]
    v_mfma_f32_16x16x32_bf16 v[224:227], a[196:199], v[68:71], v[224:227]
    v_mfma_f32_16x16x32_bf16 v[228:231], a[184:187], v[72:75], 0
    v_mfma_f32_16x16x32_bf16 v[228:231], a[188:191], v[76:79], v[228:231]
    v_mfma_f32_16x16x32_bf16 v[228:231], a[192:195], v[80:83], v[228:231]
    v_mfma_f32_16x16x32_bf16 v[228:231], a[196:199], v[84:87], v[228:231]
    v_mfma_f32_16x16x32_bf16 v[232:235], a[184:187], v[88:91], 0
    v_mfma_f32_16x16x32_bf16 v[232:235], a[188:191], v[92:95], v[232:235]
    v_mfma_f32_16x16x32_bf16 v[232:235], a[192:195], v[96:99], v[232:235]
    v_mfma_f32_16x16x32_bf16 v[232:235], a[196:199], v[100:103], v[232:235]
    s_nop 7
    v_max3_f32 v248, v248, v216, v217
    v_max3_f32 v248, v248, v218, v219
    v_max3_f32 v249, v249, v220, v221
    v_max3_f32 v249, v249, v222, v223
    v_max3_f32 v250, v250, v224, v225
    v_max3_f32 v250, v250, v226, v227
    v_max3_f32 v251, v251, v228, v229
    v_max3_f32 v251, v251, v230, v231
    v_max3_f32 v252, v252, v232, v233
    v_max3_f32 v252, v252, v234, v235
    s_cmp_lt_u32 s45, 524288
    s_cbranch_scc1 L1_scan
    s_barrier
    s_add_u32 m0, s39, 0
    s_mov_b32 s40, 0
    buffer_load_dwordx4 v5, s[16:19], s40 offen nt lds
    buffer_load_dwordx4 v6, s[16:19], s40 offen offset:1024 nt lds
    buffer_load_dwordx4 v5, s[16:19], s40 offen offset:2048 nt lds
    buffer_load_dwordx4 v6, s[16:19], s40 offen offset:3072 nt lds
    s_add_u32 m0, s39, 32768
    s_mov_b32 s40, 16384
    buffer_load_dwordx4 v5, s[16:19], s40 offen nt lds
    buffer_load_dwordx4 v6, s[16:19], s40 offen offset:1024 nt lds
    buffer_load_dwordx4 v5, s[16:19], s40 offen offset:2048 nt lds
    buffer_load_dwordx4 v6, s[16:19], s40 offen offset:3072 nt lds
    s_add_u32 m0, s39, 49152
    s_mov_b32 s40, 0
    buffer_load_dwordx4 v5, s[20:23], s40 offen nt lds
    buffer_load_dwordx4 v6, s[20:23], s40 offen offset:1024 nt lds
    buffer_load_dwordx4 v5, s[20:23], s40 offen offset:2048 nt lds
    buffer_load_dwordx4 v6, s[20:23], s40 offen offset:3072 nt lds
    v_accvgpr_write_b32 a0, 0
    v_accvgpr_write_b32 a1, 0
    v_accvgpr_write_b32 a2, 0
    v_accvgpr_write_b32 a3, 0
    v_accvgpr_write_b32 a4, 0
    v_accvgpr_write_b32 a5, 0
    v_accvgpr_write_b32 a6, 0
    v_accvgpr_write_b32 a7, 0
    v_accvgpr_write_b32 a8, 0
    v_accvgpr_write_b32 a9, 0
    v_accvgpr_write_b32 a10, 0
    v_accvgpr_write_b32 a11, 0
    v_accvgpr_write_b32 a12, 0
    v_accvgpr_write_b32 a13, 0
    v_accvgpr_write_b32 a14, 0
    v_accvgpr_write_b32 a15, 0
    v_accvgpr_write_b32 a16, 0
    v_accvgpr_write_b32 a17, 0
    v_accvgpr_write_b32 a18, 0
    v_accvgpr_write_b32 a19, 0
    v_accvgpr_write_b32 a20, 0
    v_accvgpr_write_b32 a21, 0
    v_accvgpr_write_b32 a22, 0
    v_accvgpr_write_b32 a23, 0
    v_accvgpr_write_b32 a24, 0
    v_accvgpr_write_b32 a25, 0
    v_accvgpr_write_b32 a26, 0
    v_accvgpr_write_b32 a27, 0
    v_accvgpr_write_b32 a28, 0
    v_accvgpr_write_b32 a29, 0
    v_accvgpr_write_b32 a30, 0
    v_accvgpr_write_b32 a31, 0
    v_accvgpr_write_b32 a32, 0
    v_accvgpr_write_b32 a33, 0
    v_accvgpr_write_b32 a34, 0
    v_accvgpr_write_b32 a35, 0
    v_accvgpr_write_b32 a36, 0
    v_accvgpr_write_b32 a37, 0
    v_accvgpr_write_b32 a38, 0
    v_accvgpr_write_b32 a39, 0
    v_accvgpr_write_b32 a40, 0
    v_accvgpr_write_b32 a41, 0
    v_accvgpr_write_b32 a42, 0
    v_accvgpr_write_b32 a43, 0
    v_accvgpr_write_b32 a44, 0
    v_accvgpr_write_b32 a45, 0
    v_accvgpr_write_b32 a46, 0
    v_accvgpr_write_b32 a47, 0
    v_accvgpr_write_b32 a48, 0
    v_accvgpr_write_b32 a49, 0
    v_accvgpr_write_b32 a50, 0
    v_accvgpr_write_b32 a51, 0
    v_accvgpr_write_b32 a52, 0
    v_accvgpr_write_b32 a53, 0
    v_accvgpr_write_b32 a54, 0
    v_accvgpr_write_b32 a55, 0
    v_accvgpr_write_b32 a56, 0
    v_accvgpr_write_b32 a57, 0
    v_accvgpr_write_b32 a58, 0
    v_accvgpr_write_b32 a59, 0
    v_accvgpr_write_b32 a60, 0
    v_accvgpr_write_b32 a61, 0
    v_accvgpr_write_b32 a62, 0
    v_accvgpr_write_b32 a63, 0
    v_accvgpr_write_b32 a64, 0
    v_accvgpr_write_b32 a65, 0
    v_accvgpr_write_b32 a66, 0
    v_accvgpr_write_b32 a67, 0
    v_accvgpr_write_b32 a68, 0
    v_accvgpr_write_b32 a69, 0
    v_accvgpr_write_b32 a70, 0
    v_accvgpr_write_b32 a71, 0
    v_accvgpr_write_b32 a72, 0
    v_accvgpr_write_b32 a73, 0
    v_accvgpr_write_b32 a74, 0
    v_accvgpr_write_b32 a75, 0
    v_accvgpr_write_b32 a76, 0
    v_accvgpr_write_b32 a77, 0
    v_accvgpr_write_b32 a78, 0
    v_accvgpr_write_b32 a79, 0
    v_accvgpr_write_b32 a80, 0
    v_accvgpr_write_b32 a81, 0
    v_accvgpr_write_b32 a82, 0
    v_accvgpr_write_b32 a83, 0
    v_accvgpr_write_b32 a84, 0
    v_accvgpr_write_b32 a85, 0
    v_accvgpr_write_b32 a86, 0
    v_accvgpr_write_b32 a87, 0
    v_accvgpr_write_b32 a88, 0
    v_accvgpr_write_b32 a89, 0
    v_accvgpr_write_b32 a90, 0
    v_accvgpr_write_b32 a91, 0
    v_accvgpr_write_b32 a92, 0
    v_accvgpr_write_b32 a93, 0
    v_accvgpr_write_b32 a94, 0
    v_accvgpr_write_b32 a95, 0
    v_accvgpr_write_b32 a96, 0
    v_accvgpr_write_b32 a97, 0
    v_accvgpr_write_b32 a98, 0
    v_accvgpr_write_b32 a99, 0
    v_accvgpr_write_b32 a100, 0
    v_accvgpr_write_b32 a101, 0
    v_accvgpr_write_b32 a102, 0
    v_accvgpr_write_b32 a103, 0
    v_accvgpr_write_b32 a104, 0
    v_accvgpr_write_b32 a105, 0
    v_accvgpr_write_b32 a106, 0
    v_accvgpr_write_b32 a107, 0
    v_accvgpr_write_b32 a108, 0
    v_accvgpr_write_b32 a109, 0
    v_accvgpr_write_b32 a110, 0
    v_accvgpr_write_b32 a111, 0
    v_accvgpr_write_b32 a112, 0
    v_accvgpr_write_b32 a113, 0
    v_accvgpr_write_b32 a114, 0
    v_accvgpr_write_b32 a115, 0
    v_accvgpr_write_b32 a116, 0
    v_accvgpr_write_b32 a117, 0
    v_accvgpr_write_b32 a118, 0
    v_accvgpr_write_b32 a119, 0
    v_accvgpr_write_b32 a120, 0
    v_accvgpr_write_b32 a121, 0
    v_accvgpr_write_b32 a122, 0
    v_accvgpr_write_b32 a123, 0
    v_accvgpr_write_b32 a124, 0
    v_accvgpr_write_b32 a125, 0
    v_accvgpr_write_b32 a126, 0
    v_accvgpr_write_b32 a127, 0
    v_accvgpr_write_b32 a128, 0
    v_accvgpr_write_b32 a129, 0
    v_accvgpr_write_b32 a130, 0
    v_accvgpr_write_b32 a131, 0
    v_accvgpr_write_b32 a132, 0
    v_accvgpr_write_b32 a133, 0
    v_accvgpr_write_b32 a134, 0
    v_accvgpr_write_b32 a135, 0
    v_accvgpr_write_b32 a136, 0
    v_accvgpr_write_b32 a137, 0
    v_accvgpr_write_b32 a138, 0
    v_accvgpr_write_b32 a139, 0
    v_accvgpr_write_b32 a140, 0
    v_accvgpr_write_b32 a141, 0
    v_accvgpr_write_b32 a142, 0
    v_accvgpr_write_b32 a143, 0
    v_accvgpr_write_b32 a144, 0
    v_accvgpr_write_b32 a145, 0
    v_accvgpr_write_b32 a146, 0
    v_accvgpr_write_b32 a147, 0
    v_accvgpr_write_b32 a148, 0
    v_accvgpr_write_b32 a149, 0
    v_accvgpr_write_b32 a150, 0
    v_accvgpr_write_b32 a151, 0
    v_accvgpr_write_b32 a152, 0
    v_accvgpr_write_b32 a153, 0
    v_accvgpr_write_b32 a154, 0
    v_accvgpr_write_b32 a155, 0
    v_accvgpr_write_b32 a156, 0
    v_accvgpr_write_b32 a157, 0
    v_accvgpr_write_b32 a158, 0
    v_accvgpr_write_b32 a159, 0
    v_accvgpr_write_b32 a160, 0
    v_accvgpr_write_b32 a161, 0
    v_accvgpr_write_b32 a162, 0
    v_accvgpr_write_b32 a163, 0
    v_accvgpr_write_b32 a164, 0
    v_accvgpr_write_b32 a165, 0
    v_accvgpr_write_b32 a166, 0
    v_accvgpr_write_b32 a167, 0
    v_accvgpr_write_b32 a168, 0
    v_accvgpr_write_b32 a169, 0
    v_accvgpr_write_b32 a170, 0
    v_accvgpr_write_b32 a171, 0
    v_accvgpr_write_b32 a172, 0
    v_accvgpr_write_b32 a173, 0
    v_accvgpr_write_b32 a174, 0
    v_accvgpr_write_b32 a175, 0
    v_accvgpr_write_b32 a176, 0
    v_accvgpr_write_b32 a177, 0
    v_accvgpr_write_b32 a178, 0
    v_accvgpr_write_b32 a179, 0
    s_waitcnt vmcnt(8)
    s_barrier
    ds_read_b128 a[184:187], v11 offset:0
    ds_read_b128 a[188:191], v11 offset:256
    ds_read_b128 a[192:195], v11 offset:512
    ds_read_b128 a[196:199], v11 offset:768
    ds_read_b128 a[200:203], v11 offset:4096
    ds_read_b128 a[204:207], v11 offset:4352
    ds_read_b128 a[208:211], v11 offset:4608
    ds_read_b128 a[212:215], v11 offset:4864
    s_add_u32 m0, s39, 65536
    s_mov_b32 s42, 32768
    buffer_load_dwordx4 v5, s[16:19], s42 offen nt lds
    s_nop 0
    s_nop 0
    s_nop 0
    s_nop 0
    s_nop 0
    s_nop 0
    s_nop 0
    s_nop 0
    s_nop 0
    s_nop 0
    s_nop 0
    s_nop 0
    s_nop 0
    s_nop 0
    s_nop 0
    s_nop 0
    s_nop 0
    s_waitcnt lgkmcnt(0)
    v_mfma_f32_16x16x32_bf16 v[232:235], a[184:187], v[88:91], 0
    s_mov_b32 s45, 49152
    v_mfma_f32_16x16x32_bf16 v[232:235], a[188:191], v[92:95], v[232:235]
    s_mov_b32 s1, 32768
    v_mfma_f32_16x16x32_bf16 v[232:235], a[192:195], v[96:99], v[232:235]
    s_mov_b32 s46, 0
    v_mfma_f32_16x16x32_bf16 v[232:235], a[196:199], v[100:103], v[232:235]
    s_mov_b32 s43, 32768
    v_mfma_f32_16x16x32_bf16 v[236:239], a[184:187], v[24:27], 0
    s_mov_b32 s100, 0xffce0000
    v_mfma_f32_16x16x32_bf16 v[236:239], a[188:191], v[28:31], v[236:239]
    s_mov_b32 s28, s96
    v_mfma_f32_16x16x32_bf16 v[236:239], a[192:195], v[32:35], v[236:239]
    s_mov_b32 s29, s97
    v_mfma_f32_16x16x32_bf16 v[236:239], a[196:199], v[36:39], v[236:239]
    s_mov_b32 s30, 0
    v_max3_f32 v252, v252, v232, v233
    v_mfma_f32_16x16x32_bf16 v[240:243], a[184:187], v[40:43], 0
    s_mov_b32 s31, 0x20000
    v_max3_f32 v252, v252, v234, v235
    v_mfma_f32_16x16x32_bf16 v[240:243], a[188:191], v[44:47], v[240:243]
    s_mov_b32 s101, 0
    v_mov_b32 v20, v252
    v_mfma_f32_16x16x32_bf16 v[240:243], a[192:195], v[48:51], v[240:243]
    s_mul_i32 s4, s38, 1179648
    v_permlane32_swap_b32 v20, v252
    v_mfma_f32_16x16x32_bf16 v[240:243], a[196:199], v[52:55], v[240:243]
    s_lshr_b32 s5, s2, 3
    buffer_load_dwordx4 v6, s[16:19], s42 offen offset:1024 nt lds
    s_mul_i32 s5, s5, 4096
    v_max_f32 v252, v252, v20
    s_add_u32 s4, s4, s5
    v_mov_b32 v20, v252
    s_add_u32 s4, s4, 294912
    v_max3_f32 v248, v248, v236, v237
    v_cmp_gt_u32 vcc, 512, v1
    v_permlane16_swap_b32 v20, v252
    v_lshlrev_b32 v22, 3, v1
    v_max_f32 v252, v252, v20
    v_add_u32 v22, s4, v22
    v_sub_f32 v120, 0, v252
    v_mov_b32 v23, 0x40000000
    v_sub_f32 v121, 0, v252
    v_cndmask_b32 v22, v23, v22, vcc
    v_sub_f32 v122, 0, v252
    v_sub_f32 v123, 0, v252
    v_max3_f32 v248, v248, v238, v239
    v_mov_b32 v253, v248
    v_mfma_f32_16x16x32_bf16 v[244:247], a[200:203], v[88:91], v[120:123]
    v_max3_f32 v249, v249, v240, v241
    v_permlane32_swap_b32 v253, v248
    v_mfma_f32_16x16x32_bf16 v[244:247], a[204:207], v[92:95], v[244:247]
    v_max_f32 v248, v248, v253
    v_mov_b32 v253, v248
    v_mfma_f32_16x16x32_bf16 v[244:247], a[208:211], v[96:99], v[244:247]
    v_max3_f32 v249, v249, v242, v243
    v_permlane16_swap_b32 v253, v248
    v_mfma_f32_16x16x32_bf16 v[244:247], a[212:215], v[100:103], v[244:247]
    v_max_f32 v248, v248, v253
    v_sub_f32 v104, 0, v248
    v_sub_f32 v105, 0, v248
    v_sub_f32 v106, 0, v248
    v_sub_f32 v107, 0, v248
    v_mov_b32 v254, v249
    v_sub_f32 v232, v232, v252
    v_mfma_f32_16x16x32_bf16 v[164:167], a[200:203], v[24:27], v[104:107]
    v_permlane32_swap_b32 v254, v249
    v_max_f32 v249, v249, v254
    v_mfma_f32_16x16x32_bf16 v[164:167], a[204:207], v[28:31], v[164:167]
    v_mov_b32 v254, v249
    v_exp_f32 v232, v232
    v_mfma_f32_16x16x32_bf16 v[164:167], a[208:211], v[32:35], v[164:167]
    v_permlane16_swap_b32 v254, v249
    buffer_load_dwordx4 v5, s[16:19], s42 offen offset:2048 nt lds
    v_mfma_f32_16x16x32_bf16 v[164:167], a[212:215], v[36:39], v[164:167]
    v_max_f32 v249, v249, v254
    v_sub_f32 v108, 0, v249
    v_mfma_f32_16x16x32_bf16 v[168:171], a[184:187], v[56:59], 0
    v_sub_f32 v109, 0, v249
    v_sub_f32 v110, 0, v249
    v_mfma_f32_16x16x32_bf16 v[168:171], a[188:191], v[60:63], v[168:171]
    v_sub_f32 v111, 0, v249
    v_sub_f32 v233, v233, v252
    v_mfma_f32_16x16x32_bf16 v[168:171], a[192:195], v[64:67], v[168:171]
    v_exp_f32 v233, v233
    v_mfma_f32_16x16x32_bf16 v[168:171], a[196:199], v[68:71], v[168:171]
    v_sub_f32 v234, v234, v252
    v_exp_f32 v234, v234
    v_mfma_f32_16x16x32_bf16 v[172:175], a[200:203], v[40:43], v[108:111]
    v_sub_f32 v235, v235, v252
    v_exp_f32 v235, v235
    v_mfma_f32_16x16x32_bf16 v[172:175], a[204:207], v[44:47], v[172:175]
    v_cvt_pk_bf16_f32 v156, v232, v233
    v_cvt_pk_bf16_f32 v157, v234, v235
    v_mfma_f32_16x16x32_bf16 v[172:175], a[208:211], v[48:51], v[172:175]
    v_max3_f32 v250, v250, v168, v169
    v_max3_f32 v250, v250, v170, v171
    v_mfma_f32_16x16x32_bf16 v[172:175], a[212:215], v[52:55], v[172:175]
    v_mov_b32 v255, v250
    v_sub_f32 v236, v236, v248
    v_mfma_f32_16x16x32_bf16 v[176:179], a[184:187], v[72:75], 0
    v_permlane32_swap_b32 v255, v250
    v_max_f32 v250, v250, v255
    v_mfma_f32_16x16x32_bf16 v[176:179], a[188:191], v[76:79], v[176:179]
    v_mov_b32 v255, v250
    v_exp_f32 v236, v236
    v_mfma_f32_16x16x32_bf16 v[176:179], a[192:195], v[80:83], v[176:179]
    v_permlane16_swap_b32 v255, v250
    v_max_f32 v250, v250, v255
    v_mfma_f32_16x16x32_bf16 v[176:179], a[196:199], v[84:87], v[176:179]
    v_sub_f32 v112, 0, v250
    v_sub_f32 v113, 0, v250
    ds_read_b128 a[184:187], v12 offset:0
    ds_read_b128 a[188:191], v12 offset:256
    ds_read_b128 a[192:195], v12 offset:512
    ds_read_b128 a[196:199], v12 offset:768
    v_sub_f32 v114, 0, v250
    v_sub_f32 v115, 0, v250
    buffer_load_dwordx4 v6, s[16:19], s42 offen offset:3072 nt lds
    v_max3_f32 v251, v251, v176, v177
    v_mfma_f32_16x16x32_bf16 v[180:183], a[200:203], v[56:59], v[112:115]
    v_max3_f32 v251, v251, v178, v179
    v_mov_b32 v19, v251
    v_mfma_f32_16x16x32_bf16 v[180:183], a[204:207], v[60:63], v[180:183]
    v_sub_f32 v237, v237, v248
    v_permlane32_swap_b32 v19, v251
    v_mfma_f32_16x16x32_bf16 v[180:183], a[208:211], v[64:67], v[180:183]
    v_max_f32 v251, v251, v19
    v_mov_b32 v19, v251
    v_mfma_f32_16x16x32_bf16 v[180:183], a[212:215], v[68:71], v[180:183]
    v_exp_f32 v237, v237
    v_permlane16_swap_b32 v19, v251
    v_max_f32 v251, v251, v19
    v_sub_f32 v116, 0, v251
    v_sub_f32 v117, 0, v251
    v_sub_f32 v118, 0, v251
    v_sub_f32 v119, 0, v251
    v_sub_f32 v238, v238, v248
    v_exp_f32 v238, v238
    v_mfma_f32_16x16x32_bf16 v[184:187], a[200:203], v[72:75], v[116:119]
    s_waitcnt lgkmcnt(0)
    v_sub_f32 v239, v239, v248
    v_mfma_f32_16x16x32_bf16 v[184:187], a[204:207], v[76:79], v[184:187]
    v_exp_f32 v239, v239
    v_mfma_f32_16x16x32_bf16 v[184:187], a[208:211], v[80:83], v[184:187]
    v_cvt_pk_bf16_f32 v124, v236, v237
    v_cvt_pk_bf16_f32 v125, v238, v239
    v_mfma_f32_16x16x32_bf16 v[184:187], a[212:215], v[84:87], v[184:187]
    v_sub_f32 v240, v240, v249
    v_exp_f32 v240, v240
    v_mfma_f32_16x16x32_bf16 v[188:191], a[184:187], v[24:27], v[104:107]
    ds_read_b128 a[200:203], v12 offset:4096
    ds_read_b128 a[204:207], v12 offset:4352
    v_mfma_f32_16x16x32_bf16 v[188:191], a[188:191], v[28:31], v[188:191]
    ds_read_b128 a[208:211], v12 offset:4608
    ds_read_b128 a[212:215], v12 offset:4864
    v_mfma_f32_16x16x32_bf16 v[188:191], a[192:195], v[32:35], v[188:191]
    v_sub_f32 v241, v241, v249
    v_exp_f32 v241, v241
    v_mfma_f32_16x16x32_bf16 v[188:191], a[196:199], v[36:39], v[188:191]
    v_sub_f32 v242, v242, v249
    v_exp_f32 v242, v242
    v_mfma_f32_16x16x32_bf16 v[192:195], a[184:187], v[40:43], v[108:111]
    s_add_u32 m0, s39, 81920
    s_mov_b32 s42, 16384
    buffer_load_dwordx4 v5, s[20:23], s42 offen nt lds
    v_mfma_f32_16x16x32_bf16 v[192:195], a[188:191], v[44:47], v[192:195]
    v_sub_f32 v243, v243, v249
    v_exp_f32 v243, v243
    v_mfma_f32_16x16x32_bf16 v[192:195], a[192:195], v[48:51], v[192:195]
    v_cvt_pk_bf16_f32 v132, v240, v241
    v_cvt_pk_bf16_f32 v133, v242, v243
    v_mfma_f32_16x16x32_bf16 v[192:195], a[196:199], v[52:55], v[192:195]
    v_exp_f32 v244, v244
    v_mfma_f32_16x16x32_bf16 v[196:199], a[184:187], v[56:59], v[112:115]
    v_exp_f32 v245, v245
    v_mfma_f32_16x16x32_bf16 v[196:199], a[188:191], v[60:63], v[196:199]
    v_exp_f32 v246, v246
    v_mfma_f32_16x16x32_bf16 v[196:199], a[192:195], v[64:67], v[196:199]
    v_exp_f32 v247, v247
    v_mfma_f32_16x16x32_bf16 v[196:199], a[196:199], v[68:71], v[196:199]
    s_waitcnt lgkmcnt(0)
    v_add_u32 v11, s43, v7
    v_mfma_f32_16x16x32_bf16 v[200:203], a[184:187], v[72:75], v[116:119]
    v_add_u32 v13, s43, v9
    v_add_u32 v15, s43, v10
    v_mfma_f32_16x16x32_bf16 v[200:203], a[188:191], v[76:79], v[200:203]
    v_xor_b32 v14, 32, v13
    v_xor_b32 v16, 32, v15
    v_mfma_f32_16x16x32_bf16 v[200:203], a[192:195], v[80:83], v[200:203]
    v_add_u32 v12, s43, v8
    v_cvt_pk_bf16_f32 v158, v244, v245
    v_mfma_f32_16x16x32_bf16 v[200:203], a[196:199], v[84:87], v[200:203]
    v_cvt_pk_bf16_f32 v159, v246, v247
    v_exp_f32 v164, v164
    v_mfma_f32_16x16x32_bf16 v[204:207], a[200:203], v[24:27], v[104:107]
    v_exp_f32 v165, v165
    v_mfma_f32_16x16x32_bf16 v[204:207], a[204:207], v[28:31], v[204:207]
    v_exp_f32 v166, v166
    v_mfma_f32_16x16x32_bf16 v[204:207], a[208:211], v[32:35], v[204:207]
    v_exp_f32 v167, v167
    v_mfma_f32_16x16x32_bf16 v[204:207], a[212:215], v[36:39], v[204:207]
    v_cvt_pk_bf16_f32 v126, v164, v165
    v_cvt_pk_bf16_f32 v127, v166, v167
    v_mfma_f32_16x16x32_bf16 v[208:211], a[200:203], v[40:43], v[108:111]
    v_sub_f32 v168, v168, v250
    v_exp_f32 v168, v168
    v_mfma_f32_16x16x32_bf16 v[208:211], a[204:207], v[44:47], v[208:211]
    v_sub_f32 v169, v169, v250
    v_exp_f32 v169, v169
    v_mfma_f32_16x16x32_bf16 v[208:211], a[208:211], v[48:51], v[208:211]
    buffer_load_dwordx4 v6, s[20:23], s42 offen offset:1024 nt lds
    v_sub_f32 v170, v170, v250
    v_mfma_f32_16x16x32_bf16 v[208:211], a[212:215], v[52:55], v[208:211]
    v_exp_f32 v170, v170
    v_mfma_f32_16x16x32_bf16 v[212:215], a[200:203], v[56:59], v[112:115]
    v_sub_f32 v171, v171, v250
    v_exp_f32 v171, v171
    v_mfma_f32_16x16x32_bf16 v[212:215], a[204:207], v[60:63], v[212:215]
    v_cvt_pk_bf16_f32 v140, v168, v169
    v_cvt_pk_bf16_f32 v141, v170, v171
    v_mfma_f32_16x16x32_bf16 v[212:215], a[208:211], v[64:67], v[212:215]
    v_exp_f32 v172, v172
    v_mfma_f32_16x16x32_bf16 v[212:215], a[212:215], v[68:71], v[212:215]
    v_exp_f32 v173, v173
    v_mfma_f32_16x16x32_bf16 v[216:219], a[200:203], v[72:75], v[116:119]
    v_exp_f32 v174, v174
    v_mfma_f32_16x16x32_bf16 v[216:219], a[204:207], v[76:79], v[216:219]
    v_exp_f32 v175, v175
    v_mfma_f32_16x16x32_bf16 v[216:219], a[208:211], v[80:83], v[216:219]
    v_cvt_pk_bf16_f32 v134, v172, v173
    v_cvt_pk_bf16_f32 v135, v174, v175
    v_mfma_f32_16x16x32_bf16 v[216:219], a[212:215], v[84:87], v[216:219]
    v_sub_f32 v176, v176, v251
    v_exp_f32 v176, v176
    v_sub_f32 v177, v177, v251
    v_exp_f32 v177, v177
    v_sub_f32 v178, v178, v251
    v_exp_f32 v178, v178
    v_sub_f32 v179, v179, v251
    v_exp_f32 v179, v179
    v_cvt_pk_bf16_f32 v148, v176, v177
    v_cvt_pk_bf16_f32 v149, v178, v179
    v_exp_f32 v180, v180
    v_exp_f32 v181, v181
    v_exp_f32 v182, v182
    v_exp_f32 v183, v183
    v_cvt_pk_bf16_f32 v142, v180, v181
    v_cvt_pk_bf16_f32 v143, v182, v183
    v_exp_f32 v184, v184
    v_exp_f32 v185, v185
    v_exp_f32 v186, v186
    v_exp_f32 v187, v187
    v_cvt_pk_bf16_f32 v150, v184, v185
    v_cvt_pk_bf16_f32 v151, v186, v187
    v_exp_f32 v188, v188
    buffer_load_dwordx4 v5, s[20:23], s42 offen offset:2048 nt lds
    v_exp_f32 v189, v189
    v_exp_f32 v190, v190
    v_exp_f32 v191, v191
    v_cvt_pk_bf16_f32 v128, v188, v189
    v_cvt_pk_bf16_f32 v129, v190, v191
    v_exp_f32 v192, v192
    v_exp_f32 v193, v193
    v_exp_f32 v194, v194
    v_exp_f32 v195, v195
    v_cvt_pk_bf16_f32 v136, v192, v193
    v_cvt_pk_bf16_f32 v137, v194, v195
    v_exp_f32 v196, v196
    v_exp_f32 v197, v197
    v_exp_f32 v198, v198
    v_exp_f32 v199, v199
    v_cvt_pk_bf16_f32 v144, v196, v197
    v_cvt_pk_bf16_f32 v145, v198, v199
    v_exp_f32 v200, v200
    v_exp_f32 v201, v201
    v_exp_f32 v202, v202
    v_exp_f32 v203, v203
    v_cvt_pk_bf16_f32 v152, v200, v201
    v_cvt_pk_bf16_f32 v153, v202, v203
    v_exp_f32 v204, v204
    v_exp_f32 v205, v205
    v_exp_f32 v206, v206
    v_exp_f32 v207, v207
    v_cvt_pk_bf16_f32 v130, v204, v205
    v_cvt_pk_bf16_f32 v131, v206, v207
    v_exp_f32 v208, v208
    v_exp_f32 v209, v209
    v_exp_f32 v210, v210
    v_exp_f32 v211, v211
    v_cvt_pk_bf16_f32 v138, v208, v209
    v_cvt_pk_bf16_f32 v139, v210, v211
    v_exp_f32 v212, v212
    v_exp_f32 v213, v213
    v_exp_f32 v214, v214
    v_exp_f32 v215, v215
    v_cvt_pk_bf16_f32 v146, v212, v213
    v_cvt_pk_bf16_f32 v147, v214, v215
    v_exp_f32 v216, v216
    v_exp_f32 v217, v217
    v_exp_f32 v218, v218
    buffer_load_dwordx4 v6, s[20:23], s42 offen offset:3072 nt lds
    v_exp_f32 v219, v219
    v_cvt_pk_bf16_f32 v154, v216, v217
    v_cvt_pk_bf16_f32 v155, v218, v219
    s_nop 0
    s_waitcnt vmcnt(8)
    s_barrier
    buffer_load_dword v0, v22, s[28:31], s101 offen sc1
    ds_read_b64_tr_b16 a[216:217], v13 offset:16384
    ds_read_b128 a[184:187], v11 offset:0
    ds_read_b64_tr_b16 a[218:219], v13 offset:20480
    ds_read_b128 a[188:191], v11 offset:256
    ds_read_b64_tr_b16 a[220:221], v15 offset:16384
    ds_read_b128 a[192:195], v11 offset:512
    ds_read_b64_tr_b16 a[222:223], v15 offset:20480
    ds_read_b128 a[196:199], v11 offset:768
    ds_read_b64_tr_b16 a[224:225], v14 offset:16384
    s_nop 0
    ds_read_b64_tr_b16 a[226:227], v14 offset:20480
    s_nop 0
    ds_read_b64_tr_b16 a[228:229], v16 offset:16384
    s_nop 0
    ds_read_b64_tr_b16 a[230:231], v16 offset:20480
    s_waitcnt lgkmcnt(0)
    s_branch L1_loop
L1_end:
.section .rodata,"a"
.p2align 6
.amdhsa_kernel standalone__mha_block_cached__near_ridge_kernel
  .amdhsa_next_free_vgpr 512
  .amdhsa_next_free_sgpr 102
  .amdhsa_accum_offset 256
  .amdhsa_group_segment_fixed_size 0
  .amdhsa_kernarg_size 64
  .amdhsa_user_sgpr_count 2
  .amdhsa_user_sgpr_kernarg_segment_ptr 1
  .amdhsa_system_sgpr_workgroup_id_x 1
  .amdhsa_float_denorm_mode_32 3
.end_amdhsa_kernel
```
